```python
import torch

def _softmax(x, axis=-1):
    return torch.softmax(x, dim=axis)
def _gelu(x):
    return torch.nn.functional.gelu(x, approximate="tanh")
def _silu(x):
    return torch.nn.functional.silu(x)
def _sigmoid(x):
    return torch.sigmoid(x)
def _layernorm(x, axis=-1, eps=1e-5):
    m = x.mean(dim=axis, keepdim=True)
    v = x.var(dim=axis, keepdim=True, unbiased=False)
    return (x - m) / torch.sqrt(v + eps)
def _scatter_add(tgt, idx, src, axis=0):
    return tgt.clone().index_add_(axis, idx, src)
def _segment_sum(src, seg, n):
    out = torch.zeros((n,) + src.shape[1:], dtype=src.dtype)
    return out.index_add_(0, seg, src)
def _pad(x, pw):
    flat = tuple(v for pair in reversed(pw) for v in pair)
    return torch.nn.functional.pad(x, flat)

kernel_name = 'interleave_layers__grouped_kv_mqa__dense_activation_gelu__prompt'

def setup_inputs():

    _w = (lambda a: (lambda t: t.to(torch.bfloat16) if t.is_floating_point() else t)(torch.as_tensor(a)))
    def _A_setup():
        B, S, D, H = 1, 2048, 448, 16
        Dh = D // H
        return {
            "x": _w((lambda *s: torch.randn(*s, dtype=torch.bfloat16) * 0.05)(B, S, D)),
            "wq": _w((lambda *s: torch.randn(*s, dtype=torch.bfloat16) * 0.05)(D, H * Dh)),
            "wk": _w((lambda *s: torch.randn(*s, dtype=torch.bfloat16) * 0.05)(D, Dh)),
            "wv": _w((lambda *s: torch.randn(*s, dtype=torch.bfloat16) * 0.05)(D, Dh)),
            "wo": _w((lambda *s: torch.randn(*s, dtype=torch.bfloat16) * 0.05)(H * Dh, D)),
        }
    _A_in = _A_setup()

    def _B_setup():
        B, S, D, F = 1, 2048, 448, 1792
        return {
            "x": _w((lambda *s: torch.randn(*s, dtype=torch.bfloat16) * 0.05)(B, S, D)),
            "w1": _w((lambda *s: torch.randn(*s, dtype=torch.bfloat16) * 0.8)(D, F) * (D ** -0.5)),
            "b1": _w((lambda *s: torch.randn(*s, dtype=torch.bfloat16) * 12.8)(F) * 0.01),
            "w2": _w((lambda *s: torch.randn(*s, dtype=torch.bfloat16) * 0.2)(F, D) * (F ** -0.5)),
            "b2": _w((lambda *s: torch.randn(*s, dtype=torch.bfloat16) * 1.6)(D) * 0.01),
        }
    _B_in = _B_setup()

    return {
        "A_x": _A_in["x"],
        "A_wq": _A_in["wq"],
        "A_wk": _A_in["wk"],
        "A_wv": _A_in["wv"],
        "A_wo": _A_in["wo"],
        "B_x": _B_in["x"],
        "B_w1": _B_in["w1"],
        "B_b1": _B_in["b1"],
        "B_w2": _B_in["w2"],
        "B_b2": _B_in["b2"],
    }

def reference(A_x, A_wq, A_wk, A_wv, A_wo, B_x, B_w1, B_b1, B_w2, B_b2):
    def _A_ref(x, wq, wk, wv, wo):
        B, S, D = x.shape
        H = 16
        Dh = D // H
        q = (lambda x, *d: x.permute(*d))((x @ wq).reshape(B, S, H, Dh), 0, 2, 1, 3)
        k = x @ wk
        v = x @ wv
        scores = torch.einsum("bhqd,bkd->bhqk", q, k) * (Dh ** -0.5)
        p = _softmax(scores, axis=-1)
        o = torch.einsum("bhqk,bkd->bhqd", p, v)
        return (lambda x, *d: x.permute(*d))(o, 0, 2, 1, 3).reshape(B, S, H * Dh) @ wo

    def _B_ref(x, w1, b1, w2, b2):
        h = torch.einsum("bsd,df->bsf", x, w1) + b1
        h = _gelu(h)
        return torch.einsum("bsf,fd->bsd", h, w2) + b2

    x = A_x
    x = x + _A_ref(_layernorm(x, axis=-1), A_wq, A_wk, A_wv, A_wo)
    x = x + _B_ref(_layernorm(x, axis=-1), B_w1, B_b1, B_w2, B_b2)
    x = x + _A_ref(_layernorm(x, axis=-1), A_wq, A_wk, A_wv, A_wo)
    x = x + _B_ref(_layernorm(x, axis=-1), B_w1, B_b1, B_w2, B_b2)
    return x
```

```asm
; @launch grid=(256,1,1) block=(256,1,1) lds=163840
.amdgcn_target "amdgcn-amd-amdhsa--gfx950"
.text
.globl interleave_layers__grouped_kv_mqa__dense_activation_gelu__prompt_kernel
.p2align 8
.type interleave_layers__grouped_kv_mqa__dense_activation_gelu__prompt_kernel,@function
interleave_layers__grouped_kv_mqa__dense_activation_gelu__prompt_kernel:
    s_cmp_ge_u32 s2, 256
    s_cbranch_scc1 K_end
    s_load_dwordx8 s[4:11], s[0:1], 0
    s_load_dwordx2 s[12:13], s[0:1], 80
    s_load_dwordx2 s[14:15], s[0:1], 96
    s_load_dwordx2 s[44:45], s[0:1], 32
    s_load_dwordx8 s[48:55], s[0:1], 48
    s_load_dwordx2 s[46:47], s[0:1], 88
    v_and_b32 v1, 63, v0
    v_lshrrev_b32 v4, 6, v0
    v_lshlrev_b32 v2, 4, v1
    v_readfirstlane_b32 s16, v4
    v_lshrrev_b32 v3, 5, v1
    s_and_b32 s17, s2, 7
    s_lshl_b32 s17, s17, 1
    s_bfe_u32 s18, s2, 0x10003
    s_add_u32 s17, s17, s18
    s_lshr_b32 s18, s2, 4
    s_min_u32 s19, s18, 13
    v_cmp_eq_u32 s[28:29], 1, v3
    v_lshrrev_b32 v12, 2, v1
    v_and_b32 v6, 3, v1
    v_lshlrev_b32 v4, 4, v6
    v_bfe_u32 v5, v1, 2, 2
    v_bfe_u32 v7, v1, 4, 1
    s_cmp_lt_u32 s18, 14
    s_movk_i32 s26, 25088
    s_cselect_b32 s26, 401408, s26
    s_mov_b32 s27, 0x20000
    s_cselect_b32 s60, 896, 56
    s_cselect_b32 s61, s18, 0
    s_lshl_b32 s61, s61, 6
    v_mul_lo_u32 v9, v12, s60
    v_add3_u32 v9, v9, v4, s61
    s_and_b32 s3, s18, 1
    s_lshl_b32 s3, s3, 1
    s_and_b32 s61, s17, 1
    s_add_u32 s3, s3, s61
    s_lshl_b32 s3, s3, 1
    s_lshr_b32 s61, s18, 1
    s_add_u32 s3, s3, s61
    s_cmp_ge_u32 s3, 7
    s_cselect_b32 s61, 7, 0
    s_sub_u32 s3, s3, s61
    s_lshl_b32 s30, s3, 7
    s_lshl_b32 s32, s60, 6
    s_mul_i32 s33, s16, s60
    s_lshl_b32 s33, s33, 4
    s_mul_i32 s31, s3, s32
    s_add_u32 s31, s31, s33
    s_lshl_b32 s35, s16, 10
    s_lshl_b32 s36, s17, 2
    s_add_u32 s36, s36, s16
    s_mul_i32 s36, s36, 28672
    s_mul_i32 s37, s16, 28672
    s_add_u32 s37, s37, 29696
    s_lshl_b32 s39, s16, 12
    s_add_u32 s39, s39, 144384
    v_mad_u32_u24 v11, v3, 8, v5
    v_lshlrev_b32 v11, 6, v11
    v_lshl_add_u32 v11, v7, 5, v11
    v_lshl_add_u32 v11, v6, 3, v11
    v_mov_b32 v120, 0x3f803f80
    v_mov_b32 v121, 0x3f803f80
    v_mov_b32 v122, 0x3f803f80
    v_mov_b32 v123, 0x3f803f80
    v_mov_b32 v112, 0
    v_mov_b32 v113, 0
    v_mov_b32 v114, 0
    v_mov_b32 v115, 0
    v_mov_b32 v116, 0
    v_mov_b32 v117, 0
    v_mov_b32 v118, 0
    v_mov_b32 v119, 0
    v_lshrrev_b32 v12, 3, v1
    v_mul_u32_u24 v10, 896, v12
    v_lshrrev_b32 v12, 4, v1
    v_and_b32 v13, 7, v1
    v_xor_b32 v12, v12, v13
    v_lshl_add_u32 v10, v12, 4, v10
    v_xor_b32 v124, 64, v10
    v_and_b32 v12, 31, v1
    v_lshlrev_b32 v13, 7, v12
    v_add_u32 v13, s37, v13
    v_bfe_u32 v12, v1, 1, 3
    v_xor_b32 v12, v3, v12
    v_lshl_add_u32 v13, v12, 4, v13
    v_xor_b32 v14, 32, v13
    v_xor_b32 v125, 64, v13
    v_xor_b32 v126, 96, v13
    s_waitcnt lgkmcnt(0)
    s_mov_b32 s20, s14
    s_mov_b32 s21, s15
    s_mov_b32 s22, 0x2600000
    s_mov_b32 s23, 0x20000
    s_mov_b32 s38, 0x3c9000
    s_or_b32 s3, s2, s16
    s_cbranch_scc1 K_q1_noe
    buffer_load_dwordx2 v[144:145], off, s[20:23], s38 sc1
K_q1_noe:
    s_cmp_eq_u32 s18, 15
    s_cselect_b32 s24, s10, s8
    s_cselect_b32 s25, s11, s9
    s_cmp_lt_u32 s18, 14
    s_cselect_b32 s24, s6, s24
    s_cselect_b32 s25, s7, s25
    s_mov_b32 s40, s4
    s_mov_b32 s41, s5
    s_mov_b32 s42, 0x1c0000
    s_mov_b32 s43, 0x20000
    s_add_u32 m0, s35, 0
    s_add_u32 s34, s36, s30
    buffer_load_dwordx4 v9, s[24:27], s31 offen lds
    s_add_u32 s30, s30, 128
    s_add_u32 s31, s31, s32
    s_cmp_eq_u32 s30, 896
    s_cselect_b32 s30, 0, s30
    s_cselect_b32 s31, s33, s31
    s_add_u32 m0, s37, 0
    s_add_u32 s38, s34, 0
    buffer_load_dwordx4 v10, s[40:43], s38 offen lds
    s_add_u32 m0, s37, 1024
    s_add_u32 s38, s34, 7168
    buffer_load_dwordx4 v124, s[40:43], s38 offen lds
    s_add_u32 m0, s37, 2048
    s_add_u32 s38, s34, 14336
    buffer_load_dwordx4 v10, s[40:43], s38 offen lds
    s_add_u32 m0, s37, 3072
    s_add_u32 s38, s34, 21504
    buffer_load_dwordx4 v124, s[40:43], s38 offen lds
    s_add_u32 m0, s35, 4096
    s_add_u32 s34, s36, s30
    buffer_load_dwordx4 v9, s[24:27], s31 offen lds
    s_add_u32 s30, s30, 128
    s_add_u32 s31, s31, s32
    s_cmp_eq_u32 s30, 896
    s_cselect_b32 s30, 0, s30
    s_cselect_b32 s31, s33, s31
    s_add_u32 m0, s37, 4096
    s_add_u32 s38, s34, 0
    buffer_load_dwordx4 v10, s[40:43], s38 offen lds
    s_add_u32 m0, s37, 5120
    s_add_u32 s38, s34, 7168
    buffer_load_dwordx4 v124, s[40:43], s38 offen lds
    s_add_u32 m0, s37, 6144
    s_add_u32 s38, s34, 14336
    buffer_load_dwordx4 v10, s[40:43], s38 offen lds
    s_add_u32 m0, s37, 7168
    s_add_u32 s38, s34, 21504
    buffer_load_dwordx4 v124, s[40:43], s38 offen lds
    s_cmp_lg_u32 s16, 2
    s_cbranch_scc1 K_q1_nofw
    s_cmp_lg_u32 s18, 1
    s_cbranch_scc1 K_q1_nofw
    s_lshl_b32 s38, s17, 8
    s_add_u32 s38, s38, 0x3c0000
    v_min_u32 v146, 17, v1
    v_lshlrev_b32 v147, 11, v146
    v_and_b32 v147, 0xf000, v147
    v_and_b32 v146, 1, v146
    v_lshl_add_u32 v146, v146, 7, v147
    buffer_load_dword v149, v146, s[20:23], s38 offen sc1
K_q1_nofw:
    s_lshr_b32 s3, s2, 3
    s_xor_b32 s38, s16, 3
    s_lshl_b32 s38, s38, 8
    s_add_u32 s3, s3, s38
    s_cmp_ge_u32 s3, 17
    s_cbranch_scc1 K_q1_nopf
    s_getpc_b64 s[60:61]
K_q1_pc:
    s_lshl_b32 s3, s3, 12
    v_lshlrev_b32 v146, 6, v1
    v_add_u32 v146, s3, v146
    v_min_u32 v146, K_end-K_q1_pc, v146
    v_mov_b32 v147, s61
    v_add_co_u32 v146, vcc, s60, v146
    s_nop 1
    v_addc_co_u32 v147, vcc, 0, v147, vcc
    global_load_dword v148, v[146:147], off
K_q1_nopf:
    s_lshl_b32 s3, s2, 2
    s_add_u32 s3, s3, s16
    s_mov_b32 s59, 0x20000
    s_cmp_ge_u32 s3, 392
    s_cbranch_scc1 K_q1_ru2
    s_mov_b32 s56, s48
    s_mov_b32 s57, s49
    s_mov_b32 s58, 1605632
    s_mul_hi_u32 s60, s3, 0x924924a
    s_mul_i32 s61, s60, 28
    s_sub_u32 s61, s3, s61
    s_mul_i32 s48, s61, 57344
    s_lshl_b32 s49, s60, 8
    s_add_u32 s48, s48, s49
    s_movk_i32 s49, 14336
    v_lshrrev_b32 v8, 4, v1
    v_mul_u32_u24 v8, 3584, v8
    v_and_b32 v12, 15, v1
    v_lshl_add_u32 v8, v12, 4, v8
    s_mul_i32 s50, s60, 29
    s_add_u32 s50, s50, s61
    s_lshl_b32 s50, s50, 12
    s_add_u32 s50, s50, 0x401000
    s_movk_i32 s51, 1024
    s_movk_i32 s52, 2048
    s_mov_b32 s53, 0
    s_branch K_q1_rdma
K_q1_ru2:
    s_cmp_ge_u32 s3, 882
    s_cbranch_scc1 K_q1_ru4
    v_lshrrev_b32 v8, 3, v1
    v_mul_u32_u24 v8, 896, v8
    v_and_b32 v12, 7, v1
    v_lshl_add_u32 v8, v12, 4, v8
    s_cmp_ge_u32 s3, 784
    s_cbranch_scc1 K_q1_ru3
    s_mov_b32 s56, s52
    s_mov_b32 s57, s53
    s_mov_b32 s58, 1605632
    s_sub_u32 s3, s3, 392
    s_mul_hi_u32 s60, s3, 0x4924925
    s_mul_i32 s61, s60, 56
    s_sub_u32 s61, s3, s61
    s_mul_i32 s50, s60, 226
    s_lshl_b32 s49, s61, 1
    s_add_u32 s50, s50, s49
    s_lshl_b32 s50, s50, 10
    s_add_u32 s50, s50, 0x600000
    s_mov_b32 s51, 115712
    s_movk_i32 s52, 1024
    s_mov_b32 s53, 3
    s_branch K_q1_ru23
K_q1_ru3:
    s_mov_b32 s56, s44
    s_mov_b32 s57, s45
    s_mov_b32 s58, 401408
    s_sub_u32 s3, s3, 784
    s_mul_hi_u32 s60, s3, 0x12492493
    s_mul_i32 s61, s60, 14
    s_sub_u32 s61, s3, s61
    s_mul_i32 s50, s60, 56
    s_add_u32 s50, s50, s61
    s_lshl_b32 s50, s50, 10
    s_add_u32 s50, s50, 0x300000
    s_movk_i32 s51, 14336
    s_movk_i32 s52, 28672
    s_mov_b32 s53, 1
K_q1_ru23:
    s_mul_i32 s48, s61, 28672
    s_lshl_b32 s49, s60, 7
    s_add_u32 s48, s48, s49
    s_movk_i32 s49, 7168
K_q1_rdma:
    s_add_u32 m0, s39, 0
    s_nop 0
    buffer_load_dwordx4 v8, s[56:59], s48 offen lds
    s_add_u32 m0, s39, 1024
    s_add_u32 s48, s48, s49
    buffer_load_dwordx4 v8, s[56:59], s48 offen lds
    s_add_u32 m0, s39, 2048
    s_add_u32 s48, s48, s49
    buffer_load_dwordx4 v8, s[56:59], s48 offen lds
    s_add_u32 m0, s39, 3072
    s_add_u32 s48, s48, s49
    buffer_load_dwordx4 v8, s[56:59], s48 offen lds
    s_branch K_q1_rugo
K_q1_ru4:
    s_sub_u32 s3, s3, 882
    s_cmp_lt_u32 s3, 14
    s_cselect_b32 s56, s50, s54
    s_cselect_b32 s57, s51, s55
    s_movk_i32 s58, 896
    s_cselect_b32 s58, 3584, s58
    s_cselect_b32 s60, 0, 14
    s_movk_i32 s51, 1024
    s_cselect_b32 s51, s51, 115712
    s_mov_b32 s50, 0x61c000
    s_cselect_b32 s50, 0x400000, s50
    s_mov_b32 s61, 462848
    s_cselect_b32 s61, 118784, s61
    s_sub_u32 s3, s3, s60
    s_mul_i32 s61, s61, s3
    s_add_u32 s50, s50, s61
    s_lshl_b32 s52, s51, 1
    s_lshl_b32 s48, s3, 8
    v_lshlrev_b32 v8, 1, v1
    v_lshl_add_u32 v8, v3, 20, v8
    v_mov_b32 v128, 0
    v_mov_b32 v129, 0
    v_mov_b32 v130, 0
    v_mov_b32 v131, 0
    v_mov_b32 v132, 0
    v_mov_b32 v133, 0
    v_mov_b32 v134, 0
    v_mov_b32 v135, 0
    v_mov_b32 v136, 0
    v_mov_b32 v137, 0
    v_mov_b32 v138, 0
    v_mov_b32 v139, 0
    v_mov_b32 v140, 0
    v_mov_b32 v141, 0
    v_mov_b32 v142, 0
    v_mov_b32 v143, 0
    s_mov_b32 s53, 2
    buffer_load_ushort v128, v8, s[56:59], s48 offen offset:0
    buffer_load_ushort v132, v8, s[56:59], s48 offen offset:64
    buffer_load_ushort v136, v8, s[56:59], s48 offen offset:128
    buffer_load_ushort v140, v8, s[56:59], s48 offen offset:192
K_q1_rugo:
    s_or_b32 s3, s2, s16
    s_cbranch_scc1 K_q1_nop
    s_waitcnt vmcnt(14)
    v_add_co_u32 v144, vcc, 1, v144
    s_nop 1
    v_addc_co_u32 v145, vcc, 0, v145, vcc
    v_max_u32 v144, 1, v144
    s_mov_b32 s60, s46
    s_mov_b32 s61, s47
    s_mov_b32 s62, 0x100
    s_mov_b32 s63, 0x20000
    s_mov_b32 s38, 0x3c9000
    s_mov_b64 exec, 1
    buffer_store_dwordx2 v[144:145], off, s[60:63], 0 sc1
    buffer_store_dwordx2 v[144:145], off, s[20:23], s38 sc1
    s_mov_b64 exec, -1
K_q1_nop:
    s_cmp_eq_u32 s18, 15
    s_cbranch_scc1 K_q1_v
    s_waitcnt vmcnt(9)
    s_barrier
    ds_read_b128 v[16:19], v13 offset:0
    ds_read_b64_tr_b16 v[80:81], v11 offset:0
    ds_read_b64_tr_b16 v[82:83], v11 offset:256
    ds_read_b128 v[20:23], v14 offset:0
    ds_read_b64_tr_b16 v[84:85], v11 offset:1024
    ds_read_b64_tr_b16 v[86:87], v11 offset:1280
    ds_read_b128 v[24:27], v125 offset:0
    ds_read_b64_tr_b16 v[88:89], v11 offset:2048
    ds_read_b64_tr_b16 v[90:91], v11 offset:2304
    ds_read_b128 v[28:31], v126 offset:0
    ds_read_b64_tr_b16 v[92:93], v11 offset:3072
    ds_read_b64_tr_b16 v[94:95], v11 offset:3328
    s_waitcnt vmcnt(4) lgkmcnt(0)
    s_barrier
    v_mfma_f32_32x32x16_bf16 v[48:63], v[80:83], v[16:19], 0
    ds_read_b128 v[32:35], v13 offset:4096
    ds_read_b64_tr_b16 v[96:97], v11 offset:4096
    v_mfma_f32_32x32x16_bf16 v[64:79], v[80:83], v[120:123], 0
    ds_read_b64_tr_b16 v[98:99], v11 offset:4352
    ds_read_b128 v[36:39], v14 offset:4096
    v_mfma_f32_32x32x16_bf16 v[48:63], v[84:87], v[20:23], v[48:63]
    ds_read_b64_tr_b16 v[100:101], v11 offset:5120
    ds_read_b64_tr_b16 v[102:103], v11 offset:5376
    v_mfma_f32_32x32x16_bf16 v[64:79], v[84:87], v[120:123], v[64:79]
    ds_read_b128 v[40:43], v125 offset:4096
    ds_read_b64_tr_b16 v[104:105], v11 offset:6144
    v_mfma_f32_32x32x16_bf16 v[48:63], v[88:91], v[24:27], v[48:63]
    ds_read_b64_tr_b16 v[106:107], v11 offset:6400
    ds_read_b128 v[44:47], v126 offset:4096
    v_mfma_f32_32x32x16_bf16 v[64:79], v[88:91], v[120:123], v[64:79]
    ds_read_b64_tr_b16 v[108:109], v11 offset:7168
    ds_read_b64_tr_b16 v[110:111], v11 offset:7424
    s_add_u32 m0, s35, 8192
    s_add_u32 s34, s36, s30
    buffer_load_dwordx4 v9, s[24:27], s31 offen lds
    s_add_u32 s30, s30, 128
    s_add_u32 s31, s31, s32
    s_cmp_eq_u32 s30, 896
    s_cselect_b32 s30, 0, s30
    s_cselect_b32 s31, s33, s31
    v_mfma_f32_32x32x16_bf16 v[48:63], v[92:95], v[28:31], v[48:63]
    s_add_u32 m0, s37, 8192
    s_add_u32 s38, s34, 0
    buffer_load_dwordx4 v10, s[40:43], s38 offen lds
    v_mfma_f32_32x32x16_bf16 v[64:79], v[92:95], v[120:123], v[64:79]
    s_add_u32 m0, s37, 9216
    s_add_u32 s38, s34, 7168
    buffer_load_dwordx4 v124, s[40:43], s38 offen lds
    v_dot2c_f32_bf16 v112, v16, v120
    v_dot2c_f32_bf16 v116, v16, v16
    v_dot2c_f32_bf16 v113, v17, v120
    v_dot2c_f32_bf16 v117, v17, v17
    s_add_u32 m0, s37, 10240
    s_add_u32 s38, s34, 14336
    buffer_load_dwordx4 v10, s[40:43], s38 offen lds
    v_dot2c_f32_bf16 v114, v18, v120
    v_dot2c_f32_bf16 v118, v18, v18
    v_dot2c_f32_bf16 v115, v19, v120
    v_dot2c_f32_bf16 v119, v19, v19
    s_add_u32 m0, s37, 11264
    s_add_u32 s38, s34, 21504
    buffer_load_dwordx4 v124, s[40:43], s38 offen lds
    v_dot2c_f32_bf16 v112, v20, v120
    v_dot2c_f32_bf16 v116, v20, v20
    v_dot2c_f32_bf16 v113, v21, v120
    v_dot2c_f32_bf16 v117, v21, v21
    s_add_u32 m0, s35, 12288
    s_add_u32 s34, s36, s30
    buffer_load_dwordx4 v9, s[24:27], s31 offen lds
    s_add_u32 s30, s30, 128
    s_add_u32 s31, s31, s32
    s_cmp_eq_u32 s30, 896
    s_cselect_b32 s30, 0, s30
    s_cselect_b32 s31, s33, s31
    v_dot2c_f32_bf16 v114, v22, v120
    v_dot2c_f32_bf16 v118, v22, v22
    v_dot2c_f32_bf16 v115, v23, v120
    v_dot2c_f32_bf16 v119, v23, v23
    s_add_u32 m0, s37, 12288
    s_add_u32 s38, s34, 0
    buffer_load_dwordx4 v10, s[40:43], s38 offen lds
    v_dot2c_f32_bf16 v112, v24, v120
    v_dot2c_f32_bf16 v116, v24, v24
    v_dot2c_f32_bf16 v113, v25, v120
    v_dot2c_f32_bf16 v117, v25, v25
    s_add_u32 m0, s37, 13312
    s_add_u32 s38, s34, 7168
    buffer_load_dwordx4 v124, s[40:43], s38 offen lds
    v_dot2c_f32_bf16 v114, v26, v120
    v_dot2c_f32_bf16 v118, v26, v26
    v_dot2c_f32_bf16 v115, v27, v120
    v_dot2c_f32_bf16 v119, v27, v27
    s_add_u32 m0, s37, 14336
    s_add_u32 s38, s34, 14336
    buffer_load_dwordx4 v10, s[40:43], s38 offen lds
    v_dot2c_f32_bf16 v112, v28, v120
    v_dot2c_f32_bf16 v116, v28, v28
    v_dot2c_f32_bf16 v113, v29, v120
    v_dot2c_f32_bf16 v117, v29, v29
    s_add_u32 m0, s37, 15360
    s_add_u32 s38, s34, 21504
    buffer_load_dwordx4 v124, s[40:43], s38 offen lds
    v_dot2c_f32_bf16 v114, v30, v120
    v_dot2c_f32_bf16 v118, v30, v30
    v_dot2c_f32_bf16 v115, v31, v120
    v_dot2c_f32_bf16 v119, v31, v31
    s_waitcnt vmcnt(5) lgkmcnt(0)
    s_barrier
    v_mfma_f32_32x32x16_bf16 v[48:63], v[96:99], v[32:35], v[48:63]
    ds_read_b128 v[16:19], v13 offset:8192
    ds_read_b64_tr_b16 v[80:81], v11 offset:8192
    v_mfma_f32_32x32x16_bf16 v[64:79], v[96:99], v[120:123], v[64:79]
    ds_read_b64_tr_b16 v[82:83], v11 offset:8448
    ds_read_b128 v[20:23], v14 offset:8192
    v_mfma_f32_32x32x16_bf16 v[48:63], v[100:103], v[36:39], v[48:63]
    ds_read_b64_tr_b16 v[84:85], v11 offset:9216
    ds_read_b64_tr_b16 v[86:87], v11 offset:9472
    v_mfma_f32_32x32x16_bf16 v[64:79], v[100:103], v[120:123], v[64:79]
    ds_read_b128 v[24:27], v125 offset:8192
    ds_read_b64_tr_b16 v[88:89], v11 offset:10240
    v_mfma_f32_32x32x16_bf16 v[48:63], v[104:107], v[40:43], v[48:63]
    ds_read_b64_tr_b16 v[90:91], v11 offset:10496
    ds_read_b128 v[28:31], v126 offset:8192
    v_mfma_f32_32x32x16_bf16 v[64:79], v[104:107], v[120:123], v[64:79]
    ds_read_b64_tr_b16 v[92:93], v11 offset:11264
    ds_read_b64_tr_b16 v[94:95], v11 offset:11520
    s_add_u32 m0, s35, 16384
    s_add_u32 s34, s36, s30
    buffer_load_dwordx4 v9, s[24:27], s31 offen lds
    s_add_u32 s30, s30, 128
    s_add_u32 s31, s31, s32
    s_cmp_eq_u32 s30, 896
    s_cselect_b32 s30, 0, s30
    s_cselect_b32 s31, s33, s31
    v_mfma_f32_32x32x16_bf16 v[48:63], v[108:111], v[44:47], v[48:63]
    s_add_u32 m0, s37, 16384
    s_add_u32 s38, s34, 0
    buffer_load_dwordx4 v10, s[40:43], s38 offen lds
    v_mfma_f32_32x32x16_bf16 v[64:79], v[108:111], v[120:123], v[64:79]
    s_add_u32 m0, s37, 17408
    s_add_u32 s38, s34, 7168
    buffer_load_dwordx4 v124, s[40:43], s38 offen lds
    v_dot2c_f32_bf16 v112, v32, v120
    v_dot2c_f32_bf16 v116, v32, v32
    v_dot2c_f32_bf16 v113, v33, v120
    v_dot2c_f32_bf16 v117, v33, v33
    s_add_u32 m0, s37, 18432
    s_add_u32 s38, s34, 14336
    buffer_load_dwordx4 v10, s[40:43], s38 offen lds
    v_dot2c_f32_bf16 v114, v34, v120
    v_dot2c_f32_bf16 v118, v34, v34
    v_dot2c_f32_bf16 v115, v35, v120
    v_dot2c_f32_bf16 v119, v35, v35
    s_add_u32 m0, s37, 19456
    s_add_u32 s38, s34, 21504
    buffer_load_dwordx4 v124, s[40:43], s38 offen lds
    v_dot2c_f32_bf16 v112, v36, v120
    v_dot2c_f32_bf16 v116, v36, v36
    v_dot2c_f32_bf16 v113, v37, v120
    v_dot2c_f32_bf16 v117, v37, v37
    s_add_u32 m0, s35, 20480
    s_add_u32 s34, s36, s30
    buffer_load_dwordx4 v9, s[24:27], s31 offen lds
    s_add_u32 s30, s30, 128
    s_add_u32 s31, s31, s32
    s_cmp_eq_u32 s30, 896
    s_cselect_b32 s30, 0, s30
    s_cselect_b32 s31, s33, s31
    v_dot2c_f32_bf16 v114, v38, v120
    v_dot2c_f32_bf16 v118, v38, v38
    v_dot2c_f32_bf16 v115, v39, v120
    v_dot2c_f32_bf16 v119, v39, v39
    s_add_u32 m0, s37, 20480
    s_add_u32 s38, s34, 0
    buffer_load_dwordx4 v10, s[40:43], s38 offen lds
    v_dot2c_f32_bf16 v112, v40, v120
    v_dot2c_f32_bf16 v116, v40, v40
    v_dot2c_f32_bf16 v113, v41, v120
    v_dot2c_f32_bf16 v117, v41, v41
    s_add_u32 m0, s37, 21504
    s_add_u32 s38, s34, 7168
    buffer_load_dwordx4 v124, s[40:43], s38 offen lds
    v_dot2c_f32_bf16 v114, v42, v120
    v_dot2c_f32_bf16 v118, v42, v42
    v_dot2c_f32_bf16 v115, v43, v120
    v_dot2c_f32_bf16 v119, v43, v43
    s_add_u32 m0, s37, 22528
    s_add_u32 s38, s34, 14336
    buffer_load_dwordx4 v10, s[40:43], s38 offen lds
    v_dot2c_f32_bf16 v112, v44, v120
    v_dot2c_f32_bf16 v116, v44, v44
    v_dot2c_f32_bf16 v113, v45, v120
    v_dot2c_f32_bf16 v117, v45, v45
    s_add_u32 m0, s37, 23552
    s_add_u32 s38, s34, 21504
    buffer_load_dwordx4 v124, s[40:43], s38 offen lds
    v_dot2c_f32_bf16 v114, v46, v120
    v_dot2c_f32_bf16 v118, v46, v46
    v_dot2c_f32_bf16 v115, v47, v120
    v_dot2c_f32_bf16 v119, v47, v47
    s_waitcnt vmcnt(10) lgkmcnt(0)
    s_barrier
    v_mfma_f32_32x32x16_bf16 v[48:63], v[80:83], v[16:19], v[48:63]
    ds_read_b128 v[32:35], v13 offset:12288
    ds_read_b64_tr_b16 v[96:97], v11 offset:12288
    v_mfma_f32_32x32x16_bf16 v[64:79], v[80:83], v[120:123], v[64:79]
    ds_read_b64_tr_b16 v[98:99], v11 offset:12544
    ds_read_b128 v[36:39], v14 offset:12288
    v_mfma_f32_32x32x16_bf16 v[48:63], v[84:87], v[20:23], v[48:63]
    ds_read_b64_tr_b16 v[100:101], v11 offset:13312
    ds_read_b64_tr_b16 v[102:103], v11 offset:13568
    v_mfma_f32_32x32x16_bf16 v[64:79], v[84:87], v[120:123], v[64:79]
    ds_read_b128 v[40:43], v125 offset:12288
    ds_read_b64_tr_b16 v[104:105], v11 offset:14336
    v_mfma_f32_32x32x16_bf16 v[48:63], v[88:91], v[24:27], v[48:63]
    ds_read_b64_tr_b16 v[106:107], v11 offset:14592
    ds_read_b128 v[44:47], v126 offset:12288
    v_mfma_f32_32x32x16_bf16 v[64:79], v[88:91], v[120:123], v[64:79]
    ds_read_b64_tr_b16 v[108:109], v11 offset:15360
    ds_read_b64_tr_b16 v[110:111], v11 offset:15616
    s_add_u32 m0, s35, 24576
    s_add_u32 s34, s36, s30
    buffer_load_dwordx4 v9, s[24:27], s31 offen lds
    s_add_u32 s30, s30, 128
    s_add_u32 s31, s31, s32
    s_cmp_eq_u32 s30, 896
    s_cselect_b32 s30, 0, s30
    s_cselect_b32 s31, s33, s31
    v_mfma_f32_32x32x16_bf16 v[48:63], v[92:95], v[28:31], v[48:63]
    s_add_u32 m0, s37, 24576
    s_add_u32 s38, s34, 0
    buffer_load_dwordx4 v10, s[40:43], s38 offen lds
    v_mfma_f32_32x32x16_bf16 v[64:79], v[92:95], v[120:123], v[64:79]
    s_add_u32 m0, s37, 25600
    s_add_u32 s38, s34, 7168
    buffer_load_dwordx4 v124, s[40:43], s38 offen lds
    v_dot2c_f32_bf16 v112, v16, v120
    v_dot2c_f32_bf16 v116, v16, v16
    v_dot2c_f32_bf16 v113, v17, v120
    v_dot2c_f32_bf16 v117, v17, v17
    s_add_u32 m0, s37, 26624
    s_add_u32 s38, s34, 14336
    buffer_load_dwordx4 v10, s[40:43], s38 offen lds
    v_dot2c_f32_bf16 v114, v18, v120
    v_dot2c_f32_bf16 v118, v18, v18
    v_dot2c_f32_bf16 v115, v19, v120
    v_dot2c_f32_bf16 v119, v19, v19
    s_add_u32 m0, s37, 27648
    s_add_u32 s38, s34, 21504
    buffer_load_dwordx4 v124, s[40:43], s38 offen lds
    v_dot2c_f32_bf16 v112, v20, v120
    v_dot2c_f32_bf16 v116, v20, v20
    v_dot2c_f32_bf16 v113, v21, v120
    v_dot2c_f32_bf16 v117, v21, v21
    v_dot2c_f32_bf16 v114, v22, v120
    v_dot2c_f32_bf16 v118, v22, v22
    v_dot2c_f32_bf16 v115, v23, v120
    v_dot2c_f32_bf16 v119, v23, v23
    v_dot2c_f32_bf16 v112, v24, v120
    v_dot2c_f32_bf16 v116, v24, v24
    v_dot2c_f32_bf16 v113, v25, v120
    v_dot2c_f32_bf16 v117, v25, v25
    v_dot2c_f32_bf16 v114, v26, v120
    v_dot2c_f32_bf16 v118, v26, v26
    v_dot2c_f32_bf16 v115, v27, v120
    v_dot2c_f32_bf16 v119, v27, v27
    v_dot2c_f32_bf16 v112, v28, v120
    v_dot2c_f32_bf16 v116, v28, v28
    v_dot2c_f32_bf16 v113, v29, v120
    v_dot2c_f32_bf16 v117, v29, v29
    v_dot2c_f32_bf16 v114, v30, v120
    v_dot2c_f32_bf16 v118, v30, v30
    v_dot2c_f32_bf16 v115, v31, v120
    v_dot2c_f32_bf16 v119, v31, v31
    s_waitcnt lgkmcnt(0)
    v_lshl_or_b32 v128, v128, 16, v128
    v_lshl_or_b32 v132, v132, 16, v132
    v_lshl_or_b32 v136, v136, 16, v136
    v_lshl_or_b32 v140, v140, 16, v140
    s_cmp_eq_u32 s53, 2
    s_cbranch_scc1 K_q1_rs1
    s_cmp_eq_u32 s53, 1
    s_cbranch_scc1 K_q1_rw1
    v_mad_u32_u24 v8, v3, 4, v5
    v_lshlrev_b32 v12, 5, v7
    v_lshl_add_u32 v12, v6, 3, v12
    v_add_u32 v12, s39, v12
    s_cmp_eq_u32 s53, 3
    s_cbranch_scc1 K_q1_rx1
    v_lshl_add_u32 v8, v8, 8, v12
    ds_read_b64_tr_b16 v[128:129], v8 offset:0
    ds_read_b64_tr_b16 v[130:131], v8 offset:2048
    ds_read_b64_tr_b16 v[132:133], v8 offset:64
    ds_read_b64_tr_b16 v[134:135], v8 offset:2112
    ds_read_b64_tr_b16 v[136:137], v8 offset:128
    ds_read_b64_tr_b16 v[138:139], v8 offset:2176
    ds_read_b64_tr_b16 v[140:141], v8 offset:192
    ds_read_b64_tr_b16 v[142:143], v8 offset:2240
    s_branch K_q1_rs1
K_q1_rx1:
    v_lshl_add_u32 v8, v8, 7, v12
    ds_read_b64_tr_b16 v[128:129], v8 offset:0
    ds_read_b64_tr_b16 v[130:131], v8 offset:1024
    ds_read_b64_tr_b16 v[132:133], v8 offset:64
    ds_read_b64_tr_b16 v[134:135], v8 offset:1088
    ds_read_b64_tr_b16 v[136:137], v8 offset:2048
    ds_read_b64_tr_b16 v[138:139], v8 offset:3072
    ds_read_b64_tr_b16 v[140:141], v8 offset:2112
    ds_read_b64_tr_b16 v[142:143], v8 offset:3136
    s_branch K_q1_rs1
K_q1_rw1:
    v_lshrrev_b32 v8, 4, v1
    v_lshl_add_u32 v8, v8, 3, v5
    v_lshlrev_b32 v8, 7, v8
    v_lshl_add_u32 v8, v6, 3, v8
    v_add_u32 v8, s39, v8
    ds_read_b64_tr_b16 v[128:129], v8 offset:0
    ds_read_b64_tr_b16 v[130:131], v8 offset:512
    ds_read_b64_tr_b16 v[132:133], v8 offset:32
    ds_read_b64_tr_b16 v[134:135], v8 offset:544
    ds_read_b64_tr_b16 v[136:137], v8 offset:64
    ds_read_b64_tr_b16 v[138:139], v8 offset:576
    ds_read_b64_tr_b16 v[140:141], v8 offset:96
    ds_read_b64_tr_b16 v[142:143], v8 offset:608
K_q1_rs1:
    s_mov_b32 s56, s14
    s_mov_b32 s57, s15
    s_mov_b32 s58, 0x78b800
    s_mov_b32 s59, 0x20000
    s_add_u32 s48, s50, s51
    s_add_u32 s49, s50, s52
    s_add_u32 s51, s48, s52
    s_mov_b32 s24, s46
    s_mov_b32 s25, s47
    s_mov_b32 s26, 0x100
    s_mov_b32 s27, 0x20000
    buffer_load_dwordx2 v[150:151], off, s[24:27], 0 sc1
    s_waitcnt lgkmcnt(0)
    buffer_store_dwordx4 v[128:131], v2, s[56:59], s50 offen sc1
    buffer_store_dwordx4 v[132:135], v2, s[56:59], s48 offen sc1
    buffer_store_dwordx4 v[136:139], v2, s[56:59], s49 offen sc1
    buffer_store_dwordx4 v[140:143], v2, s[56:59], s51 offen sc1
    s_waitcnt vmcnt(15) lgkmcnt(0)
    s_barrier
    v_mfma_f32_32x32x16_bf16 v[48:63], v[96:99], v[32:35], v[48:63]
    ds_read_b128 v[16:19], v13 offset:16384
    ds_read_b64_tr_b16 v[80:81], v11 offset:16384
    v_mfma_f32_32x32x16_bf16 v[64:79], v[96:99], v[120:123], v[64:79]
    ds_read_b64_tr_b16 v[82:83], v11 offset:16640
    ds_read_b128 v[20:23], v14 offset:16384
    v_mfma_f32_32x32x16_bf16 v[48:63], v[100:103], v[36:39], v[48:63]
    ds_read_b64_tr_b16 v[84:85], v11 offset:17408
    ds_read_b64_tr_b16 v[86:87], v11 offset:17664
    v_mfma_f32_32x32x16_bf16 v[64:79], v[100:103], v[120:123], v[64:79]
    ds_read_b128 v[24:27], v125 offset:16384
    ds_read_b64_tr_b16 v[88:89], v11 offset:18432
    v_mfma_f32_32x32x16_bf16 v[48:63], v[104:107], v[40:43], v[48:63]
    ds_read_b64_tr_b16 v[90:91], v11 offset:18688
    ds_read_b128 v[28:31], v126 offset:16384
    v_mfma_f32_32x32x16_bf16 v[64:79], v[104:107], v[120:123], v[64:79]
    ds_read_b64_tr_b16 v[92:93], v11 offset:19456
    ds_read_b64_tr_b16 v[94:95], v11 offset:19712
    v_mfma_f32_32x32x16_bf16 v[48:63], v[108:111], v[44:47], v[48:63]
    v_mfma_f32_32x32x16_bf16 v[64:79], v[108:111], v[120:123], v[64:79]
    v_dot2c_f32_bf16 v112, v32, v120
    v_dot2c_f32_bf16 v116, v32, v32
    v_dot2c_f32_bf16 v113, v33, v120
    v_dot2c_f32_bf16 v117, v33, v33
    v_dot2c_f32_bf16 v114, v34, v120
    v_dot2c_f32_bf16 v118, v34, v34
    v_dot2c_f32_bf16 v115, v35, v120
    v_dot2c_f32_bf16 v119, v35, v35
    v_dot2c_f32_bf16 v112, v36, v120
    v_dot2c_f32_bf16 v116, v36, v36
    v_dot2c_f32_bf16 v113, v37, v120
    v_dot2c_f32_bf16 v117, v37, v37
    v_dot2c_f32_bf16 v114, v38, v120
    v_dot2c_f32_bf16 v118, v38, v38
    v_dot2c_f32_bf16 v115, v39, v120
    v_dot2c_f32_bf16 v119, v39, v39
    v_dot2c_f32_bf16 v112, v40, v120
    v_dot2c_f32_bf16 v116, v40, v40
    v_dot2c_f32_bf16 v113, v41, v120
    v_dot2c_f32_bf16 v117, v41, v41
    v_dot2c_f32_bf16 v114, v42, v120
    v_dot2c_f32_bf16 v118, v42, v42
    v_dot2c_f32_bf16 v115, v43, v120
    v_dot2c_f32_bf16 v119, v43, v43
    v_dot2c_f32_bf16 v112, v44, v120
    v_dot2c_f32_bf16 v116, v44, v44
    v_dot2c_f32_bf16 v113, v45, v120
    v_dot2c_f32_bf16 v117, v45, v45
    v_dot2c_f32_bf16 v114, v46, v120
    v_dot2c_f32_bf16 v118, v46, v46
    v_dot2c_f32_bf16 v115, v47, v120
    v_dot2c_f32_bf16 v119, v47, v47
    s_waitcnt vmcnt(10) lgkmcnt(0)
    s_barrier
    v_mfma_f32_32x32x16_bf16 v[48:63], v[80:83], v[16:19], v[48:63]
    ds_read_b128 v[32:35], v13 offset:20480
    ds_read_b64_tr_b16 v[96:97], v11 offset:20480
    v_mfma_f32_32x32x16_bf16 v[64:79], v[80:83], v[120:123], v[64:79]
    ds_read_b64_tr_b16 v[98:99], v11 offset:20736
    ds_read_b128 v[36:39], v14 offset:20480
    v_mfma_f32_32x32x16_bf16 v[48:63], v[84:87], v[20:23], v[48:63]
    ds_read_b64_tr_b16 v[100:101], v11 offset:21504
    ds_read_b64_tr_b16 v[102:103], v11 offset:21760
    v_mfma_f32_32x32x16_bf16 v[64:79], v[84:87], v[120:123], v[64:79]
    ds_read_b128 v[40:43], v125 offset:20480
    ds_read_b64_tr_b16 v[104:105], v11 offset:22528
    v_mfma_f32_32x32x16_bf16 v[48:63], v[88:91], v[24:27], v[48:63]
    ds_read_b64_tr_b16 v[106:107], v11 offset:22784
    ds_read_b128 v[44:47], v126 offset:20480
    v_mfma_f32_32x32x16_bf16 v[64:79], v[88:91], v[120:123], v[64:79]
    ds_read_b64_tr_b16 v[108:109], v11 offset:23552
    ds_read_b64_tr_b16 v[110:111], v11 offset:23808
    v_mfma_f32_32x32x16_bf16 v[48:63], v[92:95], v[28:31], v[48:63]
    v_mfma_f32_32x32x16_bf16 v[64:79], v[92:95], v[120:123], v[64:79]
    v_dot2c_f32_bf16 v112, v16, v120
    v_dot2c_f32_bf16 v116, v16, v16
    v_dot2c_f32_bf16 v113, v17, v120
    v_dot2c_f32_bf16 v117, v17, v17
    v_dot2c_f32_bf16 v114, v18, v120
    v_dot2c_f32_bf16 v118, v18, v18
    v_dot2c_f32_bf16 v115, v19, v120
    v_dot2c_f32_bf16 v119, v19, v19
    v_dot2c_f32_bf16 v112, v20, v120
    v_dot2c_f32_bf16 v116, v20, v20
    v_dot2c_f32_bf16 v113, v21, v120
    v_dot2c_f32_bf16 v117, v21, v21
    v_dot2c_f32_bf16 v114, v22, v120
    v_dot2c_f32_bf16 v118, v22, v22
    v_dot2c_f32_bf16 v115, v23, v120
    v_dot2c_f32_bf16 v119, v23, v23
    v_dot2c_f32_bf16 v112, v24, v120
    v_dot2c_f32_bf16 v116, v24, v24
    v_dot2c_f32_bf16 v113, v25, v120
    v_dot2c_f32_bf16 v117, v25, v25
    v_dot2c_f32_bf16 v114, v26, v120
    v_dot2c_f32_bf16 v118, v26, v26
    v_dot2c_f32_bf16 v115, v27, v120
    v_dot2c_f32_bf16 v119, v27, v27
    v_dot2c_f32_bf16 v112, v28, v120
    v_dot2c_f32_bf16 v116, v28, v28
    v_dot2c_f32_bf16 v113, v29, v120
    v_dot2c_f32_bf16 v117, v29, v29
    v_dot2c_f32_bf16 v114, v30, v120
    v_dot2c_f32_bf16 v118, v30, v30
    v_dot2c_f32_bf16 v115, v31, v120
    v_dot2c_f32_bf16 v119, v31, v31
    s_waitcnt vmcnt(5) lgkmcnt(0)
    s_barrier
    v_mfma_f32_32x32x16_bf16 v[48:63], v[96:99], v[32:35], v[48:63]
    ds_read_b128 v[16:19], v13 offset:24576
    ds_read_b64_tr_b16 v[80:81], v11 offset:24576
    v_mfma_f32_32x32x16_bf16 v[64:79], v[96:99], v[120:123], v[64:79]
    ds_read_b64_tr_b16 v[82:83], v11 offset:24832
    ds_read_b128 v[20:23], v14 offset:24576
    v_mfma_f32_32x32x16_bf16 v[48:63], v[100:103], v[36:39], v[48:63]
    ds_read_b64_tr_b16 v[84:85], v11 offset:25600
    ds_read_b64_tr_b16 v[86:87], v11 offset:25856
    v_mfma_f32_32x32x16_bf16 v[64:79], v[100:103], v[120:123], v[64:79]
    ds_read_b128 v[24:27], v125 offset:24576
    ds_read_b64_tr_b16 v[88:89], v11 offset:26624
    v_mfma_f32_32x32x16_bf16 v[48:63], v[104:107], v[40:43], v[48:63]
    ds_read_b64_tr_b16 v[90:91], v11 offset:26880
    ds_read_b128 v[28:31], v126 offset:24576
    v_mfma_f32_32x32x16_bf16 v[64:79], v[104:107], v[120:123], v[64:79]
    ds_read_b64_tr_b16 v[92:93], v11 offset:27648
    ds_read_b64_tr_b16 v[94:95], v11 offset:27904
    v_mfma_f32_32x32x16_bf16 v[48:63], v[108:111], v[44:47], v[48:63]
    v_mfma_f32_32x32x16_bf16 v[64:79], v[108:111], v[120:123], v[64:79]
    v_dot2c_f32_bf16 v112, v32, v120
    v_dot2c_f32_bf16 v116, v32, v32
    v_dot2c_f32_bf16 v113, v33, v120
    v_dot2c_f32_bf16 v117, v33, v33
    v_dot2c_f32_bf16 v114, v34, v120
    v_dot2c_f32_bf16 v118, v34, v34
    v_dot2c_f32_bf16 v115, v35, v120
    v_dot2c_f32_bf16 v119, v35, v35
    v_dot2c_f32_bf16 v112, v36, v120
    v_dot2c_f32_bf16 v116, v36, v36
    v_dot2c_f32_bf16 v113, v37, v120
    v_dot2c_f32_bf16 v117, v37, v37
    v_dot2c_f32_bf16 v114, v38, v120
    v_dot2c_f32_bf16 v118, v38, v38
    v_dot2c_f32_bf16 v115, v39, v120
    v_dot2c_f32_bf16 v119, v39, v39
    v_dot2c_f32_bf16 v112, v40, v120
    v_dot2c_f32_bf16 v116, v40, v40
    v_dot2c_f32_bf16 v113, v41, v120
    v_dot2c_f32_bf16 v117, v41, v41
    v_dot2c_f32_bf16 v114, v42, v120
    v_dot2c_f32_bf16 v118, v42, v42
    v_dot2c_f32_bf16 v115, v43, v120
    v_dot2c_f32_bf16 v119, v43, v43
    v_dot2c_f32_bf16 v112, v44, v120
    v_dot2c_f32_bf16 v116, v44, v44
    v_dot2c_f32_bf16 v113, v45, v120
    v_dot2c_f32_bf16 v117, v45, v45
    v_dot2c_f32_bf16 v114, v46, v120
    v_dot2c_f32_bf16 v118, v46, v46
    v_dot2c_f32_bf16 v115, v47, v120
    v_dot2c_f32_bf16 v119, v47, v47
    s_waitcnt lgkmcnt(0)
    v_mfma_f32_32x32x16_bf16 v[48:63], v[80:83], v[16:19], v[48:63]
    v_mfma_f32_32x32x16_bf16 v[64:79], v[80:83], v[120:123], v[64:79]
    v_mfma_f32_32x32x16_bf16 v[48:63], v[84:87], v[20:23], v[48:63]
    v_mfma_f32_32x32x16_bf16 v[64:79], v[84:87], v[120:123], v[64:79]
    v_mfma_f32_32x32x16_bf16 v[48:63], v[88:91], v[24:27], v[48:63]
    v_mfma_f32_32x32x16_bf16 v[64:79], v[88:91], v[120:123], v[64:79]
    v_mfma_f32_32x32x16_bf16 v[48:63], v[92:95], v[28:31], v[48:63]
    v_mfma_f32_32x32x16_bf16 v[64:79], v[92:95], v[120:123], v[64:79]
    v_dot2c_f32_bf16 v112, v16, v120
    v_dot2c_f32_bf16 v116, v16, v16
    v_dot2c_f32_bf16 v113, v17, v120
    v_dot2c_f32_bf16 v117, v17, v17
    v_dot2c_f32_bf16 v114, v18, v120
    v_dot2c_f32_bf16 v118, v18, v18
    v_dot2c_f32_bf16 v115, v19, v120
    v_dot2c_f32_bf16 v119, v19, v19
    v_dot2c_f32_bf16 v112, v20, v120
    v_dot2c_f32_bf16 v116, v20, v20
    v_dot2c_f32_bf16 v113, v21, v120
    v_dot2c_f32_bf16 v117, v21, v21
    v_dot2c_f32_bf16 v114, v22, v120
    v_dot2c_f32_bf16 v118, v22, v22
    v_dot2c_f32_bf16 v115, v23, v120
    v_dot2c_f32_bf16 v119, v23, v23
    v_dot2c_f32_bf16 v112, v24, v120
    v_dot2c_f32_bf16 v116, v24, v24
    v_dot2c_f32_bf16 v113, v25, v120
    v_dot2c_f32_bf16 v117, v25, v25
    v_dot2c_f32_bf16 v114, v26, v120
    v_dot2c_f32_bf16 v118, v26, v26
    v_dot2c_f32_bf16 v115, v27, v120
    v_dot2c_f32_bf16 v119, v27, v27
    v_dot2c_f32_bf16 v112, v28, v120
    v_dot2c_f32_bf16 v116, v28, v28
    v_dot2c_f32_bf16 v113, v29, v120
    v_dot2c_f32_bf16 v117, v29, v29
    v_dot2c_f32_bf16 v114, v30, v120
    v_dot2c_f32_bf16 v118, v30, v30
    v_dot2c_f32_bf16 v115, v31, v120
    v_dot2c_f32_bf16 v119, v31, v31
    s_nop 2
    v_add_f32 v12, v112, v113
    v_add_f32 v14, v114, v115
    v_add_f32 v13, v116, v117
    v_add_f32 v10, v118, v119
    v_add_f32 v12, v12, v14
    v_add_f32 v13, v13, v10
    v_mov_b32 v14, v12
    v_mov_b32 v10, v13
    s_nop 1
    v_permlane32_swap_b32 v12, v14
    v_permlane32_swap_b32 v13, v10
    v_add_f32 v12, v12, v14
    v_add_f32 v13, v13, v10
    v_mul_f32 v12, 0x3b124925, v12
    v_mul_f32 v13, 0x3b124925, v13
    v_fma_f32 v13, -v12, v12, v13
    v_max_f32 v13, 0, v13
    v_add_f32 v13, 0x3727c5ac, v13
    v_rsq_f32 v13, v13
    s_lshl_b32 s30, s17, 2
    s_add_u32 s30, s30, s16
    s_lshl_b32 s30, s30, 12
    s_cmp_eq_u32 s18, 14
    s_cselect_b32 s37, 1.0, 0x3e8b97f6
    s_cselect_b64 s[40:41], s[28:29], 0
    v_mul_f32 v13, s37, v13
    s_lshl_b32 s38, s18, 11
    s_add_u32 s38, s38, s36
    s_add_u32 s38, s38, 0x0
    s_add_u32 s39, s30, 0x200000
    s_cmp_eq_u32 s18, 14
    s_cselect_b32 s38, s39, s38
    v_mul_f32_e64 v14, -v12, v13
    v_mov_b32 v12, v13
    v_mov_b32 v15, v14
    v_pk_mul_f32 v[48:49], v[48:49], v[12:13]
    v_pk_mul_f32 v[50:51], v[50:51], v[12:13]
    v_pk_mul_f32 v[52:53], v[52:53], v[12:13]
    v_pk_mul_f32 v[54:55], v[54:55], v[12:13]
    v_pk_mul_f32 v[56:57], v[56:57], v[12:13]
    v_pk_mul_f32 v[58:59], v[58:59], v[12:13]
    v_pk_mul_f32 v[60:61], v[60:61], v[12:13]
    v_pk_mul_f32 v[62:63], v[62:63], v[12:13]
    v_pk_fma_f32 v[48:49], v[64:65], v[14:15], v[48:49]
    v_pk_fma_f32 v[50:51], v[66:67], v[14:15], v[50:51]
    v_pk_fma_f32 v[52:53], v[68:69], v[14:15], v[52:53]
    v_pk_fma_f32 v[54:55], v[70:71], v[14:15], v[54:55]
    v_pk_fma_f32 v[56:57], v[72:73], v[14:15], v[56:57]
    v_pk_fma_f32 v[58:59], v[74:75], v[14:15], v[58:59]
    v_pk_fma_f32 v[60:61], v[76:77], v[14:15], v[60:61]
    v_pk_fma_f32 v[62:63], v[78:79], v[14:15], v[62:63]
    v_cvt_pk_bf16_f32 v64, v48, v49
    v_cvt_pk_bf16_f32 v65, v50, v51
    v_cvt_pk_bf16_f32 v66, v52, v53
    v_cvt_pk_bf16_f32 v67, v54, v55
    v_cvt_pk_bf16_f32 v68, v56, v57
    v_cvt_pk_bf16_f32 v69, v58, v59
    v_cvt_pk_bf16_f32 v70, v60, v61
    v_cvt_pk_bf16_f32 v71, v62, v63
    v_mov_b32 v10, 0
    v_cndmask_b32 v70, v70, v120, s[40:41]
    v_cndmask_b32 v71, v71, v10, s[40:41]
    s_branch K_q1_st
K_q1_v:
    s_waitcnt vmcnt(9)
    s_barrier
    ds_read_b128 v[16:19], v13 offset:0
    ds_read_b64_tr_b16 v[80:81], v11 offset:0
    ds_read_b64_tr_b16 v[82:83], v11 offset:256
    ds_read_b128 v[20:23], v14 offset:0
    ds_read_b64_tr_b16 v[84:85], v11 offset:1024
    ds_read_b64_tr_b16 v[86:87], v11 offset:1280
    ds_read_b128 v[24:27], v125 offset:0
    ds_read_b64_tr_b16 v[88:89], v11 offset:2048
    ds_read_b64_tr_b16 v[90:91], v11 offset:2304
    ds_read_b128 v[28:31], v126 offset:0
    ds_read_b64_tr_b16 v[92:93], v11 offset:3072
    ds_read_b64_tr_b16 v[94:95], v11 offset:3328
    s_waitcnt vmcnt(4) lgkmcnt(0)
    s_barrier
    v_mfma_f32_32x32x16_bf16 v[48:63], v[16:19], v[80:83], 0
    ds_read_b128 v[32:35], v13 offset:4096
    ds_read_b64_tr_b16 v[96:97], v11 offset:4096
    v_mfma_f32_32x32x16_bf16 v[64:79], v[120:123], v[80:83], 0
    ds_read_b64_tr_b16 v[98:99], v11 offset:4352
    ds_read_b128 v[36:39], v14 offset:4096
    v_mfma_f32_32x32x16_bf16 v[48:63], v[20:23], v[84:87], v[48:63]
    ds_read_b64_tr_b16 v[100:101], v11 offset:5120
    ds_read_b64_tr_b16 v[102:103], v11 offset:5376
    v_mfma_f32_32x32x16_bf16 v[64:79], v[120:123], v[84:87], v[64:79]
    ds_read_b128 v[40:43], v125 offset:4096
    ds_read_b64_tr_b16 v[104:105], v11 offset:6144
    v_mfma_f32_32x32x16_bf16 v[48:63], v[24:27], v[88:91], v[48:63]
    ds_read_b64_tr_b16 v[106:107], v11 offset:6400
    ds_read_b128 v[44:47], v126 offset:4096
    v_mfma_f32_32x32x16_bf16 v[64:79], v[120:123], v[88:91], v[64:79]
    ds_read_b64_tr_b16 v[108:109], v11 offset:7168
    ds_read_b64_tr_b16 v[110:111], v11 offset:7424
    s_add_u32 m0, s35, 8192
    s_add_u32 s34, s36, s30
    buffer_load_dwordx4 v9, s[24:27], s31 offen lds
    s_add_u32 s30, s30, 128
    s_add_u32 s31, s31, s32
    s_cmp_eq_u32 s30, 896
    s_cselect_b32 s30, 0, s30
    s_cselect_b32 s31, s33, s31
    v_mfma_f32_32x32x16_bf16 v[48:63], v[28:31], v[92:95], v[48:63]
    s_add_u32 m0, s37, 8192
    s_add_u32 s38, s34, 0
    buffer_load_dwordx4 v10, s[40:43], s38 offen lds
    v_mfma_f32_32x32x16_bf16 v[64:79], v[120:123], v[92:95], v[64:79]
    s_add_u32 m0, s37, 9216
    s_add_u32 s38, s34, 7168
    buffer_load_dwordx4 v124, s[40:43], s38 offen lds
    v_dot2c_f32_bf16 v112, v16, v120
    v_dot2c_f32_bf16 v116, v16, v16
    v_dot2c_f32_bf16 v113, v17, v120
    v_dot2c_f32_bf16 v117, v17, v17
    s_add_u32 m0, s37, 10240
    s_add_u32 s38, s34, 14336
    buffer_load_dwordx4 v10, s[40:43], s38 offen lds
    v_dot2c_f32_bf16 v114, v18, v120
    v_dot2c_f32_bf16 v118, v18, v18
    v_dot2c_f32_bf16 v115, v19, v120
    v_dot2c_f32_bf16 v119, v19, v19
    s_add_u32 m0, s37, 11264
    s_add_u32 s38, s34, 21504
    buffer_load_dwordx4 v124, s[40:43], s38 offen lds
    v_dot2c_f32_bf16 v112, v20, v120
    v_dot2c_f32_bf16 v116, v20, v20
    v_dot2c_f32_bf16 v113, v21, v120
    v_dot2c_f32_bf16 v117, v21, v21
    s_add_u32 m0, s35, 12288
    s_add_u32 s34, s36, s30
    buffer_load_dwordx4 v9, s[24:27], s31 offen lds
    s_add_u32 s30, s30, 128
    s_add_u32 s31, s31, s32
    s_cmp_eq_u32 s30, 896
    s_cselect_b32 s30, 0, s30
    s_cselect_b32 s31, s33, s31
    v_dot2c_f32_bf16 v114, v22, v120
    v_dot2c_f32_bf16 v118, v22, v22
    v_dot2c_f32_bf16 v115, v23, v120
    v_dot2c_f32_bf16 v119, v23, v23
    s_add_u32 m0, s37, 12288
    s_add_u32 s38, s34, 0
    buffer_load_dwordx4 v10, s[40:43], s38 offen lds
    v_dot2c_f32_bf16 v112, v24, v120
    v_dot2c_f32_bf16 v116, v24, v24
    v_dot2c_f32_bf16 v113, v25, v120
    v_dot2c_f32_bf16 v117, v25, v25
    s_add_u32 m0, s37, 13312
    s_add_u32 s38, s34, 7168
    buffer_load_dwordx4 v124, s[40:43], s38 offen lds
    v_dot2c_f32_bf16 v114, v26, v120
    v_dot2c_f32_bf16 v118, v26, v26
    v_dot2c_f32_bf16 v115, v27, v120
    v_dot2c_f32_bf16 v119, v27, v27
    s_add_u32 m0, s37, 14336
    s_add_u32 s38, s34, 14336
    buffer_load_dwordx4 v10, s[40:43], s38 offen lds
    v_dot2c_f32_bf16 v112, v28, v120
    v_dot2c_f32_bf16 v116, v28, v28
    v_dot2c_f32_bf16 v113, v29, v120
    v_dot2c_f32_bf16 v117, v29, v29
    s_add_u32 m0, s37, 15360
    s_add_u32 s38, s34, 21504
    buffer_load_dwordx4 v124, s[40:43], s38 offen lds
    v_dot2c_f32_bf16 v114, v30, v120
    v_dot2c_f32_bf16 v118, v30, v30
    v_dot2c_f32_bf16 v115, v31, v120
    v_dot2c_f32_bf16 v119, v31, v31
    s_waitcnt vmcnt(5) lgkmcnt(0)
    s_barrier
    v_mfma_f32_32x32x16_bf16 v[48:63], v[32:35], v[96:99], v[48:63]
    ds_read_b128 v[16:19], v13 offset:8192
    ds_read_b64_tr_b16 v[80:81], v11 offset:8192
    v_mfma_f32_32x32x16_bf16 v[64:79], v[120:123], v[96:99], v[64:79]
    ds_read_b64_tr_b16 v[82:83], v11 offset:8448
    ds_read_b128 v[20:23], v14 offset:8192
    v_mfma_f32_32x32x16_bf16 v[48:63], v[36:39], v[100:103], v[48:63]
    ds_read_b64_tr_b16 v[84:85], v11 offset:9216
    ds_read_b64_tr_b16 v[86:87], v11 offset:9472
    v_mfma_f32_32x32x16_bf16 v[64:79], v[120:123], v[100:103], v[64:79]
    ds_read_b128 v[24:27], v125 offset:8192
    ds_read_b64_tr_b16 v[88:89], v11 offset:10240
    v_mfma_f32_32x32x16_bf16 v[48:63], v[40:43], v[104:107], v[48:63]
    ds_read_b64_tr_b16 v[90:91], v11 offset:10496
    ds_read_b128 v[28:31], v126 offset:8192
    v_mfma_f32_32x32x16_bf16 v[64:79], v[120:123], v[104:107], v[64:79]
    ds_read_b64_tr_b16 v[92:93], v11 offset:11264
    ds_read_b64_tr_b16 v[94:95], v11 offset:11520
    s_add_u32 m0, s35, 16384
    s_add_u32 s34, s36, s30
    buffer_load_dwordx4 v9, s[24:27], s31 offen lds
    s_add_u32 s30, s30, 128
    s_add_u32 s31, s31, s32
    s_cmp_eq_u32 s30, 896
    s_cselect_b32 s30, 0, s30
    s_cselect_b32 s31, s33, s31
    v_mfma_f32_32x32x16_bf16 v[48:63], v[44:47], v[108:111], v[48:63]
    s_add_u32 m0, s37, 16384
    s_add_u32 s38, s34, 0
    buffer_load_dwordx4 v10, s[40:43], s38 offen lds
    v_mfma_f32_32x32x16_bf16 v[64:79], v[120:123], v[108:111], v[64:79]
    s_add_u32 m0, s37, 17408
    s_add_u32 s38, s34, 7168
    buffer_load_dwordx4 v124, s[40:43], s38 offen lds
    v_dot2c_f32_bf16 v112, v32, v120
    v_dot2c_f32_bf16 v116, v32, v32
    v_dot2c_f32_bf16 v113, v33, v120
    v_dot2c_f32_bf16 v117, v33, v33
    s_add_u32 m0, s37, 18432
    s_add_u32 s38, s34, 14336
    buffer_load_dwordx4 v10, s[40:43], s38 offen lds
    v_dot2c_f32_bf16 v114, v34, v120
    v_dot2c_f32_bf16 v118, v34, v34
    v_dot2c_f32_bf16 v115, v35, v120
    v_dot2c_f32_bf16 v119, v35, v35
    s_add_u32 m0, s37, 19456
    s_add_u32 s38, s34, 21504
    buffer_load_dwordx4 v124, s[40:43], s38 offen lds
    v_dot2c_f32_bf16 v112, v36, v120
    v_dot2c_f32_bf16 v116, v36, v36
    v_dot2c_f32_bf16 v113, v37, v120
    v_dot2c_f32_bf16 v117, v37, v37
    s_add_u32 m0, s35, 20480
    s_add_u32 s34, s36, s30
    buffer_load_dwordx4 v9, s[24:27], s31 offen lds
    s_add_u32 s30, s30, 128
    s_add_u32 s31, s31, s32
    s_cmp_eq_u32 s30, 896
    s_cselect_b32 s30, 0, s30
    s_cselect_b32 s31, s33, s31
    v_dot2c_f32_bf16 v114, v38, v120
    v_dot2c_f32_bf16 v118, v38, v38
    v_dot2c_f32_bf16 v115, v39, v120
    v_dot2c_f32_bf16 v119, v39, v39
    s_add_u32 m0, s37, 20480
    s_add_u32 s38, s34, 0
    buffer_load_dwordx4 v10, s[40:43], s38 offen lds
    v_dot2c_f32_bf16 v112, v40, v120
    v_dot2c_f32_bf16 v116, v40, v40
    v_dot2c_f32_bf16 v113, v41, v120
    v_dot2c_f32_bf16 v117, v41, v41
    s_add_u32 m0, s37, 21504
    s_add_u32 s38, s34, 7168
    buffer_load_dwordx4 v124, s[40:43], s38 offen lds
    v_dot2c_f32_bf16 v114, v42, v120
    v_dot2c_f32_bf16 v118, v42, v42
    v_dot2c_f32_bf16 v115, v43, v120
    v_dot2c_f32_bf16 v119, v43, v43
    s_add_u32 m0, s37, 22528
    s_add_u32 s38, s34, 14336
    buffer_load_dwordx4 v10, s[40:43], s38 offen lds
    v_dot2c_f32_bf16 v112, v44, v120
    v_dot2c_f32_bf16 v116, v44, v44
    v_dot2c_f32_bf16 v113, v45, v120
    v_dot2c_f32_bf16 v117, v45, v45
    s_add_u32 m0, s37, 23552
    s_add_u32 s38, s34, 21504
    buffer_load_dwordx4 v124, s[40:43], s38 offen lds
    v_dot2c_f32_bf16 v114, v46, v120
    v_dot2c_f32_bf16 v118, v46, v46
    v_dot2c_f32_bf16 v115, v47, v120
    v_dot2c_f32_bf16 v119, v47, v47
    s_waitcnt vmcnt(10) lgkmcnt(0)
    s_barrier
    v_mfma_f32_32x32x16_bf16 v[48:63], v[16:19], v[80:83], v[48:63]
    ds_read_b128 v[32:35], v13 offset:12288
    ds_read_b64_tr_b16 v[96:97], v11 offset:12288
    v_mfma_f32_32x32x16_bf16 v[64:79], v[120:123], v[80:83], v[64:79]
    ds_read_b64_tr_b16 v[98:99], v11 offset:12544
    ds_read_b128 v[36:39], v14 offset:12288
    v_mfma_f32_32x32x16_bf16 v[48:63], v[20:23], v[84:87], v[48:63]
    ds_read_b64_tr_b16 v[100:101], v11 offset:13312
    ds_read_b64_tr_b16 v[102:103], v11 offset:13568
    v_mfma_f32_32x32x16_bf16 v[64:79], v[120:123], v[84:87], v[64:79]
    ds_read_b128 v[40:43], v125 offset:12288
    ds_read_b64_tr_b16 v[104:105], v11 offset:14336
    v_mfma_f32_32x32x16_bf16 v[48:63], v[24:27], v[88:91], v[48:63]
    ds_read_b64_tr_b16 v[106:107], v11 offset:14592
    ds_read_b128 v[44:47], v126 offset:12288
    v_mfma_f32_32x32x16_bf16 v[64:79], v[120:123], v[88:91], v[64:79]
    ds_read_b64_tr_b16 v[108:109], v11 offset:15360
    ds_read_b64_tr_b16 v[110:111], v11 offset:15616
    s_add_u32 m0, s35, 24576
    s_add_u32 s34, s36, s30
    buffer_load_dwordx4 v9, s[24:27], s31 offen lds
    s_add_u32 s30, s30, 128
    s_add_u32 s31, s31, s32
    s_cmp_eq_u32 s30, 896
    s_cselect_b32 s30, 0, s30
    s_cselect_b32 s31, s33, s31
    v_mfma_f32_32x32x16_bf16 v[48:63], v[28:31], v[92:95], v[48:63]
    s_add_u32 m0, s37, 24576
    s_add_u32 s38, s34, 0
    buffer_load_dwordx4 v10, s[40:43], s38 offen lds
    v_mfma_f32_32x32x16_bf16 v[64:79], v[120:123], v[92:95], v[64:79]
    s_add_u32 m0, s37, 25600
    s_add_u32 s38, s34, 7168
    buffer_load_dwordx4 v124, s[40:43], s38 offen lds
    v_dot2c_f32_bf16 v112, v16, v120
    v_dot2c_f32_bf16 v116, v16, v16
    v_dot2c_f32_bf16 v113, v17, v120
    v_dot2c_f32_bf16 v117, v17, v17
    s_add_u32 m0, s37, 26624
    s_add_u32 s38, s34, 14336
    buffer_load_dwordx4 v10, s[40:43], s38 offen lds
    v_dot2c_f32_bf16 v114, v18, v120
    v_dot2c_f32_bf16 v118, v18, v18
    v_dot2c_f32_bf16 v115, v19, v120
    v_dot2c_f32_bf16 v119, v19, v19
    s_add_u32 m0, s37, 27648
    s_add_u32 s38, s34, 21504
    buffer_load_dwordx4 v124, s[40:43], s38 offen lds
    v_dot2c_f32_bf16 v112, v20, v120
    v_dot2c_f32_bf16 v116, v20, v20
    v_dot2c_f32_bf16 v113, v21, v120
    v_dot2c_f32_bf16 v117, v21, v21
    v_dot2c_f32_bf16 v114, v22, v120
    v_dot2c_f32_bf16 v118, v22, v22
    v_dot2c_f32_bf16 v115, v23, v120
    v_dot2c_f32_bf16 v119, v23, v23
    v_dot2c_f32_bf16 v112, v24, v120
    v_dot2c_f32_bf16 v116, v24, v24
    v_dot2c_f32_bf16 v113, v25, v120
    v_dot2c_f32_bf16 v117, v25, v25
    v_dot2c_f32_bf16 v114, v26, v120
    v_dot2c_f32_bf16 v118, v26, v26
    v_dot2c_f32_bf16 v115, v27, v120
    v_dot2c_f32_bf16 v119, v27, v27
    v_dot2c_f32_bf16 v112, v28, v120
    v_dot2c_f32_bf16 v116, v28, v28
    v_dot2c_f32_bf16 v113, v29, v120
    v_dot2c_f32_bf16 v117, v29, v29
    v_dot2c_f32_bf16 v114, v30, v120
    v_dot2c_f32_bf16 v118, v30, v30
    v_dot2c_f32_bf16 v115, v31, v120
    v_dot2c_f32_bf16 v119, v31, v31
    s_waitcnt lgkmcnt(0)
    v_lshl_or_b32 v128, v128, 16, v128
    v_lshl_or_b32 v132, v132, 16, v132
    v_lshl_or_b32 v136, v136, 16, v136
    v_lshl_or_b32 v140, v140, 16, v140
    s_cmp_eq_u32 s53, 2
    s_cbranch_scc1 K_q1_rs2
    s_cmp_eq_u32 s53, 1
    s_cbranch_scc1 K_q1_rw2
    v_mad_u32_u24 v8, v3, 4, v5
    v_lshlrev_b32 v12, 5, v7
    v_lshl_add_u32 v12, v6, 3, v12
    v_add_u32 v12, s39, v12
    s_cmp_eq_u32 s53, 3
    s_cbranch_scc1 K_q1_rx2
    v_lshl_add_u32 v8, v8, 8, v12
    ds_read_b64_tr_b16 v[128:129], v8 offset:0
    ds_read_b64_tr_b16 v[130:131], v8 offset:2048
    ds_read_b64_tr_b16 v[132:133], v8 offset:64
    ds_read_b64_tr_b16 v[134:135], v8 offset:2112
    ds_read_b64_tr_b16 v[136:137], v8 offset:128
    ds_read_b64_tr_b16 v[138:139], v8 offset:2176
    ds_read_b64_tr_b16 v[140:141], v8 offset:192
    ds_read_b64_tr_b16 v[142:143], v8 offset:2240
    s_branch K_q1_rs2
K_q1_rx2:
    v_lshl_add_u32 v8, v8, 7, v12
    ds_read_b64_tr_b16 v[128:129], v8 offset:0
    ds_read_b64_tr_b16 v[130:131], v8 offset:1024
    ds_read_b64_tr_b16 v[132:133], v8 offset:64
    ds_read_b64_tr_b16 v[134:135], v8 offset:1088
    ds_read_b64_tr_b16 v[136:137], v8 offset:2048
    ds_read_b64_tr_b16 v[138:139], v8 offset:3072
    ds_read_b64_tr_b16 v[140:141], v8 offset:2112
    ds_read_b64_tr_b16 v[142:143], v8 offset:3136
    s_branch K_q1_rs2
K_q1_rw2:
    v_lshrrev_b32 v8, 4, v1
    v_lshl_add_u32 v8, v8, 3, v5
    v_lshlrev_b32 v8, 7, v8
    v_lshl_add_u32 v8, v6, 3, v8
    v_add_u32 v8, s39, v8
    ds_read_b64_tr_b16 v[128:129], v8 offset:0
    ds_read_b64_tr_b16 v[130:131], v8 offset:512
    ds_read_b64_tr_b16 v[132:133], v8 offset:32
    ds_read_b64_tr_b16 v[134:135], v8 offset:544
    ds_read_b64_tr_b16 v[136:137], v8 offset:64
    ds_read_b64_tr_b16 v[138:139], v8 offset:576
    ds_read_b64_tr_b16 v[140:141], v8 offset:96
    ds_read_b64_tr_b16 v[142:143], v8 offset:608
K_q1_rs2:
    s_mov_b32 s56, s14
    s_mov_b32 s57, s15
    s_mov_b32 s58, 0x78b800
    s_mov_b32 s59, 0x20000
    s_add_u32 s48, s50, s51
    s_add_u32 s49, s50, s52
    s_add_u32 s51, s48, s52
    s_mov_b32 s24, s46
    s_mov_b32 s25, s47
    s_mov_b32 s26, 0x100
    s_mov_b32 s27, 0x20000
    buffer_load_dwordx2 v[150:151], off, s[24:27], 0 sc1
    s_waitcnt lgkmcnt(0)
    buffer_store_dwordx4 v[128:131], v2, s[56:59], s50 offen sc1
    buffer_store_dwordx4 v[132:135], v2, s[56:59], s48 offen sc1
    buffer_store_dwordx4 v[136:139], v2, s[56:59], s49 offen sc1
    buffer_store_dwordx4 v[140:143], v2, s[56:59], s51 offen sc1
    s_waitcnt vmcnt(15) lgkmcnt(0)
    s_barrier
    v_mfma_f32_32x32x16_bf16 v[48:63], v[32:35], v[96:99], v[48:63]
    ds_read_b128 v[16:19], v13 offset:16384
    ds_read_b64_tr_b16 v[80:81], v11 offset:16384
    v_mfma_f32_32x32x16_bf16 v[64:79], v[120:123], v[96:99], v[64:79]
    ds_read_b64_tr_b16 v[82:83], v11 offset:16640
    ds_read_b128 v[20:23], v14 offset:16384
    v_mfma_f32_32x32x16_bf16 v[48:63], v[36:39], v[100:103], v[48:63]
    ds_read_b64_tr_b16 v[84:85], v11 offset:17408
    ds_read_b64_tr_b16 v[86:87], v11 offset:17664
    v_mfma_f32_32x32x16_bf16 v[64:79], v[120:123], v[100:103], v[64:79]
    ds_read_b128 v[24:27], v125 offset:16384
    ds_read_b64_tr_b16 v[88:89], v11 offset:18432
    v_mfma_f32_32x32x16_bf16 v[48:63], v[40:43], v[104:107], v[48:63]
    ds_read_b64_tr_b16 v[90:91], v11 offset:18688
    ds_read_b128 v[28:31], v126 offset:16384
    v_mfma_f32_32x32x16_bf16 v[64:79], v[120:123], v[104:107], v[64:79]
    ds_read_b64_tr_b16 v[92:93], v11 offset:19456
    ds_read_b64_tr_b16 v[94:95], v11 offset:19712
    v_mfma_f32_32x32x16_bf16 v[48:63], v[44:47], v[108:111], v[48:63]
    v_mfma_f32_32x32x16_bf16 v[64:79], v[120:123], v[108:111], v[64:79]
    v_dot2c_f32_bf16 v112, v32, v120
    v_dot2c_f32_bf16 v116, v32, v32
    v_dot2c_f32_bf16 v113, v33, v120
    v_dot2c_f32_bf16 v117, v33, v33
    v_dot2c_f32_bf16 v114, v34, v120
    v_dot2c_f32_bf16 v118, v34, v34
    v_dot2c_f32_bf16 v115, v35, v120
    v_dot2c_f32_bf16 v119, v35, v35
    v_dot2c_f32_bf16 v112, v36, v120
    v_dot2c_f32_bf16 v116, v36, v36
    v_dot2c_f32_bf16 v113, v37, v120
    v_dot2c_f32_bf16 v117, v37, v37
    v_dot2c_f32_bf16 v114, v38, v120
    v_dot2c_f32_bf16 v118, v38, v38
    v_dot2c_f32_bf16 v115, v39, v120
    v_dot2c_f32_bf16 v119, v39, v39
    v_dot2c_f32_bf16 v112, v40, v120
    v_dot2c_f32_bf16 v116, v40, v40
    v_dot2c_f32_bf16 v113, v41, v120
    v_dot2c_f32_bf16 v117, v41, v41
    v_dot2c_f32_bf16 v114, v42, v120
    v_dot2c_f32_bf16 v118, v42, v42
    v_dot2c_f32_bf16 v115, v43, v120
    v_dot2c_f32_bf16 v119, v43, v43
    v_dot2c_f32_bf16 v112, v44, v120
    v_dot2c_f32_bf16 v116, v44, v44
    v_dot2c_f32_bf16 v113, v45, v120
    v_dot2c_f32_bf16 v117, v45, v45
    v_dot2c_f32_bf16 v114, v46, v120
    v_dot2c_f32_bf16 v118, v46, v46
    v_dot2c_f32_bf16 v115, v47, v120
    v_dot2c_f32_bf16 v119, v47, v47
    s_waitcnt vmcnt(10) lgkmcnt(0)
    s_barrier
    v_mfma_f32_32x32x16_bf16 v[48:63], v[16:19], v[80:83], v[48:63]
    ds_read_b128 v[32:35], v13 offset:20480
    ds_read_b64_tr_b16 v[96:97], v11 offset:20480
    v_mfma_f32_32x32x16_bf16 v[64:79], v[120:123], v[80:83], v[64:79]
    ds_read_b64_tr_b16 v[98:99], v11 offset:20736
    ds_read_b128 v[36:39], v14 offset:20480
    v_mfma_f32_32x32x16_bf16 v[48:63], v[20:23], v[84:87], v[48:63]
    ds_read_b64_tr_b16 v[100:101], v11 offset:21504
    ds_read_b64_tr_b16 v[102:103], v11 offset:21760
    v_mfma_f32_32x32x16_bf16 v[64:79], v[120:123], v[84:87], v[64:79]
    ds_read_b128 v[40:43], v125 offset:20480
    ds_read_b64_tr_b16 v[104:105], v11 offset:22528
    v_mfma_f32_32x32x16_bf16 v[48:63], v[24:27], v[88:91], v[48:63]
    ds_read_b64_tr_b16 v[106:107], v11 offset:22784
    ds_read_b128 v[44:47], v126 offset:20480
    v_mfma_f32_32x32x16_bf16 v[64:79], v[120:123], v[88:91], v[64:79]
    ds_read_b64_tr_b16 v[108:109], v11 offset:23552
    ds_read_b64_tr_b16 v[110:111], v11 offset:23808
    v_mfma_f32_32x32x16_bf16 v[48:63], v[28:31], v[92:95], v[48:63]
    v_mfma_f32_32x32x16_bf16 v[64:79], v[120:123], v[92:95], v[64:79]
    v_dot2c_f32_bf16 v112, v16, v120
    v_dot2c_f32_bf16 v116, v16, v16
    v_dot2c_f32_bf16 v113, v17, v120
    v_dot2c_f32_bf16 v117, v17, v17
    v_dot2c_f32_bf16 v114, v18, v120
    v_dot2c_f32_bf16 v118, v18, v18
    v_dot2c_f32_bf16 v115, v19, v120
    v_dot2c_f32_bf16 v119, v19, v19
    v_dot2c_f32_bf16 v112, v20, v120
    v_dot2c_f32_bf16 v116, v20, v20
    v_dot2c_f32_bf16 v113, v21, v120
    v_dot2c_f32_bf16 v117, v21, v21
    v_dot2c_f32_bf16 v114, v22, v120
    v_dot2c_f32_bf16 v118, v22, v22
    v_dot2c_f32_bf16 v115, v23, v120
    v_dot2c_f32_bf16 v119, v23, v23
    v_dot2c_f32_bf16 v112, v24, v120
    v_dot2c_f32_bf16 v116, v24, v24
    v_dot2c_f32_bf16 v113, v25, v120
    v_dot2c_f32_bf16 v117, v25, v25
    v_dot2c_f32_bf16 v114, v26, v120
    v_dot2c_f32_bf16 v118, v26, v26
    v_dot2c_f32_bf16 v115, v27, v120
    v_dot2c_f32_bf16 v119, v27, v27
    v_dot2c_f32_bf16 v112, v28, v120
    v_dot2c_f32_bf16 v116, v28, v28
    v_dot2c_f32_bf16 v113, v29, v120
    v_dot2c_f32_bf16 v117, v29, v29
    v_dot2c_f32_bf16 v114, v30, v120
    v_dot2c_f32_bf16 v118, v30, v30
    v_dot2c_f32_bf16 v115, v31, v120
    v_dot2c_f32_bf16 v119, v31, v31
    s_waitcnt vmcnt(5) lgkmcnt(0)
    s_barrier
    v_mfma_f32_32x32x16_bf16 v[48:63], v[32:35], v[96:99], v[48:63]
    ds_read_b128 v[16:19], v13 offset:24576
    ds_read_b64_tr_b16 v[80:81], v11 offset:24576
    v_mfma_f32_32x32x16_bf16 v[64:79], v[120:123], v[96:99], v[64:79]
    ds_read_b64_tr_b16 v[82:83], v11 offset:24832
    ds_read_b128 v[20:23], v14 offset:24576
    v_mfma_f32_32x32x16_bf16 v[48:63], v[36:39], v[100:103], v[48:63]
    ds_read_b64_tr_b16 v[84:85], v11 offset:25600
    ds_read_b64_tr_b16 v[86:87], v11 offset:25856
    v_mfma_f32_32x32x16_bf16 v[64:79], v[120:123], v[100:103], v[64:79]
    ds_read_b128 v[24:27], v125 offset:24576
    ds_read_b64_tr_b16 v[88:89], v11 offset:26624
    v_mfma_f32_32x32x16_bf16 v[48:63], v[40:43], v[104:107], v[48:63]
    ds_read_b64_tr_b16 v[90:91], v11 offset:26880
    ds_read_b128 v[28:31], v126 offset:24576
    v_mfma_f32_32x32x16_bf16 v[64:79], v[120:123], v[104:107], v[64:79]
    ds_read_b64_tr_b16 v[92:93], v11 offset:27648
    ds_read_b64_tr_b16 v[94:95], v11 offset:27904
    v_mfma_f32_32x32x16_bf16 v[48:63], v[44:47], v[108:111], v[48:63]
    v_mfma_f32_32x32x16_bf16 v[64:79], v[120:123], v[108:111], v[64:79]
    v_dot2c_f32_bf16 v112, v32, v120
    v_dot2c_f32_bf16 v116, v32, v32
    v_dot2c_f32_bf16 v113, v33, v120
    v_dot2c_f32_bf16 v117, v33, v33
    v_dot2c_f32_bf16 v114, v34, v120
    v_dot2c_f32_bf16 v118, v34, v34
    v_dot2c_f32_bf16 v115, v35, v120
    v_dot2c_f32_bf16 v119, v35, v35
    v_dot2c_f32_bf16 v112, v36, v120
    v_dot2c_f32_bf16 v116, v36, v36
    v_dot2c_f32_bf16 v113, v37, v120
    v_dot2c_f32_bf16 v117, v37, v37
    v_dot2c_f32_bf16 v114, v38, v120
    v_dot2c_f32_bf16 v118, v38, v38
    v_dot2c_f32_bf16 v115, v39, v120
    v_dot2c_f32_bf16 v119, v39, v39
    v_dot2c_f32_bf16 v112, v40, v120
    v_dot2c_f32_bf16 v116, v40, v40
    v_dot2c_f32_bf16 v113, v41, v120
    v_dot2c_f32_bf16 v117, v41, v41
    v_dot2c_f32_bf16 v114, v42, v120
    v_dot2c_f32_bf16 v118, v42, v42
    v_dot2c_f32_bf16 v115, v43, v120
    v_dot2c_f32_bf16 v119, v43, v43
    v_dot2c_f32_bf16 v112, v44, v120
    v_dot2c_f32_bf16 v116, v44, v44
    v_dot2c_f32_bf16 v113, v45, v120
    v_dot2c_f32_bf16 v117, v45, v45
    v_dot2c_f32_bf16 v114, v46, v120
    v_dot2c_f32_bf16 v118, v46, v46
    v_dot2c_f32_bf16 v115, v47, v120
    v_dot2c_f32_bf16 v119, v47, v47
    s_waitcnt lgkmcnt(0)
    v_mfma_f32_32x32x16_bf16 v[48:63], v[16:19], v[80:83], v[48:63]
    v_mfma_f32_32x32x16_bf16 v[64:79], v[120:123], v[80:83], v[64:79]
    v_mfma_f32_32x32x16_bf16 v[48:63], v[20:23], v[84:87], v[48:63]
    v_mfma_f32_32x32x16_bf16 v[64:79], v[120:123], v[84:87], v[64:79]
    v_mfma_f32_32x32x16_bf16 v[48:63], v[24:27], v[88:91], v[48:63]
    v_mfma_f32_32x32x16_bf16 v[64:79], v[120:123], v[88:91], v[64:79]
    v_mfma_f32_32x32x16_bf16 v[48:63], v[28:31], v[92:95], v[48:63]
    v_mfma_f32_32x32x16_bf16 v[64:79], v[120:123], v[92:95], v[64:79]
    v_dot2c_f32_bf16 v112, v16, v120
    v_dot2c_f32_bf16 v116, v16, v16
    v_dot2c_f32_bf16 v113, v17, v120
    v_dot2c_f32_bf16 v117, v17, v17
    v_dot2c_f32_bf16 v114, v18, v120
    v_dot2c_f32_bf16 v118, v18, v18
    v_dot2c_f32_bf16 v115, v19, v120
    v_dot2c_f32_bf16 v119, v19, v19
    v_dot2c_f32_bf16 v112, v20, v120
    v_dot2c_f32_bf16 v116, v20, v20
    v_dot2c_f32_bf16 v113, v21, v120
    v_dot2c_f32_bf16 v117, v21, v21
    v_dot2c_f32_bf16 v114, v22, v120
    v_dot2c_f32_bf16 v118, v22, v22
    v_dot2c_f32_bf16 v115, v23, v120
    v_dot2c_f32_bf16 v119, v23, v23
    v_dot2c_f32_bf16 v112, v24, v120
    v_dot2c_f32_bf16 v116, v24, v24
    v_dot2c_f32_bf16 v113, v25, v120
    v_dot2c_f32_bf16 v117, v25, v25
    v_dot2c_f32_bf16 v114, v26, v120
    v_dot2c_f32_bf16 v118, v26, v26
    v_dot2c_f32_bf16 v115, v27, v120
    v_dot2c_f32_bf16 v119, v27, v27
    v_dot2c_f32_bf16 v112, v28, v120
    v_dot2c_f32_bf16 v116, v28, v28
    v_dot2c_f32_bf16 v113, v29, v120
    v_dot2c_f32_bf16 v117, v29, v29
    v_dot2c_f32_bf16 v114, v30, v120
    v_dot2c_f32_bf16 v118, v30, v30
    v_dot2c_f32_bf16 v115, v31, v120
    v_dot2c_f32_bf16 v119, v31, v31
    s_nop 2
    v_add_f32 v12, v112, v113
    v_add_f32 v14, v114, v115
    v_add_f32 v13, v116, v117
    v_add_f32 v10, v118, v119
    v_add_f32 v12, v12, v14
    v_add_f32 v13, v13, v10
    v_mov_b32 v14, v12
    v_mov_b32 v10, v13
    s_nop 1
    v_permlane32_swap_b32 v12, v14
    v_permlane32_swap_b32 v13, v10
    v_add_f32 v12, v12, v14
    v_add_f32 v13, v13, v10
    v_mul_f32 v12, 0x3b124925, v12
    v_mul_f32 v13, 0x3b124925, v13
    v_fma_f32 v13, -v12, v12, v13
    v_max_f32 v13, 0, v13
    v_add_f32 v13, 0x3727c5ac, v13
    v_rsq_f32 v13, v13
    s_lshl_b32 s30, s17, 2
    s_add_u32 s30, s30, s16
    s_lshl_b32 s30, s30, 12
    v_mul_f32_e64 v12, -v12, v13
    s_lshl_b32 s37, s16, 8
    s_add_u32 s37, s37, 28672
    v_and_b32 v10, 31, v1
    v_lshlrev_b32 v10, 2, v10
    v_add_u32 v10, s37, v10
    ds_write_b32 v10, v13
    ds_write_b32 v10, v12 offset:128
    v_lshlrev_b32 v10, 4, v3
    v_add_u32 v10, s37, v10
    s_waitcnt lgkmcnt(0)
    ds_read_b128 v[16:19], v10 offset:0
    ds_read_b128 v[32:35], v10 offset:128
    ds_read_b128 v[20:23], v10 offset:32
    ds_read_b128 v[36:39], v10 offset:160
    ds_read_b128 v[24:27], v10 offset:64
    ds_read_b128 v[40:43], v10 offset:192
    ds_read_b128 v[28:31], v10 offset:96
    ds_read_b128 v[44:47], v10 offset:224
    v_and_b32 v14, 31, v1
    v_cmp_eq_u32 vcc, 28, v14
    v_cmp_gt_u32 s[40:41], 28, v14
    v_mov_b32 v12, 0
    s_add_u32 s38, s30, 0x200800
    v_cndmask_b32 v14, v12, v120, vcc
    s_waitcnt lgkmcnt(0)
    v_pk_mul_f32 v[48:49], v[16:17], v[48:49]
    v_pk_mul_f32 v[50:51], v[18:19], v[50:51]
    v_pk_mul_f32 v[52:53], v[20:21], v[52:53]
    v_pk_mul_f32 v[54:55], v[22:23], v[54:55]
    v_pk_mul_f32 v[56:57], v[24:25], v[56:57]
    v_pk_mul_f32 v[58:59], v[26:27], v[58:59]
    v_pk_mul_f32 v[60:61], v[28:29], v[60:61]
    v_pk_mul_f32 v[62:63], v[30:31], v[62:63]
    v_pk_fma_f32 v[48:49], v[32:33], v[64:65], v[48:49]
    v_pk_fma_f32 v[50:51], v[34:35], v[66:67], v[50:51]
    v_pk_fma_f32 v[52:53], v[36:37], v[68:69], v[52:53]
    v_pk_fma_f32 v[54:55], v[38:39], v[70:71], v[54:55]
    v_pk_fma_f32 v[56:57], v[40:41], v[72:73], v[56:57]
    v_pk_fma_f32 v[58:59], v[42:43], v[74:75], v[58:59]
    v_pk_fma_f32 v[60:61], v[44:45], v[76:77], v[60:61]
    v_pk_fma_f32 v[62:63], v[46:47], v[78:79], v[62:63]
    v_cvt_pk_bf16_f32 v64, v48, v49
    v_cvt_pk_bf16_f32 v65, v50, v51
    v_cvt_pk_bf16_f32 v66, v52, v53
    v_cvt_pk_bf16_f32 v67, v54, v55
    v_cvt_pk_bf16_f32 v68, v56, v57
    v_cvt_pk_bf16_f32 v69, v58, v59
    v_cvt_pk_bf16_f32 v70, v60, v61
    v_cvt_pk_bf16_f32 v71, v62, v63
    v_cndmask_b32 v64, v14, v64, s[40:41]
    v_cndmask_b32 v65, v14, v65, s[40:41]
    v_cndmask_b32 v66, v14, v66, s[40:41]
    v_cndmask_b32 v67, v14, v67, s[40:41]
    v_cndmask_b32 v68, v14, v68, s[40:41]
    v_cndmask_b32 v69, v14, v69, s[40:41]
    v_cndmask_b32 v70, v14, v70, s[40:41]
    v_cndmask_b32 v71, v14, v71, s[40:41]
K_q1_st:
    buffer_store_dwordx4 v[64:67], v2, s[20:23], s38 offen sc1
    buffer_store_dwordx4 v[68:71], v2, s[20:23], s38 offen offset:1024 sc1
    s_waitcnt vmcnt(6)
    s_mov_b32 s41, 0
K_q1_nl:
    v_readfirstlane_b32 s62, v150
    v_readfirstlane_b32 s63, v151
    s_add_u32 s41, s41, 1
    s_cmp_lg_u32 s62, 0
    s_cbranch_scc1 K_q1_nok
    s_cmp_gt_u32 s41, 0x40000
    s_cbranch_scc1 K_q1_nok
    buffer_load_dwordx2 v[150:151], off, s[24:27], 0 sc1
    s_waitcnt vmcnt(0)
    s_branch K_q1_nl
K_q1_nok:
    v_and_b32 v8, 7, v1
    v_lshrrev_b32 v9, 3, v1
    v_lshlrev_b32 v9, 9, v9
    v_lshl_add_u32 v9, v8, 4, v9
    s_lshl_b32 s30, s17, 2
    s_lshr_b32 s37, s18, 2
    s_add_u32 s30, s30, s37
    s_mul_i32 s30, s30, 28672
    s_and_b32 s37, s18, 3
    s_lshl_b32 s37, s37, 7
    s_add_u32 s30, s30, s37
    s_mov_b32 s36, 0
    v_bfe_u32 v10, v1, 3, 2
    v_mad_u32_u24 v10, v10, 7, v3
    v_lshrrev_b32 v11, 2, v10
    v_lshlrev_b32 v12, 8, v11
    v_and_b32 v11, 1, v10
    v_lshl_add_u32 v12, v11, 7, v12
    v_bfe_u32 v11, v10, 1, 1
    v_lshl_add_u32 v12, v11, 3, v12
    v_lshl_add_u32 v12, v8, 4, v12
    v_add_u32 v10, 2, v10
    v_lshrrev_b32 v11, 2, v10
    v_lshlrev_b32 v13, 8, v11
    v_and_b32 v11, 1, v10
    v_lshl_add_u32 v13, v11, 7, v13
    v_bfe_u32 v11, v10, 1, 1
    v_lshl_add_u32 v13, v11, 3, v13
    v_lshl_add_u32 v13, v8, 4, v13
    s_xor_b32 s37, s16, 0
    s_mul_i32 s37, s37, 1792
    v_add_u32 v112, s37, v12
    v_add_u32 v113, s37, v13
    s_xor_b32 s37, s16, 1
    s_mul_i32 s37, s37, 1792
    v_add_u32 v114, s37, v12
    v_add_u32 v115, s37, v13
    s_xor_b32 s37, s16, 2
    s_mul_i32 s37, s37, 1792
    v_add_u32 v116, s37, v12
    v_add_u32 v117, s37, v13
    s_xor_b32 s37, s16, 3
    s_mul_i32 s37, s37, 1792
    v_add_u32 v118, s37, v12
    v_add_u32 v119, s37, v13
    s_mul_i32 s33, s16, 100352
    s_add_u32 s33, s33, 0x300000
    v_mov_b32 v6, s62
    v_mov_b32 v7, s63
    s_lshl_b32 s40, s17, 8
    s_add_u32 s40, s40, 0x3c6000
    s_lshl_b32 s41, s18, 3
    s_add_u32 s41, s41, s40
    v_min_u32 v4, 15, v1
    v_lshlrev_b32 v4, 3, v4
    s_and_b32 s3, s40, 0x100
    s_andn2_b32 s40, s40, 0x100
    v_add_u32 v4, s3, v4
    s_xor_b32 s3, s3, 0x170
    v_and_b32 v5, 1, v1
    v_lshl_add_u32 v5, v5, 3, s3
    v_cndmask_b32 v4, v4, v5, s[28:29]
    s_cmp_lg_u32 s16, 0
    s_waitcnt vmcnt(0)
    s_barrier
    s_cbranch_scc1 K_sig1
    s_mov_b64 exec, 1
    buffer_store_dwordx2 v[6:7], off, s[20:23], s41
    buffer_store_dwordx2 v[6:7], off, s[20:23], s41 offset:128 sc1
    s_mov_b64 exec, -1
K_sig1:
    s_cmp_lg_u32 s16, 0
    s_cbranch_scc1 K_wdone2
    buffer_load_dwordx2 v[6:7], v4, s[20:23], s40 offen sc1
    s_mov_b64 s[42:43], 0
    s_mov_b32 s3, 0
K_wloop3:
    s_waitcnt vmcnt(0)
    v_cmp_eq_u64 vcc, s[62:63], v[6:7]
    s_or_b64 s[42:43], s[42:43], vcc
    s_cmp_eq_u64 s[42:43], -1
    s_cbranch_scc1 K_wgot5
    s_add_u32 s3, s3, 1
    s_bitcmp1_b32 s3, 3
    s_cbranch_scc0 K_wskip4
    s_add_u32 s3, s3, 7
    buffer_load_dwordx2 v[6:7], v4, s[20:23], s40 offen offset:128 sc1
    s_cmp_gt_u32 s3, 0x40000
    s_cbranch_scc0 K_wloop3
    s_branch K_wgot5
K_wskip4:
    buffer_load_dwordx2 v[6:7], v4, s[20:23], s40 offen sc1
    s_branch K_wloop3
K_wgot5:
    s_waitcnt vmcnt(0)
    s_cmp_lg_u32 s18, 0
    s_cbranch_scc1 K_wdone2
    v_mov_b32 v6, s62
    v_mov_b32 v7, s63
    s_lshl_b32 s40, s17, 3
    s_add_u32 s40, s40, 0x3c8000
    v_lshlrev_b32 v4, 8, v1
    s_mov_b64 exec, 0xffff
    buffer_store_dwordx2 v[6:7], v4, s[20:23], s40 offen sc1
    s_mov_b64 exec, -1
K_wdone2:
    s_barrier
    s_lshl_b32 s37, s16, 13
    s_add_u32 s37, s37, s30
    s_add_u32 s37, s37, 0x0
    s_lshl_b32 s38, s16, 11
    s_add_u32 m0, s38, 0
    s_add_u32 s39, s37, 4096
    buffer_load_dwordx4 v9, s[20:23], s37 offen sc1 lds
    s_add_u32 m0, s38, 1024
    s_lshl_b32 s31, s17, 14
    buffer_load_dwordx4 v9, s[20:23], s39 offen sc1 lds
    s_add_u32 s31, s31, 0x200000
    buffer_load_dwordx4 v[144:147], v2, s[20:23], s31 offen sc1
    buffer_load_dwordx4 v[148:151], v2, s[20:23], s31 offen offset:1024 sc1
    s_lshl_b32 s31, s17, 14
    s_lshl_b32 s32, s16, 12
    s_add_u32 s31, s31, s32
    s_add_u32 s31, s31, 0x200000
    s_mov_b32 s32, s31
    buffer_load_dwordx4 v[160:163], v2, s[20:23], s31 offen sc1
    buffer_load_dwordx4 v[164:167], v2, s[20:23], s31 offen offset:1024 sc1
    s_add_u32 m0, s38, 8192
    s_mov_b32 s24, s4
    s_mov_b32 s25, s5
    s_mov_b32 s26, 0x1c0000
    s_mov_b32 s27, 0x20000
    s_lshl_b32 s37, s17, 7
    s_lshl_b32 s39, s18, 3
    s_add_u32 s37, s37, s39
    s_mul_i32 s37, s37, 896
    s_mul_i32 s39, s16, 224
    s_add_u32 s37, s37, s39
    v_lshrrev_b32 v10, 3, v1
    v_mul_u32_u24 v10, 896, v10
    v_lshl_add_u32 v10, v8, 4, v10
    buffer_load_dwordx4 v10, s[24:27], s37 offen lds
    s_add_u32 m0, s38, 9088
    v_lshrrev_b32 v11, 4, v1
    buffer_load_dwordx4 v10, s[24:27], s37 offen offset:128 lds
    v_lshlrev_b32 v10, 7, v8
    v_lshl_add_u32 v10, v11, 3, v10
    v_add_u32 v10, s38, v10
    v_lshrrev_b32 v7, 4, v1
    v_bfe_u32 v6, v1, 3, 2
    v_mul_u32_u24 v4, 912, v8
    v_lshl_add_u32 v5, v7, 4, v4
    v_mad_u32_u24 v4, v6, 56, v4
    v_lshl_add_u32 v4, v3, 3, v4
    s_mul_i32 s37, s16, 224
    s_add_u32 s37, s37, 49152
    v_add_u32 v4, s37, v4
    s_xor_b32 s37, s16, 1
    s_mul_i32 s37, s37, 12288
    s_add_u32 s37, s37, 0
    v_add_u32 v12, s37, v2
    s_xor_b32 s37, s16, 2
    s_mul_i32 s37, s37, 12288
    s_add_u32 s37, s37, 4096
    v_add_u32 v13, s37, v2
    s_xor_b32 s37, s16, 3
    s_mul_i32 s37, s37, 12288
    s_add_u32 s37, s37, 8192
    v_add_u32 v14, s37, v2
    s_mul_i32 s37, s16, 12288
    v_add_u32 v11, s37, v2
    s_mul_i32 s34, s19, 118784
    s_lshl_b32 s35, s16, 12
    s_add_u32 s34, s34, s35
    s_add_u32 s34, s34, 0x400000
    s_add_u32 m0, s35, 65536
    s_lshl_b32 s40, s17, 8
    s_add_u32 s40, s40, 0x3c8000
    v_and_b32 v15, 15, v1
    v_lshlrev_b32 v15, 3, v15
    s_lshl_b32 s37, s16, 7
    s_add_u32 s37, s37, 57344
    v_and_b32 v6, 31, v1
    v_lshl_add_u32 v6, v6, 2, s37
    v_xor_b32 v120, 128, v6
    v_xor_b32 v121, 256, v6
    v_xor_b32 v122, 384, v6
    s_waitcnt vmcnt(6)
    s_barrier
    ds_read_b64 v[16:17], v112 offset:0
    ds_read_b64 v[18:19], v113 offset:0
    ds_read_b64 v[20:21], v112 offset:256
    ds_read_b64 v[22:23], v113 offset:256
    ds_read_b64 v[24:25], v114 offset:0
    ds_read_b64 v[26:27], v115 offset:0
    ds_read_b64 v[28:29], v114 offset:256
    ds_read_b64 v[30:31], v115 offset:256
    ds_read_b64 v[32:33], v116 offset:0
    ds_read_b64 v[34:35], v117 offset:0
    ds_read_b64 v[36:37], v116 offset:256
    ds_read_b64 v[38:39], v117 offset:256
    ds_read_b64 v[40:41], v118 offset:0
    ds_read_b64 v[42:43], v119 offset:0
    ds_read_b64 v[44:45], v118 offset:256
    ds_read_b64 v[46:47], v119 offset:256
    buffer_load_dwordx4 v[184:187], v2, s[20:23], s31 offen offset:2048 sc1
    buffer_load_dwordx4 v[188:191], v2, s[20:23], s31 offen offset:3072 sc1
    s_xor_b32 s31, s32, 0x4000
    s_mov_b32 exec_lo, 0
    s_waitcnt lgkmcnt(12)
    v_mov_b32 v22, 0
    v_mov_b32 v23, 0
    s_mov_b32 exec_lo, -1
    s_waitcnt vmcnt(6)
    v_mfma_f32_32x32x16_bf16 v[48:63], v[144:147], v[16:19], 0
    v_mfma_f32_32x32x16_bf16 v[48:63], v[148:151], v[20:23], v[48:63]
    s_mov_b32 exec_lo, 0
    s_waitcnt lgkmcnt(0)
    v_mov_b32 v31, 0
    v_mov_b32 v39, 0
    v_mov_b32 v47, 0
    s_mov_b32 exec_lo, -1
    s_nop 5
    v_max3_f32 v128, v48, v49, v50
    v_max3_f32 v129, v51, v52, v53
    v_max3_f32 v128, v128, v54, v55
    v_max3_f32 v129, v129, v56, v57
    v_max3_f32 v128, v128, v58, v59
    v_max3_f32 v129, v129, v60, v61
    v_max3_f32 v128, v128, v62, v63
    v_max_f32 v128, v128, v129
    s_mov_b32 exec_lo, 0
    v_cvt_pk_bf16_f32 v22, -v128, 0
    ds_write_b32 v6, v22
    s_mov_b32 exec_lo, -1
    buffer_load_dwordx2 v[222:223], v15, s[20:23], s40 offen sc1
    s_waitcnt lgkmcnt(0)
    s_barrier
    s_mov_b32 exec_lo, 0
    ds_read_b32 v30, v120
    ds_read_b32 v38, v121
    ds_read_b32 v46, v122
    s_mov_b32 exec_lo, -1
    s_waitcnt vmcnt(5)
K_att6_go:
    v_mfma_f32_32x32x16_bf16 v[112:127], v[160:163], v[24:27], 0
    buffer_load_dwordx4 v[168:171], v2, s[20:23], s31 offen sc1
    buffer_load_dwordx4 v[172:175], v2, s[20:23], s31 offen offset:1024 sc1
    s_waitcnt lgkmcnt(0)
    v_mfma_f32_32x32x16_bf16 v[112:127], v[164:167], v[28:31], v[112:127]
    buffer_load_dwordx4 v[192:195], v2, s[20:23], s31 offen offset:2048 sc1
    buffer_load_dwordx4 v[196:199], v2, s[20:23], s31 offen offset:3072 sc1
    s_xor_b32 s31, s32, 0x8000
    s_nop 7
    v_mfma_f32_32x32x16_bf16 v[128:143], v[160:163], v[32:35], 0
    v_exp_f32 v112, v112
    v_exp_f32 v113, v113
    v_exp_f32 v114, v114
    v_exp_f32 v115, v115
    v_cvt_pk_bf16_f32 v144, v112, v113
    v_cvt_pk_bf16_f32 v145, v114, v115
    v_exp_f32 v116, v116
    v_exp_f32 v117, v117
    v_exp_f32 v118, v118
    v_exp_f32 v119, v119
    v_cvt_pk_bf16_f32 v146, v116, v117
    v_mfma_f32_32x32x16_bf16 v[128:143], v[164:167], v[36:39], v[128:143]
    v_cvt_pk_bf16_f32 v147, v118, v119
    v_exp_f32 v120, v120
    v_exp_f32 v121, v121
    v_exp_f32 v122, v122
    v_exp_f32 v123, v123
    v_cvt_pk_bf16_f32 v148, v120, v121
    s_waitcnt vmcnt(5)
    v_mfma_f32_32x32x16_bf16 v[64:79], v[184:187], v[144:147], 0
    v_cvt_pk_bf16_f32 v149, v122, v123
    v_exp_f32 v124, v124
    v_exp_f32 v125, v125
    v_exp_f32 v126, v126
    v_exp_f32 v127, v127
    v_cvt_pk_bf16_f32 v150, v124, v125
    v_cvt_pk_bf16_f32 v151, v126, v127
    v_mfma_f32_32x32x16_bf16 v[112:127], v[160:163], v[40:43], 0
    ds_read_b64 v[208:209], v10 offset:8192
    v_exp_f32 v128, v128
    v_exp_f32 v129, v129
    v_exp_f32 v130, v130
    v_exp_f32 v131, v131
    v_cvt_pk_bf16_f32 v152, v128, v129
    v_mfma_f32_32x32x16_bf16 v[64:79], v[188:191], v[148:151], v[64:79]
    ds_read_b64 v[210:211], v10 offset:8224
    v_cvt_pk_bf16_f32 v153, v130, v131
    v_exp_f32 v132, v132
    v_exp_f32 v133, v133
    v_exp_f32 v134, v134
    v_exp_f32 v135, v135
    v_cvt_pk_bf16_f32 v154, v132, v133
    v_mfma_f32_32x32x16_bf16 v[112:127], v[164:167], v[44:47], v[112:127]
    ds_read_b64 v[212:213], v10 offset:8256
    v_cvt_pk_bf16_f32 v155, v134, v135
    v_exp_f32 v136, v136
    v_exp_f32 v137, v137
    v_exp_f32 v138, v138
    v_exp_f32 v139, v139
    v_cvt_pk_bf16_f32 v156, v136, v137
    v_mfma_f32_32x32x16_bf16 v[80:95], v[184:187], v[152:155], 0
    ds_read_b64 v[214:215], v10 offset:8288
    v_cvt_pk_bf16_f32 v157, v138, v139
    v_exp_f32 v140, v140
    v_exp_f32 v141, v141
    v_exp_f32 v142, v142
    v_exp_f32 v143, v143
    v_cvt_pk_bf16_f32 v158, v140, v141
    v_cvt_pk_bf16_f32 v159, v142, v143
    v_mfma_f32_32x32x16_bf16 v[128:143], v[160:163], v[16:19], 0
    s_waitcnt vmcnt(4)
    v_cmp_ne_u64 vcc, s[62:63], v[222:223]
    s_cbranch_vccnz K_gslow7
K_gback8:
    buffer_load_dwordx4 v[176:179], v2, s[20:23], s31 offen sc1
    buffer_load_dwordx4 v[180:183], v2, s[20:23], s31 offen offset:1024 sc1
    v_exp_f32 v112, v112
    v_exp_f32 v113, v113
    v_exp_f32 v114, v114
    v_exp_f32 v115, v115
    v_cvt_pk_bf16_f32 v144, v112, v113
    v_mfma_f32_32x32x16_bf16 v[80:95], v[188:191], v[156:159], v[80:95]
    buffer_load_dwordx4 v[200:203], v2, s[20:23], s31 offen offset:2048 sc1
    buffer_load_dwordx4 v[204:207], v2, s[20:23], s31 offen offset:3072 sc1
    v_cvt_pk_bf16_f32 v145, v114, v115
    v_exp_f32 v116, v116
    v_exp_f32 v117, v117
    v_exp_f32 v118, v118
    v_exp_f32 v119, v119
    v_cvt_pk_bf16_f32 v146, v116, v117
    v_mfma_f32_32x32x16_bf16 v[128:143], v[164:167], v[20:23], v[128:143]
    ds_read_b64 v[216:217], v10 offset:9216
    v_cvt_pk_bf16_f32 v147, v118, v119
    v_exp_f32 v120, v120
    v_exp_f32 v121, v121
    v_exp_f32 v122, v122
    v_exp_f32 v123, v123
    v_cvt_pk_bf16_f32 v148, v120, v121
    v_mfma_f32_32x32x16_bf16 v[96:111], v[184:187], v[144:147], 0
    s_waitcnt vmcnt(4)
    v_cvt_pk_bf16_f32 v149, v122, v123
    v_exp_f32 v124, v124
    v_exp_f32 v125, v125
    v_exp_f32 v126, v126
    v_exp_f32 v127, v127
    v_cvt_pk_bf16_f32 v150, v124, v125
    v_cvt_pk_bf16_f32 v151, v126, v127
    v_mfma_f32_32x32x16_bf16 v[112:127], v[168:171], v[24:27], 0
    s_xor_b32 s31, s32, 0xc000
    buffer_load_dwordx4 v[160:163], v2, s[20:23], s31 offen sc1
    buffer_load_dwordx4 v[164:167], v2, s[20:23], s31 offen offset:1024 sc1
    v_exp_f32 v128, v128
    v_exp_f32 v129, v129
    v_exp_f32 v130, v130
    v_exp_f32 v131, v131
    v_cvt_pk_bf16_f32 v152, v128, v129
    v_mfma_f32_32x32x16_bf16 v[96:111], v[188:191], v[148:151], v[96:111]
    ds_read_b64 v[218:219], v10 offset:9248
    v_cvt_pk_bf16_f32 v153, v130, v131
    v_exp_f32 v132, v132
    v_exp_f32 v133, v133
    v_exp_f32 v134, v134
    v_exp_f32 v135, v135
    v_cvt_pk_bf16_f32 v154, v132, v133
    v_mfma_f32_32x32x16_bf16 v[112:127], v[172:175], v[28:31], v[112:127]
    buffer_load_dwordx4 a[0:3], v2, s[20:23], s33 offen offset:0 sc1
    v_cvt_pk_bf16_f32 v155, v134, v135
    v_exp_f32 v136, v136
    v_exp_f32 v137, v137
    v_exp_f32 v138, v138
    v_exp_f32 v139, v139
    v_cvt_pk_bf16_f32 v156, v136, v137
    v_mfma_f32_32x32x16_bf16 v[48:63], v[184:187], v[152:155], 0
    ds_read_b64 v[220:221], v10 offset:9280
    v_cvt_pk_bf16_f32 v157, v138, v139
    v_exp_f32 v140, v140
    v_exp_f32 v141, v141
    v_exp_f32 v142, v142
    v_exp_f32 v143, v143
    v_cvt_pk_bf16_f32 v158, v140, v141
    v_cvt_pk_bf16_f32 v159, v142, v143
    v_mfma_f32_32x32x16_bf16 v[128:143], v[168:171], v[32:35], 0
    v_exp_f32 v112, v112
    v_exp_f32 v113, v113
    v_exp_f32 v114, v114
    v_exp_f32 v115, v115
    v_cvt_pk_bf16_f32 v144, v112, v113
    v_mfma_f32_32x32x16_bf16 v[48:63], v[188:191], v[156:159], v[48:63]
    buffer_load_dwordx4 a[4:7], v2, s[20:23], s33 offen offset:1024 sc1
    v_cvt_pk_bf16_f32 v145, v114, v115
    v_exp_f32 v116, v116
    v_exp_f32 v117, v117
    v_exp_f32 v118, v118
    v_exp_f32 v119, v119
    v_cvt_pk_bf16_f32 v146, v116, v117
    v_mfma_f32_32x32x16_bf16 v[128:143], v[172:175], v[36:39], v[128:143]
    buffer_load_dwordx4 a[8:11], v2, s[20:23], s33 offen offset:2048 sc1
    v_cvt_pk_bf16_f32 v147, v118, v119
    v_exp_f32 v120, v120
    v_exp_f32 v121, v121
    v_exp_f32 v122, v122
    v_exp_f32 v123, v123
    v_cvt_pk_bf16_f32 v148, v120, v121
    v_mfma_f32_32x32x16_bf16 v[64:79], v[192:195], v[144:147], v[64:79]
    v_cvt_pk_bf16_f32 v149, v122, v123
    v_exp_f32 v124, v124
    v_exp_f32 v125, v125
    v_exp_f32 v126, v126
    v_exp_f32 v127, v127
    v_cvt_pk_bf16_f32 v150, v124, v125
    v_cvt_pk_bf16_f32 v151, v126, v127
    v_mfma_f32_32x32x16_bf16 v[112:127], v[168:171], v[40:43], 0
    buffer_load_dwordx4 v[184:187], v2, s[20:23], s31 offen offset:2048 sc1
    buffer_load_dwordx4 v[188:191], v2, s[20:23], s31 offen offset:3072 sc1
    v_exp_f32 v128, v128
    v_exp_f32 v129, v129
    v_exp_f32 v130, v130
    v_exp_f32 v131, v131
    v_cvt_pk_bf16_f32 v152, v128, v129
    v_mfma_f32_32x32x16_bf16 v[64:79], v[196:199], v[148:151], v[64:79]
    buffer_load_dwordx4 a[12:15], v2, s[20:23], s33 offen offset:3072 sc1
    v_cvt_pk_bf16_f32 v153, v130, v131
    v_exp_f32 v132, v132
    v_exp_f32 v133, v133
    v_exp_f32 v134, v134
    v_exp_f32 v135, v135
    v_cvt_pk_bf16_f32 v154, v132, v133
    v_mfma_f32_32x32x16_bf16 v[112:127], v[172:175], v[44:47], v[112:127]
    s_add_u32 s33, s33, 4096
    buffer_load_dwordx4 a[16:19], v2, s[20:23], s33 offen offset:0 sc1
    v_cvt_pk_bf16_f32 v155, v134, v135
    v_exp_f32 v136, v136
    v_exp_f32 v137, v137
    v_exp_f32 v138, v138
    v_exp_f32 v139, v139
    v_cvt_pk_bf16_f32 v156, v136, v137
    v_mfma_f32_32x32x16_bf16 v[80:95], v[192:195], v[152:155], v[80:95]
    s_xor_b32 s31, s32, 0x10000
    v_cvt_pk_bf16_f32 v157, v138, v139
    v_exp_f32 v140, v140
    v_exp_f32 v141, v141
    v_exp_f32 v142, v142
    v_exp_f32 v143, v143
    v_cvt_pk_bf16_f32 v158, v140, v141
    v_cvt_pk_bf16_f32 v159, v142, v143
    v_mfma_f32_32x32x16_bf16 v[128:143], v[168:171], v[16:19], 0
    v_exp_f32 v112, v112
    v_exp_f32 v113, v113
    v_exp_f32 v114, v114
    v_exp_f32 v115, v115
    v_cvt_pk_bf16_f32 v144, v112, v113
    v_mfma_f32_32x32x16_bf16 v[80:95], v[196:199], v[156:159], v[80:95]
    buffer_load_dwordx4 a[20:23], v2, s[20:23], s33 offen offset:1024 sc1
    v_cvt_pk_bf16_f32 v145, v114, v115
    v_exp_f32 v116, v116
    v_exp_f32 v117, v117
    v_exp_f32 v118, v118
    v_exp_f32 v119, v119
    v_cvt_pk_bf16_f32 v146, v116, v117
    v_mfma_f32_32x32x16_bf16 v[128:143], v[172:175], v[20:23], v[128:143]
    buffer_load_dwordx4 a[24:27], v2, s[20:23], s33 offen offset:2048 sc1
    v_cvt_pk_bf16_f32 v147, v118, v119
    v_exp_f32 v120, v120
    v_exp_f32 v121, v121
    v_exp_f32 v122, v122
    v_exp_f32 v123, v123
    v_cvt_pk_bf16_f32 v148, v120, v121
    v_mfma_f32_32x32x16_bf16 v[96:111], v[192:195], v[144:147], v[96:111]
    s_waitcnt vmcnt(11)
    v_cvt_pk_bf16_f32 v149, v122, v123
    v_exp_f32 v124, v124
    v_exp_f32 v125, v125
    v_exp_f32 v126, v126
    v_exp_f32 v127, v127
    v_cvt_pk_bf16_f32 v150, v124, v125
    v_cvt_pk_bf16_f32 v151, v126, v127
    v_mfma_f32_32x32x16_bf16 v[112:127], v[176:179], v[24:27], 0
    buffer_load_dwordx4 v[168:171], v2, s[20:23], s31 offen sc1
    buffer_load_dwordx4 v[172:175], v2, s[20:23], s31 offen offset:1024 sc1
    v_exp_f32 v128, v128
    v_exp_f32 v129, v129
    v_exp_f32 v130, v130
    v_exp_f32 v131, v131
    v_cvt_pk_bf16_f32 v152, v128, v129
    v_mfma_f32_32x32x16_bf16 v[96:111], v[196:199], v[148:151], v[96:111]
    v_cvt_pk_bf16_f32 v153, v130, v131
    v_exp_f32 v132, v132
    v_exp_f32 v133, v133
    v_exp_f32 v134, v134
    v_exp_f32 v135, v135
    v_cvt_pk_bf16_f32 v154, v132, v133
    v_mfma_f32_32x32x16_bf16 v[112:127], v[180:183], v[28:31], v[112:127]
    buffer_load_dwordx4 a[28:31], v2, s[20:23], s33 offen offset:3072 sc1
    v_cvt_pk_bf16_f32 v155, v134, v135
    v_exp_f32 v136, v136
    v_exp_f32 v137, v137
    v_exp_f32 v138, v138
    v_exp_f32 v139, v139
    v_cvt_pk_bf16_f32 v156, v136, v137
    v_mfma_f32_32x32x16_bf16 v[48:63], v[192:195], v[152:155], v[48:63]
    s_add_u32 s33, s33, 4096
    v_cvt_pk_bf16_f32 v157, v138, v139
    v_exp_f32 v140, v140
    v_exp_f32 v141, v141
    v_exp_f32 v142, v142
    v_exp_f32 v143, v143
    v_cvt_pk_bf16_f32 v158, v140, v141
    v_cvt_pk_bf16_f32 v159, v142, v143
    v_mfma_f32_32x32x16_bf16 v[128:143], v[176:179], v[32:35], 0
    v_exp_f32 v112, v112
    v_exp_f32 v113, v113
    v_exp_f32 v114, v114
    v_exp_f32 v115, v115
    v_cvt_pk_bf16_f32 v144, v112, v113
    v_mfma_f32_32x32x16_bf16 v[48:63], v[196:199], v[156:159], v[48:63]
    buffer_load_dwordx4 a[32:35], v2, s[20:23], s33 offen offset:0 sc1
    v_cvt_pk_bf16_f32 v145, v114, v115
    v_exp_f32 v116, v116
    v_exp_f32 v117, v117
    v_exp_f32 v118, v118
    v_exp_f32 v119, v119
    v_cvt_pk_bf16_f32 v146, v116, v117
    v_mfma_f32_32x32x16_bf16 v[128:143], v[180:183], v[36:39], v[128:143]
    buffer_load_dwordx4 a[36:39], v2, s[20:23], s33 offen offset:1024 sc1
    v_cvt_pk_bf16_f32 v147, v118, v119
    v_exp_f32 v120, v120
    v_exp_f32 v121, v121
    v_exp_f32 v122, v122
    v_exp_f32 v123, v123
    v_cvt_pk_bf16_f32 v148, v120, v121
    v_mfma_f32_32x32x16_bf16 v[64:79], v[200:203], v[144:147], v[64:79]
    v_cvt_pk_bf16_f32 v149, v122, v123
    v_exp_f32 v124, v124
    v_exp_f32 v125, v125
    v_exp_f32 v126, v126
    v_exp_f32 v127, v127
    v_cvt_pk_bf16_f32 v150, v124, v125
    v_cvt_pk_bf16_f32 v151, v126, v127
    v_mfma_f32_32x32x16_bf16 v[112:127], v[176:179], v[40:43], 0
    buffer_load_dwordx4 v[192:195], v2, s[20:23], s31 offen offset:2048 sc1
    buffer_load_dwordx4 v[196:199], v2, s[20:23], s31 offen offset:3072 sc1
    v_exp_f32 v128, v128
    v_exp_f32 v129, v129
    v_exp_f32 v130, v130
    v_exp_f32 v131, v131
    v_cvt_pk_bf16_f32 v152, v128, v129
    v_mfma_f32_32x32x16_bf16 v[64:79], v[204:207], v[148:151], v[64:79]
    buffer_load_dwordx4 a[40:43], v2, s[20:23], s33 offen offset:2048 sc1
    v_cvt_pk_bf16_f32 v153, v130, v131
    v_exp_f32 v132, v132
    v_exp_f32 v133, v133
    v_exp_f32 v134, v134
    v_exp_f32 v135, v135
    v_cvt_pk_bf16_f32 v154, v132, v133
    v_mfma_f32_32x32x16_bf16 v[112:127], v[180:183], v[44:47], v[112:127]
    buffer_load_dwordx4 a[44:47], v2, s[20:23], s33 offen offset:3072 sc1
    v_cvt_pk_bf16_f32 v155, v134, v135
    v_exp_f32 v136, v136
    v_exp_f32 v137, v137
    v_exp_f32 v138, v138
    v_exp_f32 v139, v139
    v_cvt_pk_bf16_f32 v156, v136, v137
    v_mfma_f32_32x32x16_bf16 v[80:95], v[200:203], v[152:155], v[80:95]
    s_xor_b32 s31, s32, 0x14000
    v_cvt_pk_bf16_f32 v157, v138, v139
    v_exp_f32 v140, v140
    v_exp_f32 v141, v141
    v_exp_f32 v142, v142
    v_exp_f32 v143, v143
    v_cvt_pk_bf16_f32 v158, v140, v141
    v_cvt_pk_bf16_f32 v159, v142, v143
    v_mfma_f32_32x32x16_bf16 v[128:143], v[176:179], v[16:19], 0
    s_add_u32 s33, s33, 4096
    v_exp_f32 v112, v112
    v_exp_f32 v113, v113
    v_exp_f32 v114, v114
    v_exp_f32 v115, v115
    v_cvt_pk_bf16_f32 v144, v112, v113
    v_mfma_f32_32x32x16_bf16 v[80:95], v[204:207], v[156:159], v[80:95]
    buffer_load_dwordx4 a[48:51], v2, s[20:23], s33 offen offset:0 sc1
    v_cvt_pk_bf16_f32 v145, v114, v115
    v_exp_f32 v116, v116
    v_exp_f32 v117, v117
    v_exp_f32 v118, v118
    v_exp_f32 v119, v119
    v_cvt_pk_bf16_f32 v146, v116, v117
    v_mfma_f32_32x32x16_bf16 v[128:143], v[180:183], v[20:23], v[128:143]
    buffer_load_dwordx4 a[52:55], v2, s[20:23], s33 offen offset:1024 sc1
    v_cvt_pk_bf16_f32 v147, v118, v119
    v_exp_f32 v120, v120
    v_exp_f32 v121, v121
    v_exp_f32 v122, v122
    v_exp_f32 v123, v123
    v_cvt_pk_bf16_f32 v148, v120, v121
    v_mfma_f32_32x32x16_bf16 v[96:111], v[200:203], v[144:147], v[96:111]
    s_waitcnt vmcnt(15)
    v_cvt_pk_bf16_f32 v149, v122, v123
    v_exp_f32 v124, v124
    v_exp_f32 v125, v125
    v_exp_f32 v126, v126
    v_exp_f32 v127, v127
    v_cvt_pk_bf16_f32 v150, v124, v125
    v_cvt_pk_bf16_f32 v151, v126, v127
    v_mfma_f32_32x32x16_bf16 v[112:127], v[160:163], v[24:27], 0
    buffer_load_dwordx4 v[176:179], v2, s[20:23], s31 offen sc1
    buffer_load_dwordx4 v[180:183], v2, s[20:23], s31 offen offset:1024 sc1
    v_exp_f32 v128, v128
    v_exp_f32 v129, v129
    v_exp_f32 v130, v130
    v_exp_f32 v131, v131
    v_cvt_pk_bf16_f32 v152, v128, v129
    v_mfma_f32_32x32x16_bf16 v[96:111], v[204:207], v[148:151], v[96:111]
    v_cvt_pk_bf16_f32 v153, v130, v131
    v_exp_f32 v132, v132
    v_exp_f32 v133, v133
    v_exp_f32 v134, v134
    v_exp_f32 v135, v135
    v_cvt_pk_bf16_f32 v154, v132, v133
    v_mfma_f32_32x32x16_bf16 v[112:127], v[164:167], v[28:31], v[112:127]
    buffer_load_dwordx4 a[56:59], v2, s[20:23], s33 offen offset:2048 sc1
    v_cvt_pk_bf16_f32 v155, v134, v135
    v_exp_f32 v136, v136
    v_exp_f32 v137, v137
    v_exp_f32 v138, v138
    v_exp_f32 v139, v139
    v_cvt_pk_bf16_f32 v156, v136, v137
    v_mfma_f32_32x32x16_bf16 v[48:63], v[200:203], v[152:155], v[48:63]
    v_cvt_pk_bf16_f32 v157, v138, v139
    v_exp_f32 v140, v140
    v_exp_f32 v141, v141
    v_exp_f32 v142, v142
    v_exp_f32 v143, v143
    v_cvt_pk_bf16_f32 v158, v140, v141
    v_cvt_pk_bf16_f32 v159, v142, v143
    v_mfma_f32_32x32x16_bf16 v[128:143], v[160:163], v[32:35], 0
    v_exp_f32 v112, v112
    v_exp_f32 v113, v113
    v_exp_f32 v114, v114
    v_exp_f32 v115, v115
    v_cvt_pk_bf16_f32 v144, v112, v113
    v_mfma_f32_32x32x16_bf16 v[48:63], v[204:207], v[156:159], v[48:63]
    buffer_load_dwordx4 a[60:63], v2, s[20:23], s33 offen offset:3072 sc1
    v_cvt_pk_bf16_f32 v145, v114, v115
    v_exp_f32 v116, v116
    v_exp_f32 v117, v117
    v_exp_f32 v118, v118
    v_exp_f32 v119, v119
    v_cvt_pk_bf16_f32 v146, v116, v117
    v_mfma_f32_32x32x16_bf16 v[128:143], v[164:167], v[36:39], v[128:143]
    s_add_u32 s33, s33, 4096
    buffer_load_dwordx4 a[64:67], v2, s[20:23], s33 offen offset:0 sc1
    v_cvt_pk_bf16_f32 v147, v118, v119
    v_exp_f32 v120, v120
    v_exp_f32 v121, v121
    v_exp_f32 v122, v122
    v_exp_f32 v123, v123
    v_cvt_pk_bf16_f32 v148, v120, v121
    v_mfma_f32_32x32x16_bf16 v[64:79], v[184:187], v[144:147], v[64:79]
    v_cvt_pk_bf16_f32 v149, v122, v123
    v_exp_f32 v124, v124
    v_exp_f32 v125, v125
    v_exp_f32 v126, v126
    v_exp_f32 v127, v127
    v_cvt_pk_bf16_f32 v150, v124, v125
    v_cvt_pk_bf16_f32 v151, v126, v127
    v_mfma_f32_32x32x16_bf16 v[112:127], v[160:163], v[40:43], 0
    buffer_load_dwordx4 v[200:203], v2, s[20:23], s31 offen offset:2048 sc1
    buffer_load_dwordx4 v[204:207], v2, s[20:23], s31 offen offset:3072 sc1
    v_exp_f32 v128, v128
    v_exp_f32 v129, v129
    v_exp_f32 v130, v130
    v_exp_f32 v131, v131
    v_cvt_pk_bf16_f32 v152, v128, v129
    v_mfma_f32_32x32x16_bf16 v[64:79], v[188:191], v[148:151], v[64:79]
    buffer_load_dwordx4 a[68:71], v2, s[20:23], s33 offen offset:1024 sc1
    v_cvt_pk_bf16_f32 v153, v130, v131
    v_exp_f32 v132, v132
    v_exp_f32 v133, v133
    v_exp_f32 v134, v134
    v_exp_f32 v135, v135
    v_cvt_pk_bf16_f32 v154, v132, v133
    v_mfma_f32_32x32x16_bf16 v[112:127], v[164:167], v[44:47], v[112:127]
    buffer_load_dwordx4 a[72:75], v2, s[20:23], s33 offen offset:2048 sc1
    v_cvt_pk_bf16_f32 v155, v134, v135
    v_exp_f32 v136, v136
    v_exp_f32 v137, v137
    v_exp_f32 v138, v138
    v_exp_f32 v139, v139
    v_cvt_pk_bf16_f32 v156, v136, v137
    v_mfma_f32_32x32x16_bf16 v[80:95], v[184:187], v[152:155], v[80:95]
    s_xor_b32 s31, s32, 0x18000
    v_cvt_pk_bf16_f32 v157, v138, v139
    v_exp_f32 v140, v140
    v_exp_f32 v141, v141
    v_exp_f32 v142, v142
    v_exp_f32 v143, v143
    v_cvt_pk_bf16_f32 v158, v140, v141
    v_cvt_pk_bf16_f32 v159, v142, v143
    v_mfma_f32_32x32x16_bf16 v[128:143], v[160:163], v[16:19], 0
    v_exp_f32 v112, v112
    v_exp_f32 v113, v113
    v_exp_f32 v114, v114
    v_exp_f32 v115, v115
    v_cvt_pk_bf16_f32 v144, v112, v113
    v_mfma_f32_32x32x16_bf16 v[80:95], v[188:191], v[156:159], v[80:95]
    buffer_load_dwordx4 a[76:79], v2, s[20:23], s33 offen offset:3072 sc1
    v_cvt_pk_bf16_f32 v145, v114, v115
    v_exp_f32 v116, v116
    v_exp_f32 v117, v117
    v_exp_f32 v118, v118
    v_exp_f32 v119, v119
    v_cvt_pk_bf16_f32 v146, v116, v117
    v_mfma_f32_32x32x16_bf16 v[128:143], v[164:167], v[20:23], v[128:143]
    s_add_u32 s33, s33, 4096
    buffer_load_dwordx4 a[80:83], v2, s[20:23], s33 offen offset:0 sc1
    v_cvt_pk_bf16_f32 v147, v118, v119
    v_exp_f32 v120, v120
    v_exp_f32 v121, v121
    v_exp_f32 v122, v122
    v_exp_f32 v123, v123
    v_cvt_pk_bf16_f32 v148, v120, v121
    v_mfma_f32_32x32x16_bf16 v[96:111], v[184:187], v[144:147], v[96:111]
    s_waitcnt vmcnt(15)
    v_cvt_pk_bf16_f32 v149, v122, v123
    v_exp_f32 v124, v124
    v_exp_f32 v125, v125
    v_exp_f32 v126, v126
    v_exp_f32 v127, v127
    v_cvt_pk_bf16_f32 v150, v124, v125
    v_cvt_pk_bf16_f32 v151, v126, v127
    v_mfma_f32_32x32x16_bf16 v[112:127], v[168:171], v[24:27], 0
    buffer_load_dwordx4 v[160:163], v2, s[20:23], s31 offen sc1
    buffer_load_dwordx4 v[164:167], v2, s[20:23], s31 offen offset:1024 sc1
    v_exp_f32 v128, v128
    v_exp_f32 v129, v129
    v_exp_f32 v130, v130
    v_exp_f32 v131, v131
    v_cvt_pk_bf16_f32 v152, v128, v129
    v_mfma_f32_32x32x16_bf16 v[96:111], v[188:191], v[148:151], v[96:111]
    v_cvt_pk_bf16_f32 v153, v130, v131
    v_exp_f32 v132, v132
    v_exp_f32 v133, v133
    v_exp_f32 v134, v134
    v_exp_f32 v135, v135
    v_cvt_pk_bf16_f32 v154, v132, v133
    v_mfma_f32_32x32x16_bf16 v[112:127], v[172:175], v[28:31], v[112:127]
    buffer_load_dwordx4 a[84:87], v2, s[20:23], s33 offen offset:1024 sc1
    v_cvt_pk_bf16_f32 v155, v134, v135
    v_exp_f32 v136, v136
    v_exp_f32 v137, v137
    v_exp_f32 v138, v138
    v_exp_f32 v139, v139
    v_cvt_pk_bf16_f32 v156, v136, v137
    v_mfma_f32_32x32x16_bf16 v[48:63], v[184:187], v[152:155], v[48:63]
    v_cvt_pk_bf16_f32 v157, v138, v139
    v_exp_f32 v140, v140
    v_exp_f32 v141, v141
    v_exp_f32 v142, v142
    v_exp_f32 v143, v143
    v_cvt_pk_bf16_f32 v158, v140, v141
    v_cvt_pk_bf16_f32 v159, v142, v143
    v_mfma_f32_32x32x16_bf16 v[128:143], v[168:171], v[32:35], 0
    v_exp_f32 v112, v112
    v_exp_f32 v113, v113
    v_exp_f32 v114, v114
    v_exp_f32 v115, v115
    v_cvt_pk_bf16_f32 v144, v112, v113
    v_mfma_f32_32x32x16_bf16 v[48:63], v[188:191], v[156:159], v[48:63]
    buffer_load_dwordx4 a[88:91], v2, s[20:23], s33 offen offset:2048 sc1
    v_cvt_pk_bf16_f32 v145, v114, v115
    v_exp_f32 v116, v116
    v_exp_f32 v117, v117
    v_exp_f32 v118, v118
    v_exp_f32 v119, v119
    v_cvt_pk_bf16_f32 v146, v116, v117
    v_mfma_f32_32x32x16_bf16 v[128:143], v[172:175], v[36:39], v[128:143]
    buffer_load_dwordx4 a[92:95], v2, s[20:23], s33 offen offset:3072 sc1
    v_cvt_pk_bf16_f32 v147, v118, v119
    v_exp_f32 v120, v120
    v_exp_f32 v121, v121
    v_exp_f32 v122, v122
    v_exp_f32 v123, v123
    v_cvt_pk_bf16_f32 v148, v120, v121
    v_mfma_f32_32x32x16_bf16 v[64:79], v[192:195], v[144:147], v[64:79]
    s_add_u32 s33, s33, 4096
    v_cvt_pk_bf16_f32 v149, v122, v123
    v_exp_f32 v124, v124
    v_exp_f32 v125, v125
    v_exp_f32 v126, v126
    v_exp_f32 v127, v127
    v_cvt_pk_bf16_f32 v150, v124, v125
    v_cvt_pk_bf16_f32 v151, v126, v127
    v_mfma_f32_32x32x16_bf16 v[112:127], v[168:171], v[40:43], 0
    buffer_load_dwordx4 v[184:187], v2, s[20:23], s31 offen offset:2048 sc1
    buffer_load_dwordx4 v[188:191], v2, s[20:23], s31 offen offset:3072 sc1
    v_exp_f32 v128, v128
    v_exp_f32 v129, v129
    v_exp_f32 v130, v130
    v_exp_f32 v131, v131
    v_cvt_pk_bf16_f32 v152, v128, v129
    v_mfma_f32_32x32x16_bf16 v[64:79], v[196:199], v[148:151], v[64:79]
    buffer_load_dwordx4 a[96:99], v2, s[20:23], s33 offen offset:0 sc1
    v_cvt_pk_bf16_f32 v153, v130, v131
    v_exp_f32 v132, v132
    v_exp_f32 v133, v133
    v_exp_f32 v134, v134
    v_exp_f32 v135, v135
    v_cvt_pk_bf16_f32 v154, v132, v133
    v_mfma_f32_32x32x16_bf16 v[112:127], v[172:175], v[44:47], v[112:127]
    buffer_load_dwordx4 a[100:103], v2, s[20:23], s33 offen offset:1024 sc1
    v_cvt_pk_bf16_f32 v155, v134, v135
    v_exp_f32 v136, v136
    v_exp_f32 v137, v137
    v_exp_f32 v138, v138
    v_exp_f32 v139, v139
    v_cvt_pk_bf16_f32 v156, v136, v137
    v_mfma_f32_32x32x16_bf16 v[80:95], v[192:195], v[152:155], v[80:95]
    s_xor_b32 s31, s32, 0x1c000
    v_cvt_pk_bf16_f32 v157, v138, v139
    v_exp_f32 v140, v140
    v_exp_f32 v141, v141
    v_exp_f32 v142, v142
    v_exp_f32 v143, v143
    v_cvt_pk_bf16_f32 v158, v140, v141
    v_cvt_pk_bf16_f32 v159, v142, v143
    v_mfma_f32_32x32x16_bf16 v[128:143], v[168:171], v[16:19], 0
    v_exp_f32 v112, v112
    v_exp_f32 v113, v113
    v_exp_f32 v114, v114
    v_exp_f32 v115, v115
    v_cvt_pk_bf16_f32 v144, v112, v113
    v_mfma_f32_32x32x16_bf16 v[80:95], v[196:199], v[156:159], v[80:95]
    buffer_load_dwordx4 a[104:107], v2, s[20:23], s33 offen offset:2048 sc1
    v_cvt_pk_bf16_f32 v145, v114, v115
    v_exp_f32 v116, v116
    v_exp_f32 v117, v117
    v_exp_f32 v118, v118
    v_exp_f32 v119, v119
    v_cvt_pk_bf16_f32 v146, v116, v117
    v_mfma_f32_32x32x16_bf16 v[128:143], v[172:175], v[20:23], v[128:143]
    buffer_load_dwordx4 a[108:111], v2, s[20:23], s33 offen offset:3072 sc1
    v_cvt_pk_bf16_f32 v147, v118, v119
    v_exp_f32 v120, v120
    v_exp_f32 v121, v121
    v_exp_f32 v122, v122
    v_exp_f32 v123, v123
    v_cvt_pk_bf16_f32 v148, v120, v121
    v_mfma_f32_32x32x16_bf16 v[96:111], v[192:195], v[144:147], v[96:111]
    s_waitcnt vmcnt(15)
    v_cvt_pk_bf16_f32 v149, v122, v123
    v_exp_f32 v124, v124
    v_exp_f32 v125, v125
    v_exp_f32 v126, v126
    v_exp_f32 v127, v127
    v_cvt_pk_bf16_f32 v150, v124, v125
    v_cvt_pk_bf16_f32 v151, v126, v127
    v_mfma_f32_32x32x16_bf16 v[112:127], v[176:179], v[24:27], 0
    buffer_load_dwordx4 v[168:171], v2, s[20:23], s31 offen sc1
    buffer_load_dwordx4 v[172:175], v2, s[20:23], s31 offen offset:1024 sc1
    v_exp_f32 v128, v128
    v_exp_f32 v129, v129
    v_exp_f32 v130, v130
    v_exp_f32 v131, v131
    v_cvt_pk_bf16_f32 v152, v128, v129
    v_mfma_f32_32x32x16_bf16 v[96:111], v[196:199], v[148:151], v[96:111]
    s_add_u32 s33, s33, 4096
    v_cvt_pk_bf16_f32 v153, v130, v131
    v_exp_f32 v132, v132
    v_exp_f32 v133, v133
    v_exp_f32 v134, v134
    v_exp_f32 v135, v135
    v_cvt_pk_bf16_f32 v154, v132, v133
    v_mfma_f32_32x32x16_bf16 v[112:127], v[180:183], v[28:31], v[112:127]
    buffer_load_dwordx4 a[112:115], v2, s[20:23], s33 offen offset:0 sc1
    v_cvt_pk_bf16_f32 v155, v134, v135
    v_exp_f32 v136, v136
    v_exp_f32 v137, v137
    v_exp_f32 v138, v138
    v_exp_f32 v139, v139
    v_cvt_pk_bf16_f32 v156, v136, v137
    v_mfma_f32_32x32x16_bf16 v[48:63], v[192:195], v[152:155], v[48:63]
    v_cvt_pk_bf16_f32 v157, v138, v139
    v_exp_f32 v140, v140
    v_exp_f32 v141, v141
    v_exp_f32 v142, v142
    v_exp_f32 v143, v143
    v_cvt_pk_bf16_f32 v158, v140, v141
    v_cvt_pk_bf16_f32 v159, v142, v143
    v_mfma_f32_32x32x16_bf16 v[128:143], v[176:179], v[32:35], 0
    v_exp_f32 v112, v112
    v_exp_f32 v113, v113
    v_exp_f32 v114, v114
    v_exp_f32 v115, v115
    v_cvt_pk_bf16_f32 v144, v112, v113
    v_mfma_f32_32x32x16_bf16 v[48:63], v[196:199], v[156:159], v[48:63]
    buffer_load_dwordx4 a[116:119], v2, s[20:23], s33 offen offset:1024 sc1
    v_cvt_pk_bf16_f32 v145, v114, v115
    v_exp_f32 v116, v116
    v_exp_f32 v117, v117
    v_exp_f32 v118, v118
    v_exp_f32 v119, v119
    v_cvt_pk_bf16_f32 v146, v116, v117
    v_mfma_f32_32x32x16_bf16 v[128:143], v[180:183], v[36:39], v[128:143]
    buffer_load_dwordx4 a[120:123], v2, s[20:23], s33 offen offset:2048 sc1
    v_cvt_pk_bf16_f32 v147, v118, v119
    v_exp_f32 v120, v120
    v_exp_f32 v121, v121
    v_exp_f32 v122, v122
    v_exp_f32 v123, v123
    v_cvt_pk_bf16_f32 v148, v120, v121
    v_mfma_f32_32x32x16_bf16 v[64:79], v[200:203], v[144:147], v[64:79]
    v_cvt_pk_bf16_f32 v149, v122, v123
    v_exp_f32 v124, v124
    v_exp_f32 v125, v125
    v_exp_f32 v126, v126
    v_exp_f32 v127, v127
    v_cvt_pk_bf16_f32 v150, v124, v125
    v_cvt_pk_bf16_f32 v151, v126, v127
    v_mfma_f32_32x32x16_bf16 v[112:127], v[176:179], v[40:43], 0
    buffer_load_dwordx4 v[192:195], v2, s[20:23], s31 offen offset:2048 sc1
    buffer_load_dwordx4 v[196:199], v2, s[20:23], s31 offen offset:3072 sc1
    v_exp_f32 v128, v128
    v_exp_f32 v129, v129
    v_exp_f32 v130, v130
    v_exp_f32 v131, v131
    v_cvt_pk_bf16_f32 v152, v128, v129
    v_mfma_f32_32x32x16_bf16 v[64:79], v[204:207], v[148:151], v[64:79]
    buffer_load_dwordx4 a[124:127], v2, s[20:23], s33 offen offset:3072 sc1
    v_cvt_pk_bf16_f32 v153, v130, v131
    v_exp_f32 v132, v132
    v_exp_f32 v133, v133
    v_exp_f32 v134, v134
    v_exp_f32 v135, v135
    v_cvt_pk_bf16_f32 v154, v132, v133
    v_mfma_f32_32x32x16_bf16 v[112:127], v[180:183], v[44:47], v[112:127]
    s_add_u32 s33, s33, 4096
    buffer_load_dwordx4 a[128:131], v2, s[20:23], s33 offen offset:0 sc1
    v_cvt_pk_bf16_f32 v155, v134, v135
    v_exp_f32 v136, v136
    v_exp_f32 v137, v137
    v_exp_f32 v138, v138
    v_exp_f32 v139, v139
    v_cvt_pk_bf16_f32 v156, v136, v137
    v_mfma_f32_32x32x16_bf16 v[80:95], v[200:203], v[152:155], v[80:95]
    s_xor_b32 s31, s32, 0x20000
    v_cvt_pk_bf16_f32 v157, v138, v139
    v_exp_f32 v140, v140
    v_exp_f32 v141, v141
    v_exp_f32 v142, v142
    v_exp_f32 v143, v143
    v_cvt_pk_bf16_f32 v158, v140, v141
    v_cvt_pk_bf16_f32 v159, v142, v143
    v_mfma_f32_32x32x16_bf16 v[128:143], v[176:179], v[16:19], 0
    v_exp_f32 v112, v112
    v_exp_f32 v113, v113
    v_exp_f32 v114, v114
    v_exp_f32 v115, v115
    v_cvt_pk_bf16_f32 v144, v112, v113
    v_mfma_f32_32x32x16_bf16 v[80:95], v[204:207], v[156:159], v[80:95]
    buffer_load_dwordx4 a[132:135], v2, s[20:23], s33 offen offset:1024 sc1
    v_cvt_pk_bf16_f32 v145, v114, v115
    v_exp_f32 v116, v116
    v_exp_f32 v117, v117
    v_exp_f32 v118, v118
    v_exp_f32 v119, v119
    v_cvt_pk_bf16_f32 v146, v116, v117
    v_mfma_f32_32x32x16_bf16 v[128:143], v[180:183], v[20:23], v[128:143]
    buffer_load_dwordx4 a[136:139], v2, s[20:23], s33 offen offset:2048 sc1
    v_cvt_pk_bf16_f32 v147, v118, v119
    v_exp_f32 v120, v120
    v_exp_f32 v121, v121
    v_exp_f32 v122, v122
    v_exp_f32 v123, v123
    v_cvt_pk_bf16_f32 v148, v120, v121
    v_mfma_f32_32x32x16_bf16 v[96:111], v[200:203], v[144:147], v[96:111]
    s_waitcnt vmcnt(15)
    v_cvt_pk_bf16_f32 v149, v122, v123
    v_exp_f32 v124, v124
    v_exp_f32 v125, v125
    v_exp_f32 v126, v126
    v_exp_f32 v127, v127
    v_cvt_pk_bf16_f32 v150, v124, v125
    v_cvt_pk_bf16_f32 v151, v126, v127
    v_mfma_f32_32x32x16_bf16 v[112:127], v[160:163], v[24:27], 0
    buffer_load_dwordx4 v[176:179], v2, s[20:23], s31 offen sc1
    buffer_load_dwordx4 v[180:183], v2, s[20:23], s31 offen offset:1024 sc1
    v_exp_f32 v128, v128
    v_exp_f32 v129, v129
    v_exp_f32 v130, v130
    v_exp_f32 v131, v131
    v_cvt_pk_bf16_f32 v152, v128, v129
    v_mfma_f32_32x32x16_bf16 v[96:111], v[204:207], v[148:151], v[96:111]
    v_cvt_pk_bf16_f32 v153, v130, v131
    v_exp_f32 v132, v132
    v_exp_f32 v133, v133
    v_exp_f32 v134, v134
    v_exp_f32 v135, v135
    v_cvt_pk_bf16_f32 v154, v132, v133
    v_mfma_f32_32x32x16_bf16 v[112:127], v[164:167], v[28:31], v[112:127]
    buffer_load_dwordx4 a[140:143], v2, s[20:23], s33 offen offset:3072 sc1
    v_cvt_pk_bf16_f32 v155, v134, v135
    v_exp_f32 v136, v136
    v_exp_f32 v137, v137
    v_exp_f32 v138, v138
    v_exp_f32 v139, v139
    v_cvt_pk_bf16_f32 v156, v136, v137
    v_mfma_f32_32x32x16_bf16 v[48:63], v[200:203], v[152:155], v[48:63]
    s_add_u32 s33, s33, 4096
    v_cvt_pk_bf16_f32 v157, v138, v139
    v_exp_f32 v140, v140
    v_exp_f32 v141, v141
    v_exp_f32 v142, v142
    v_exp_f32 v143, v143
    v_cvt_pk_bf16_f32 v158, v140, v141
    v_cvt_pk_bf16_f32 v159, v142, v143
    v_mfma_f32_32x32x16_bf16 v[128:143], v[160:163], v[32:35], 0
    v_exp_f32 v112, v112
    v_exp_f32 v113, v113
    v_exp_f32 v114, v114
    v_exp_f32 v115, v115
    v_cvt_pk_bf16_f32 v144, v112, v113
    v_mfma_f32_32x32x16_bf16 v[48:63], v[204:207], v[156:159], v[48:63]
    buffer_load_dwordx4 a[144:147], v2, s[20:23], s33 offen offset:0 sc1
    v_cvt_pk_bf16_f32 v145, v114, v115
    v_exp_f32 v116, v116
    v_exp_f32 v117, v117
    v_exp_f32 v118, v118
    v_exp_f32 v119, v119
    v_cvt_pk_bf16_f32 v146, v116, v117
    v_mfma_f32_32x32x16_bf16 v[128:143], v[164:167], v[36:39], v[128:143]
    buffer_load_dwordx4 a[148:151], v2, s[20:23], s33 offen offset:1024 sc1
    v_cvt_pk_bf16_f32 v147, v118, v119
    v_exp_f32 v120, v120
    v_exp_f32 v121, v121
    v_exp_f32 v122, v122
    v_exp_f32 v123, v123
    v_cvt_pk_bf16_f32 v148, v120, v121
    v_mfma_f32_32x32x16_bf16 v[64:79], v[184:187], v[144:147], v[64:79]
    v_cvt_pk_bf16_f32 v149, v122, v123
    v_exp_f32 v124, v124
    v_exp_f32 v125, v125
    v_exp_f32 v126, v126
    v_exp_f32 v127, v127
    v_cvt_pk_bf16_f32 v150, v124, v125
    v_cvt_pk_bf16_f32 v151, v126, v127
    v_mfma_f32_32x32x16_bf16 v[112:127], v[160:163], v[40:43], 0
    buffer_load_dwordx4 v[200:203], v2, s[20:23], s31 offen offset:2048 sc1
    buffer_load_dwordx4 v[204:207], v2, s[20:23], s31 offen offset:3072 sc1
    v_exp_f32 v128, v128
    v_exp_f32 v129, v129
    v_exp_f32 v130, v130
    v_exp_f32 v131, v131
    v_cvt_pk_bf16_f32 v152, v128, v129
    v_mfma_f32_32x32x16_bf16 v[64:79], v[188:191], v[148:151], v[64:79]
    buffer_load_dwordx4 a[152:155], v2, s[20:23], s33 offen offset:2048 sc1
    v_cvt_pk_bf16_f32 v153, v130, v131
    v_exp_f32 v132, v132
    v_exp_f32 v133, v133
    v_exp_f32 v134, v134
    v_exp_f32 v135, v135
    v_cvt_pk_bf16_f32 v154, v132, v133
    v_mfma_f32_32x32x16_bf16 v[112:127], v[164:167], v[44:47], v[112:127]
    buffer_load_dwordx4 a[156:159], v2, s[20:23], s33 offen offset:3072 sc1
    v_cvt_pk_bf16_f32 v155, v134, v135
    v_exp_f32 v136, v136
    v_exp_f32 v137, v137
    v_exp_f32 v138, v138
    v_exp_f32 v139, v139
    v_cvt_pk_bf16_f32 v156, v136, v137
    v_mfma_f32_32x32x16_bf16 v[80:95], v[184:187], v[152:155], v[80:95]
    s_xor_b32 s31, s32, 0x24000
    v_cvt_pk_bf16_f32 v157, v138, v139
    v_exp_f32 v140, v140
    v_exp_f32 v141, v141
    v_exp_f32 v142, v142
    v_exp_f32 v143, v143
    v_cvt_pk_bf16_f32 v158, v140, v141
    v_cvt_pk_bf16_f32 v159, v142, v143
    v_mfma_f32_32x32x16_bf16 v[128:143], v[160:163], v[16:19], 0
    s_add_u32 s33, s33, 4096
    v_exp_f32 v112, v112
    v_exp_f32 v113, v113
    v_exp_f32 v114, v114
    v_exp_f32 v115, v115
    v_cvt_pk_bf16_f32 v144, v112, v113
    v_mfma_f32_32x32x16_bf16 v[80:95], v[188:191], v[156:159], v[80:95]
    buffer_load_dwordx4 a[160:163], v2, s[20:23], s33 offen offset:0 sc1
    v_cvt_pk_bf16_f32 v145, v114, v115
    v_exp_f32 v116, v116
    v_exp_f32 v117, v117
    v_exp_f32 v118, v118
    v_exp_f32 v119, v119
    v_cvt_pk_bf16_f32 v146, v116, v117
    v_mfma_f32_32x32x16_bf16 v[128:143], v[164:167], v[20:23], v[128:143]
    buffer_load_dwordx4 a[164:167], v2, s[20:23], s33 offen offset:1024 sc1
    v_cvt_pk_bf16_f32 v147, v118, v119
    v_exp_f32 v120, v120
    v_exp_f32 v121, v121
    v_exp_f32 v122, v122
    v_exp_f32 v123, v123
    v_cvt_pk_bf16_f32 v148, v120, v121
    v_mfma_f32_32x32x16_bf16 v[96:111], v[184:187], v[144:147], v[96:111]
    s_waitcnt vmcnt(15)
    v_cvt_pk_bf16_f32 v149, v122, v123
    v_exp_f32 v124, v124
    v_exp_f32 v125, v125
    v_exp_f32 v126, v126
    v_exp_f32 v127, v127
    v_cvt_pk_bf16_f32 v150, v124, v125
    v_cvt_pk_bf16_f32 v151, v126, v127
    v_mfma_f32_32x32x16_bf16 v[112:127], v[168:171], v[24:27], 0
    buffer_load_dwordx4 v[160:163], v2, s[20:23], s31 offen sc1
    buffer_load_dwordx4 v[164:167], v2, s[20:23], s31 offen offset:1024 sc1
    v_exp_f32 v128, v128
    v_exp_f32 v129, v129
    v_exp_f32 v130, v130
    v_exp_f32 v131, v131
    v_cvt_pk_bf16_f32 v152, v128, v129
    v_mfma_f32_32x32x16_bf16 v[96:111], v[188:191], v[148:151], v[96:111]
    v_cvt_pk_bf16_f32 v153, v130, v131
    v_exp_f32 v132, v132
    v_exp_f32 v133, v133
    v_exp_f32 v134, v134
    v_exp_f32 v135, v135
    v_cvt_pk_bf16_f32 v154, v132, v133
    v_mfma_f32_32x32x16_bf16 v[112:127], v[172:175], v[28:31], v[112:127]
    buffer_load_dwordx4 a[168:171], v2, s[20:23], s33 offen offset:2048 sc1
    v_cvt_pk_bf16_f32 v155, v134, v135
    v_exp_f32 v136, v136
    v_exp_f32 v137, v137
    v_exp_f32 v138, v138
    v_exp_f32 v139, v139
    v_cvt_pk_bf16_f32 v156, v136, v137
    v_mfma_f32_32x32x16_bf16 v[48:63], v[184:187], v[152:155], v[48:63]
    v_cvt_pk_bf16_f32 v157, v138, v139
    v_exp_f32 v140, v140
    v_exp_f32 v141, v141
    v_exp_f32 v142, v142
    v_exp_f32 v143, v143
    v_cvt_pk_bf16_f32 v158, v140, v141
    v_cvt_pk_bf16_f32 v159, v142, v143
    v_mfma_f32_32x32x16_bf16 v[128:143], v[168:171], v[32:35], 0
    v_exp_f32 v112, v112
    v_exp_f32 v113, v113
    v_exp_f32 v114, v114
    v_exp_f32 v115, v115
    v_cvt_pk_bf16_f32 v144, v112, v113
    v_mfma_f32_32x32x16_bf16 v[48:63], v[188:191], v[156:159], v[48:63]
    buffer_load_dwordx4 a[172:175], v2, s[20:23], s33 offen offset:3072 sc1
    v_cvt_pk_bf16_f32 v145, v114, v115
    v_exp_f32 v116, v116
    v_exp_f32 v117, v117
    v_exp_f32 v118, v118
    v_exp_f32 v119, v119
    v_cvt_pk_bf16_f32 v146, v116, v117
    v_mfma_f32_32x32x16_bf16 v[128:143], v[172:175], v[36:39], v[128:143]
    s_add_u32 s33, s33, 4096
    buffer_load_dwordx4 a[176:179], v2, s[20:23], s33 offen offset:0 sc1
    v_cvt_pk_bf16_f32 v147, v118, v119
    v_exp_f32 v120, v120
    v_exp_f32 v121, v121
    v_exp_f32 v122, v122
    v_exp_f32 v123, v123
    v_cvt_pk_bf16_f32 v148, v120, v121
    v_mfma_f32_32x32x16_bf16 v[64:79], v[192:195], v[144:147], v[64:79]
    v_cvt_pk_bf16_f32 v149, v122, v123
    v_exp_f32 v124, v124
    v_exp_f32 v125, v125
    v_exp_f32 v126, v126
    v_exp_f32 v127, v127
    v_cvt_pk_bf16_f32 v150, v124, v125
    v_cvt_pk_bf16_f32 v151, v126, v127
    v_mfma_f32_32x32x16_bf16 v[112:127], v[168:171], v[40:43], 0
    buffer_load_dwordx4 v[184:187], v2, s[20:23], s31 offen offset:2048 sc1
    buffer_load_dwordx4 v[188:191], v2, s[20:23], s31 offen offset:3072 sc1
    v_exp_f32 v128, v128
    v_exp_f32 v129, v129
    v_exp_f32 v130, v130
    v_exp_f32 v131, v131
    v_cvt_pk_bf16_f32 v152, v128, v129
    v_mfma_f32_32x32x16_bf16 v[64:79], v[196:199], v[148:151], v[64:79]
    buffer_load_dwordx4 a[180:183], v2, s[20:23], s33 offen offset:1024 sc1
    v_cvt_pk_bf16_f32 v153, v130, v131
    v_exp_f32 v132, v132
    v_exp_f32 v133, v133
    v_exp_f32 v134, v134
    v_exp_f32 v135, v135
    v_cvt_pk_bf16_f32 v154, v132, v133
    v_mfma_f32_32x32x16_bf16 v[112:127], v[172:175], v[44:47], v[112:127]
    buffer_load_dwordx4 a[184:187], v2, s[20:23], s33 offen offset:2048 sc1
    v_cvt_pk_bf16_f32 v155, v134, v135
    v_exp_f32 v136, v136
    v_exp_f32 v137, v137
    v_exp_f32 v138, v138
    v_exp_f32 v139, v139
    v_cvt_pk_bf16_f32 v156, v136, v137
    v_mfma_f32_32x32x16_bf16 v[80:95], v[192:195], v[152:155], v[80:95]
    s_xor_b32 s31, s32, 0x28000
    v_cvt_pk_bf16_f32 v157, v138, v139
    v_exp_f32 v140, v140
    v_exp_f32 v141, v141
    v_exp_f32 v142, v142
    v_exp_f32 v143, v143
    v_cvt_pk_bf16_f32 v158, v140, v141
    v_cvt_pk_bf16_f32 v159, v142, v143
    v_mfma_f32_32x32x16_bf16 v[128:143], v[168:171], v[16:19], 0
    v_exp_f32 v112, v112
    v_exp_f32 v113, v113
    v_exp_f32 v114, v114
    v_exp_f32 v115, v115
    v_cvt_pk_bf16_f32 v144, v112, v113
    v_mfma_f32_32x32x16_bf16 v[80:95], v[196:199], v[156:159], v[80:95]
    buffer_load_dwordx4 a[188:191], v2, s[20:23], s33 offen offset:3072 sc1
    v_cvt_pk_bf16_f32 v145, v114, v115
    v_exp_f32 v116, v116
    v_exp_f32 v117, v117
    v_exp_f32 v118, v118
    v_exp_f32 v119, v119
    v_cvt_pk_bf16_f32 v146, v116, v117
    v_mfma_f32_32x32x16_bf16 v[128:143], v[172:175], v[20:23], v[128:143]
    s_add_u32 s33, s33, 4096
    buffer_load_dwordx4 a[192:195], v2, s[20:23], s33 offen offset:0 sc1
    v_cvt_pk_bf16_f32 v147, v118, v119
    v_exp_f32 v120, v120
    v_exp_f32 v121, v121
    v_exp_f32 v122, v122
    v_exp_f32 v123, v123
    v_cvt_pk_bf16_f32 v148, v120, v121
    v_mfma_f32_32x32x16_bf16 v[96:111], v[192:195], v[144:147], v[96:111]
    s_waitcnt vmcnt(15)
    v_cvt_pk_bf16_f32 v149, v122, v123
    v_exp_f32 v124, v124
    v_exp_f32 v125, v125
    v_exp_f32 v126, v126
    v_exp_f32 v127, v127
    v_cvt_pk_bf16_f32 v150, v124, v125
    v_cvt_pk_bf16_f32 v151, v126, v127
    v_mfma_f32_32x32x16_bf16 v[112:127], v[176:179], v[24:27], 0
    buffer_load_dwordx4 v[168:171], v2, s[20:23], s31 offen sc1
    buffer_load_dwordx4 v[172:175], v2, s[20:23], s31 offen offset:1024 sc1
    v_exp_f32 v128, v128
    v_exp_f32 v129, v129
    v_exp_f32 v130, v130
    v_exp_f32 v131, v131
    v_cvt_pk_bf16_f32 v152, v128, v129
    v_mfma_f32_32x32x16_bf16 v[96:111], v[196:199], v[148:151], v[96:111]
    v_cvt_pk_bf16_f32 v153, v130, v131
    v_exp_f32 v132, v132
    v_exp_f32 v133, v133
    v_exp_f32 v134, v134
    v_exp_f32 v135, v135
    v_cvt_pk_bf16_f32 v154, v132, v133
    v_mfma_f32_32x32x16_bf16 v[112:127], v[180:183], v[28:31], v[112:127]
    buffer_load_dwordx4 a[196:199], v2, s[20:23], s33 offen offset:1024 sc1
    v_cvt_pk_bf16_f32 v155, v134, v135
    v_exp_f32 v136, v136
    v_exp_f32 v137, v137
    v_exp_f32 v138, v138
    v_exp_f32 v139, v139
    v_cvt_pk_bf16_f32 v156, v136, v137
    v_mfma_f32_32x32x16_bf16 v[48:63], v[192:195], v[152:155], v[48:63]
    v_cvt_pk_bf16_f32 v157, v138, v139
    v_exp_f32 v140, v140
    v_exp_f32 v141, v141
    v_exp_f32 v142, v142
    v_exp_f32 v143, v143
    v_cvt_pk_bf16_f32 v158, v140, v141
    v_cvt_pk_bf16_f32 v159, v142, v143
    v_mfma_f32_32x32x16_bf16 v[128:143], v[176:179], v[32:35], 0
    v_exp_f32 v112, v112
    v_exp_f32 v113, v113
    v_exp_f32 v114, v114
    v_exp_f32 v115, v115
    v_cvt_pk_bf16_f32 v144, v112, v113
    v_mfma_f32_32x32x16_bf16 v[48:63], v[196:199], v[156:159], v[48:63]
    buffer_load_dwordx4 a[200:203], v2, s[20:23], s33 offen offset:2048 sc1
    v_cvt_pk_bf16_f32 v145, v114, v115
    v_exp_f32 v116, v116
    v_exp_f32 v117, v117
    v_exp_f32 v118, v118
    v_exp_f32 v119, v119
    v_cvt_pk_bf16_f32 v146, v116, v117
    v_mfma_f32_32x32x16_bf16 v[128:143], v[180:183], v[36:39], v[128:143]
    buffer_load_dwordx4 a[204:207], v2, s[20:23], s33 offen offset:3072 sc1
    v_cvt_pk_bf16_f32 v147, v118, v119
    v_exp_f32 v120, v120
    v_exp_f32 v121, v121
    v_exp_f32 v122, v122
    v_exp_f32 v123, v123
    v_cvt_pk_bf16_f32 v148, v120, v121
    v_mfma_f32_32x32x16_bf16 v[64:79], v[200:203], v[144:147], v[64:79]
    s_add_u32 s33, s33, 4096
    v_cvt_pk_bf16_f32 v149, v122, v123
    v_exp_f32 v124, v124
    v_exp_f32 v125, v125
    v_exp_f32 v126, v126
    v_exp_f32 v127, v127
    v_cvt_pk_bf16_f32 v150, v124, v125
    v_cvt_pk_bf16_f32 v151, v126, v127
    v_mfma_f32_32x32x16_bf16 v[112:127], v[176:179], v[40:43], 0
    buffer_load_dwordx4 v[192:195], v2, s[20:23], s31 offen offset:2048 sc1
    buffer_load_dwordx4 v[196:199], v2, s[20:23], s31 offen offset:3072 sc1
    v_exp_f32 v128, v128
    v_exp_f32 v129, v129
    v_exp_f32 v130, v130
    v_exp_f32 v131, v131
    v_cvt_pk_bf16_f32 v152, v128, v129
    v_mfma_f32_32x32x16_bf16 v[64:79], v[204:207], v[148:151], v[64:79]
    buffer_load_dwordx4 a[208:211], v2, s[20:23], s33 offen offset:0 sc1
    v_cvt_pk_bf16_f32 v153, v130, v131
    v_exp_f32 v132, v132
    v_exp_f32 v133, v133
    v_exp_f32 v134, v134
    v_exp_f32 v135, v135
    v_cvt_pk_bf16_f32 v154, v132, v133
    v_mfma_f32_32x32x16_bf16 v[112:127], v[180:183], v[44:47], v[112:127]
    buffer_load_dwordx4 a[212:215], v2, s[20:23], s33 offen offset:1024 sc1
    v_cvt_pk_bf16_f32 v155, v134, v135
    v_exp_f32 v136, v136
    v_exp_f32 v137, v137
    v_exp_f32 v138, v138
    v_exp_f32 v139, v139
    v_cvt_pk_bf16_f32 v156, v136, v137
    v_mfma_f32_32x32x16_bf16 v[80:95], v[200:203], v[152:155], v[80:95]
    s_xor_b32 s31, s32, 0x2c000
    v_cvt_pk_bf16_f32 v157, v138, v139
    v_exp_f32 v140, v140
    v_exp_f32 v141, v141
    v_exp_f32 v142, v142
    v_exp_f32 v143, v143
    v_cvt_pk_bf16_f32 v158, v140, v141
    v_cvt_pk_bf16_f32 v159, v142, v143
    v_mfma_f32_32x32x16_bf16 v[128:143], v[176:179], v[16:19], 0
    v_exp_f32 v112, v112
    v_exp_f32 v113, v113
    v_exp_f32 v114, v114
    v_exp_f32 v115, v115
    v_cvt_pk_bf16_f32 v144, v112, v113
    v_mfma_f32_32x32x16_bf16 v[80:95], v[204:207], v[156:159], v[80:95]
    buffer_load_dwordx4 a[216:219], v2, s[20:23], s33 offen offset:2048 sc1
    v_cvt_pk_bf16_f32 v145, v114, v115
    v_exp_f32 v116, v116
    v_exp_f32 v117, v117
    v_exp_f32 v118, v118
    v_exp_f32 v119, v119
    v_cvt_pk_bf16_f32 v146, v116, v117
    v_mfma_f32_32x32x16_bf16 v[128:143], v[180:183], v[20:23], v[128:143]
    buffer_load_dwordx4 a[220:223], v2, s[20:23], s33 offen offset:3072 sc1
    v_cvt_pk_bf16_f32 v147, v118, v119
    v_exp_f32 v120, v120
    v_exp_f32 v121, v121
    v_exp_f32 v122, v122
    v_exp_f32 v123, v123
    v_cvt_pk_bf16_f32 v148, v120, v121
    v_mfma_f32_32x32x16_bf16 v[96:111], v[200:203], v[144:147], v[96:111]
    s_waitcnt vmcnt(15)
    v_cvt_pk_bf16_f32 v149, v122, v123
    v_exp_f32 v124, v124
    v_exp_f32 v125, v125
    v_exp_f32 v126, v126
    v_exp_f32 v127, v127
    v_cvt_pk_bf16_f32 v150, v124, v125
    v_cvt_pk_bf16_f32 v151, v126, v127
    v_mfma_f32_32x32x16_bf16 v[112:127], v[160:163], v[24:27], 0
    buffer_load_dwordx4 v[176:179], v2, s[20:23], s31 offen sc1
    buffer_load_dwordx4 v[180:183], v2, s[20:23], s31 offen offset:1024 sc1
    v_exp_f32 v128, v128
    v_exp_f32 v129, v129
    v_exp_f32 v130, v130
    v_exp_f32 v131, v131
    v_cvt_pk_bf16_f32 v152, v128, v129
    v_mfma_f32_32x32x16_bf16 v[96:111], v[204:207], v[148:151], v[96:111]
    s_add_u32 s33, s33, 4096
    v_cvt_pk_bf16_f32 v153, v130, v131
    v_exp_f32 v132, v132
    v_exp_f32 v133, v133
    v_exp_f32 v134, v134
    v_exp_f32 v135, v135
    v_cvt_pk_bf16_f32 v154, v132, v133
    v_mfma_f32_32x32x16_bf16 v[112:127], v[164:167], v[28:31], v[112:127]
    buffer_load_dwordx4 a[224:227], v2, s[20:23], s33 offen offset:0 sc1
    v_cvt_pk_bf16_f32 v155, v134, v135
    v_exp_f32 v136, v136
    v_exp_f32 v137, v137
    v_exp_f32 v138, v138
    v_exp_f32 v139, v139
    v_cvt_pk_bf16_f32 v156, v136, v137
    v_mfma_f32_32x32x16_bf16 v[48:63], v[200:203], v[152:155], v[48:63]
    v_cvt_pk_bf16_f32 v157, v138, v139
    v_exp_f32 v140, v140
    v_exp_f32 v141, v141
    v_exp_f32 v142, v142
    v_exp_f32 v143, v143
    v_cvt_pk_bf16_f32 v158, v140, v141
    v_cvt_pk_bf16_f32 v159, v142, v143
    v_mfma_f32_32x32x16_bf16 v[128:143], v[160:163], v[32:35], 0
    v_exp_f32 v112, v112
    v_exp_f32 v113, v113
    v_exp_f32 v114, v114
    v_exp_f32 v115, v115
    v_cvt_pk_bf16_f32 v144, v112, v113
    v_mfma_f32_32x32x16_bf16 v[48:63], v[204:207], v[156:159], v[48:63]
    buffer_load_dwordx4 a[228:231], v2, s[20:23], s33 offen offset:1024 sc1
    v_cvt_pk_bf16_f32 v145, v114, v115
    v_exp_f32 v116, v116
    v_exp_f32 v117, v117
    v_exp_f32 v118, v118
    v_exp_f32 v119, v119
    v_cvt_pk_bf16_f32 v146, v116, v117
    v_mfma_f32_32x32x16_bf16 v[128:143], v[164:167], v[36:39], v[128:143]
    buffer_load_dwordx4 a[232:235], v2, s[20:23], s33 offen offset:2048 sc1
    v_cvt_pk_bf16_f32 v147, v118, v119
    v_exp_f32 v120, v120
    v_exp_f32 v121, v121
    v_exp_f32 v122, v122
    v_exp_f32 v123, v123
    v_cvt_pk_bf16_f32 v148, v120, v121
    v_mfma_f32_32x32x16_bf16 v[64:79], v[184:187], v[144:147], v[64:79]
    v_cvt_pk_bf16_f32 v149, v122, v123
    v_exp_f32 v124, v124
    v_exp_f32 v125, v125
    v_exp_f32 v126, v126
    v_exp_f32 v127, v127
    v_cvt_pk_bf16_f32 v150, v124, v125
    v_cvt_pk_bf16_f32 v151, v126, v127
    v_mfma_f32_32x32x16_bf16 v[112:127], v[160:163], v[40:43], 0
    buffer_load_dwordx4 v[200:203], v2, s[20:23], s31 offen offset:2048 sc1
    buffer_load_dwordx4 v[204:207], v2, s[20:23], s31 offen offset:3072 sc1
    v_exp_f32 v128, v128
    v_exp_f32 v129, v129
    v_exp_f32 v130, v130
    v_exp_f32 v131, v131
    v_cvt_pk_bf16_f32 v152, v128, v129
    v_mfma_f32_32x32x16_bf16 v[64:79], v[188:191], v[148:151], v[64:79]
    buffer_load_dwordx4 a[236:239], v2, s[20:23], s33 offen offset:3072 sc1
    v_cvt_pk_bf16_f32 v153, v130, v131
    v_exp_f32 v132, v132
    v_exp_f32 v133, v133
    v_exp_f32 v134, v134
    v_exp_f32 v135, v135
    v_cvt_pk_bf16_f32 v154, v132, v133
    v_mfma_f32_32x32x16_bf16 v[112:127], v[164:167], v[44:47], v[112:127]
    s_add_u32 s33, s33, 4096
    buffer_load_dwordx4 a[240:243], v2, s[20:23], s33 offen offset:0 sc1
    v_cvt_pk_bf16_f32 v155, v134, v135
    v_exp_f32 v136, v136
    v_exp_f32 v137, v137
    v_exp_f32 v138, v138
    v_exp_f32 v139, v139
    v_cvt_pk_bf16_f32 v156, v136, v137
    v_mfma_f32_32x32x16_bf16 v[80:95], v[184:187], v[152:155], v[80:95]
    s_xor_b32 s31, s32, 0x30000
    v_cvt_pk_bf16_f32 v157, v138, v139
    v_exp_f32 v140, v140
    v_exp_f32 v141, v141
    v_exp_f32 v142, v142
    v_exp_f32 v143, v143
    v_cvt_pk_bf16_f32 v158, v140, v141
    v_cvt_pk_bf16_f32 v159, v142, v143
    v_mfma_f32_32x32x16_bf16 v[128:143], v[160:163], v[16:19], 0
    v_exp_f32 v112, v112
    v_exp_f32 v113, v113
    v_exp_f32 v114, v114
    v_exp_f32 v115, v115
    v_cvt_pk_bf16_f32 v144, v112, v113
    v_mfma_f32_32x32x16_bf16 v[80:95], v[188:191], v[156:159], v[80:95]
    buffer_load_dwordx4 a[244:247], v2, s[20:23], s33 offen offset:1024 sc1
    v_cvt_pk_bf16_f32 v145, v114, v115
    v_exp_f32 v116, v116
    v_exp_f32 v117, v117
    v_exp_f32 v118, v118
    v_exp_f32 v119, v119
    v_cvt_pk_bf16_f32 v146, v116, v117
    v_mfma_f32_32x32x16_bf16 v[128:143], v[164:167], v[20:23], v[128:143]
    buffer_load_dwordx4 a[248:251], v2, s[20:23], s33 offen offset:2048 sc1
    v_cvt_pk_bf16_f32 v147, v118, v119
    v_exp_f32 v120, v120
    v_exp_f32 v121, v121
    v_exp_f32 v122, v122
    v_exp_f32 v123, v123
    v_cvt_pk_bf16_f32 v148, v120, v121
    v_mfma_f32_32x32x16_bf16 v[96:111], v[184:187], v[144:147], v[96:111]
    s_waitcnt vmcnt(15)
    v_cvt_pk_bf16_f32 v149, v122, v123
    v_exp_f32 v124, v124
    v_exp_f32 v125, v125
    v_exp_f32 v126, v126
    v_exp_f32 v127, v127
    v_cvt_pk_bf16_f32 v150, v124, v125
    v_cvt_pk_bf16_f32 v151, v126, v127
    v_mfma_f32_32x32x16_bf16 v[112:127], v[168:171], v[24:27], 0
    buffer_load_dwordx4 v[160:163], v2, s[20:23], s31 offen sc1
    buffer_load_dwordx4 v[164:167], v2, s[20:23], s31 offen offset:1024 sc1
    v_exp_f32 v128, v128
    v_exp_f32 v129, v129
    v_exp_f32 v130, v130
    v_exp_f32 v131, v131
    v_cvt_pk_bf16_f32 v152, v128, v129
    v_mfma_f32_32x32x16_bf16 v[96:111], v[188:191], v[148:151], v[96:111]
    v_cvt_pk_bf16_f32 v153, v130, v131
    v_exp_f32 v132, v132
    v_exp_f32 v133, v133
    v_exp_f32 v134, v134
    v_exp_f32 v135, v135
    v_cvt_pk_bf16_f32 v154, v132, v133
    v_mfma_f32_32x32x16_bf16 v[112:127], v[172:175], v[28:31], v[112:127]
    buffer_load_dwordx4 a[252:255], v2, s[20:23], s33 offen offset:3072 sc1
    v_cvt_pk_bf16_f32 v155, v134, v135
    v_exp_f32 v136, v136
    v_exp_f32 v137, v137
    v_exp_f32 v138, v138
    v_exp_f32 v139, v139
    v_cvt_pk_bf16_f32 v156, v136, v137
    v_mfma_f32_32x32x16_bf16 v[48:63], v[184:187], v[152:155], v[48:63]
    s_add_u32 s33, s33, 4096
    v_cvt_pk_bf16_f32 v157, v138, v139
    v_exp_f32 v140, v140
    v_exp_f32 v141, v141
    v_exp_f32 v142, v142
    v_exp_f32 v143, v143
    v_cvt_pk_bf16_f32 v158, v140, v141
    v_cvt_pk_bf16_f32 v159, v142, v143
    v_mfma_f32_32x32x16_bf16 v[128:143], v[168:171], v[32:35], 0
    v_exp_f32 v112, v112
    v_exp_f32 v113, v113
    v_exp_f32 v114, v114
    v_exp_f32 v115, v115
    v_cvt_pk_bf16_f32 v144, v112, v113
    v_mfma_f32_32x32x16_bf16 v[48:63], v[188:191], v[156:159], v[48:63]
    buffer_load_dwordx4 v[224:227], v2, s[20:23], s33 offen offset:0 sc1
    v_cvt_pk_bf16_f32 v145, v114, v115
    v_exp_f32 v116, v116
    v_exp_f32 v117, v117
    v_exp_f32 v118, v118
    v_exp_f32 v119, v119
    v_cvt_pk_bf16_f32 v146, v116, v117
    v_mfma_f32_32x32x16_bf16 v[128:143], v[172:175], v[36:39], v[128:143]
    buffer_load_dwordx4 v[228:231], v2, s[20:23], s33 offen offset:1024 sc1
    v_cvt_pk_bf16_f32 v147, v118, v119
    v_exp_f32 v120, v120
    v_exp_f32 v121, v121
    v_exp_f32 v122, v122
    v_exp_f32 v123, v123
    v_cvt_pk_bf16_f32 v148, v120, v121
    v_mfma_f32_32x32x16_bf16 v[64:79], v[192:195], v[144:147], v[64:79]
    v_cvt_pk_bf16_f32 v149, v122, v123
    v_exp_f32 v124, v124
    v_exp_f32 v125, v125
    v_exp_f32 v126, v126
    v_exp_f32 v127, v127
    v_cvt_pk_bf16_f32 v150, v124, v125
    v_cvt_pk_bf16_f32 v151, v126, v127
    v_mfma_f32_32x32x16_bf16 v[112:127], v[168:171], v[40:43], 0
    buffer_load_dwordx4 v[184:187], v2, s[20:23], s31 offen offset:2048 sc1
    buffer_load_dwordx4 v[188:191], v2, s[20:23], s31 offen offset:3072 sc1
    v_exp_f32 v128, v128
    v_exp_f32 v129, v129
    v_exp_f32 v130, v130
    v_exp_f32 v131, v131
    v_cvt_pk_bf16_f32 v152, v128, v129
    v_mfma_f32_32x32x16_bf16 v[64:79], v[196:199], v[148:151], v[64:79]
    buffer_load_dwordx4 v[232:235], v2, s[20:23], s33 offen offset:2048 sc1
    v_cvt_pk_bf16_f32 v153, v130, v131
    v_exp_f32 v132, v132
    v_exp_f32 v133, v133
    v_exp_f32 v134, v134
    v_exp_f32 v135, v135
    v_cvt_pk_bf16_f32 v154, v132, v133
    v_mfma_f32_32x32x16_bf16 v[112:127], v[172:175], v[44:47], v[112:127]
    buffer_load_dwordx4 v[236:239], v2, s[20:23], s33 offen offset:3072 sc1
    v_cvt_pk_bf16_f32 v155, v134, v135
    v_exp_f32 v136, v136
    v_exp_f32 v137, v137
    v_exp_f32 v138, v138
    v_exp_f32 v139, v139
    v_cvt_pk_bf16_f32 v156, v136, v137
    v_mfma_f32_32x32x16_bf16 v[80:95], v[192:195], v[152:155], v[80:95]
    s_xor_b32 s31, s32, 0x34000
    v_cvt_pk_bf16_f32 v157, v138, v139
    v_exp_f32 v140, v140
    v_exp_f32 v141, v141
    v_exp_f32 v142, v142
    v_exp_f32 v143, v143
    v_cvt_pk_bf16_f32 v158, v140, v141
    v_cvt_pk_bf16_f32 v159, v142, v143
    v_mfma_f32_32x32x16_bf16 v[128:143], v[168:171], v[16:19], 0
    s_add_u32 s33, s33, 4096
    v_exp_f32 v112, v112
    v_exp_f32 v113, v113
    v_exp_f32 v114, v114
    v_exp_f32 v115, v115
    v_cvt_pk_bf16_f32 v144, v112, v113
    v_mfma_f32_32x32x16_bf16 v[80:95], v[196:199], v[156:159], v[80:95]
    buffer_load_dwordx4 v[240:243], v2, s[20:23], s33 offen offset:0 sc1
    v_cvt_pk_bf16_f32 v145, v114, v115
    v_exp_f32 v116, v116
    v_exp_f32 v117, v117
    v_exp_f32 v118, v118
    v_exp_f32 v119, v119
    v_cvt_pk_bf16_f32 v146, v116, v117
    v_mfma_f32_32x32x16_bf16 v[128:143], v[172:175], v[20:23], v[128:143]
    buffer_load_dwordx4 v[244:247], v2, s[20:23], s33 offen offset:1024 sc1
    v_cvt_pk_bf16_f32 v147, v118, v119
    v_exp_f32 v120, v120
    v_exp_f32 v121, v121
    v_exp_f32 v122, v122
    v_exp_f32 v123, v123
    v_cvt_pk_bf16_f32 v148, v120, v121
    v_mfma_f32_32x32x16_bf16 v[96:111], v[192:195], v[144:147], v[96:111]
    s_waitcnt vmcnt(15)
    v_cvt_pk_bf16_f32 v149, v122, v123
    v_exp_f32 v124, v124
    v_exp_f32 v125, v125
    v_exp_f32 v126, v126
    v_exp_f32 v127, v127
    v_cvt_pk_bf16_f32 v150, v124, v125
    v_cvt_pk_bf16_f32 v151, v126, v127
    v_mfma_f32_32x32x16_bf16 v[112:127], v[176:179], v[24:27], 0
    buffer_load_dwordx4 v[168:171], v2, s[20:23], s31 offen sc1
    buffer_load_dwordx4 v[172:175], v2, s[20:23], s31 offen offset:1024 sc1
    v_exp_f32 v128, v128
    v_exp_f32 v129, v129
    v_exp_f32 v130, v130
    v_exp_f32 v131, v131
    v_cvt_pk_bf16_f32 v152, v128, v129
    v_mfma_f32_32x32x16_bf16 v[96:111], v[196:199], v[148:151], v[96:111]
    v_cvt_pk_bf16_f32 v153, v130, v131
    v_exp_f32 v132, v132
    v_exp_f32 v133, v133
    v_exp_f32 v134, v134
    v_exp_f32 v135, v135
    v_cvt_pk_bf16_f32 v154, v132, v133
    v_mfma_f32_32x32x16_bf16 v[112:127], v[180:183], v[28:31], v[112:127]
    buffer_load_dwordx4 v[248:251], v2, s[20:23], s33 offen offset:2048 sc1
    v_cvt_pk_bf16_f32 v155, v134, v135
    v_exp_f32 v136, v136
    v_exp_f32 v137, v137
    v_exp_f32 v138, v138
    v_exp_f32 v139, v139
    v_cvt_pk_bf16_f32 v156, v136, v137
    v_mfma_f32_32x32x16_bf16 v[48:63], v[192:195], v[152:155], v[48:63]
    v_cvt_pk_bf16_f32 v157, v138, v139
    v_exp_f32 v140, v140
    v_exp_f32 v141, v141
    v_exp_f32 v142, v142
    v_exp_f32 v143, v143
    v_cvt_pk_bf16_f32 v158, v140, v141
    v_cvt_pk_bf16_f32 v159, v142, v143
    v_mfma_f32_32x32x16_bf16 v[128:143], v[176:179], v[32:35], 0
    v_exp_f32 v112, v112
    v_exp_f32 v113, v113
    v_exp_f32 v114, v114
    v_exp_f32 v115, v115
    v_cvt_pk_bf16_f32 v144, v112, v113
    v_mfma_f32_32x32x16_bf16 v[48:63], v[196:199], v[156:159], v[48:63]
    buffer_load_dwordx4 v[252:255], v2, s[20:23], s33 offen offset:3072 sc1
    v_cvt_pk_bf16_f32 v145, v114, v115
    v_exp_f32 v116, v116
    v_exp_f32 v117, v117
    v_exp_f32 v118, v118
    v_exp_f32 v119, v119
    v_cvt_pk_bf16_f32 v146, v116, v117
    v_mfma_f32_32x32x16_bf16 v[128:143], v[180:183], v[36:39], v[128:143]
    buffer_load_dwordx4 v2, s[20:23], s34 offen offset:0 sc1 lds
    v_cvt_pk_bf16_f32 v147, v118, v119
    v_exp_f32 v120, v120
    v_exp_f32 v121, v121
    v_exp_f32 v122, v122
    v_exp_f32 v123, v123
    v_cvt_pk_bf16_f32 v148, v120, v121
    v_mfma_f32_32x32x16_bf16 v[64:79], v[200:203], v[144:147], v[64:79]
    s_add_u32 s33, s33, 4096
    v_cvt_pk_bf16_f32 v149, v122, v123
    v_exp_f32 v124, v124
    v_exp_f32 v125, v125
    v_exp_f32 v126, v126
    v_exp_f32 v127, v127
    v_cvt_pk_bf16_f32 v150, v124, v125
    v_cvt_pk_bf16_f32 v151, v126, v127
    v_mfma_f32_32x32x16_bf16 v[112:127], v[176:179], v[40:43], 0
    buffer_load_dwordx4 v[192:195], v2, s[20:23], s31 offen offset:2048 sc1
    buffer_load_dwordx4 v[196:199], v2, s[20:23], s31 offen offset:3072 sc1
    v_exp_f32 v128, v128
    v_exp_f32 v129, v129
    v_exp_f32 v130, v130
    v_exp_f32 v131, v131
    v_cvt_pk_bf16_f32 v152, v128, v129
    v_mfma_f32_32x32x16_bf16 v[64:79], v[204:207], v[148:151], v[64:79]
    buffer_load_dwordx4 v2, s[20:23], s34 offen offset:1024 sc1 lds
    v_cvt_pk_bf16_f32 v153, v130, v131
    v_exp_f32 v132, v132
    v_exp_f32 v133, v133
    v_exp_f32 v134, v134
    v_exp_f32 v135, v135
    v_cvt_pk_bf16_f32 v154, v132, v133
    v_mfma_f32_32x32x16_bf16 v[112:127], v[180:183], v[44:47], v[112:127]
    buffer_load_dwordx4 v2, s[20:23], s34 offen offset:2048 sc1 lds
    v_cvt_pk_bf16_f32 v155, v134, v135
    v_exp_f32 v136, v136
    v_exp_f32 v137, v137
    v_exp_f32 v138, v138
    v_exp_f32 v139, v139
    v_cvt_pk_bf16_f32 v156, v136, v137
    v_mfma_f32_32x32x16_bf16 v[80:95], v[200:203], v[152:155], v[80:95]
    s_xor_b32 s31, s32, 0x38000
    v_cvt_pk_bf16_f32 v157, v138, v139
    v_exp_f32 v140, v140
    v_exp_f32 v141, v141
    v_exp_f32 v142, v142
    v_exp_f32 v143, v143
    v_cvt_pk_bf16_f32 v158, v140, v141
    v_cvt_pk_bf16_f32 v159, v142, v143
    v_mfma_f32_32x32x16_bf16 v[128:143], v[176:179], v[16:19], 0
    v_exp_f32 v112, v112
    v_exp_f32 v113, v113
    v_exp_f32 v114, v114
    v_exp_f32 v115, v115
    v_cvt_pk_bf16_f32 v144, v112, v113
    v_mfma_f32_32x32x16_bf16 v[80:95], v[204:207], v[156:159], v[80:95]
    buffer_load_dwordx4 v2, s[20:23], s34 offen offset:3072 sc1 lds
    v_cvt_pk_bf16_f32 v145, v114, v115
    v_exp_f32 v116, v116
    v_exp_f32 v117, v117
    v_exp_f32 v118, v118
    v_exp_f32 v119, v119
    v_cvt_pk_bf16_f32 v146, v116, v117
    v_mfma_f32_32x32x16_bf16 v[128:143], v[180:183], v[20:23], v[128:143]
    s_add_u32 m0, m0, 16384
    s_add_u32 s34, s34, 16384
    buffer_load_dwordx4 v2, s[20:23], s34 offen offset:0 sc1 lds
    v_cvt_pk_bf16_f32 v147, v118, v119
    v_exp_f32 v120, v120
    v_exp_f32 v121, v121
    v_exp_f32 v122, v122
    v_exp_f32 v123, v123
    v_cvt_pk_bf16_f32 v148, v120, v121
    v_mfma_f32_32x32x16_bf16 v[96:111], v[200:203], v[144:147], v[96:111]
    s_waitcnt vmcnt(15)
    v_cvt_pk_bf16_f32 v149, v122, v123
    v_exp_f32 v124, v124
    v_exp_f32 v125, v125
    v_exp_f32 v126, v126
    v_exp_f32 v127, v127
    v_cvt_pk_bf16_f32 v150, v124, v125
    v_cvt_pk_bf16_f32 v151, v126, v127
    v_mfma_f32_32x32x16_bf16 v[112:127], v[160:163], v[24:27], 0
    buffer_load_dwordx4 v[176:179], v2, s[20:23], s31 offen sc1
    buffer_load_dwordx4 v[180:183], v2, s[20:23], s31 offen offset:1024 sc1
    v_exp_f32 v128, v128
    v_exp_f32 v129, v129
    v_exp_f32 v130, v130
    v_exp_f32 v131, v131
    v_cvt_pk_bf16_f32 v152, v128, v129
    v_mfma_f32_32x32x16_bf16 v[96:111], v[204:207], v[148:151], v[96:111]
    v_cvt_pk_bf16_f32 v153, v130, v131
    v_exp_f32 v132, v132
    v_exp_f32 v133, v133
    v_exp_f32 v134, v134
    v_exp_f32 v135, v135
    v_cvt_pk_bf16_f32 v154, v132, v133
    v_mfma_f32_32x32x16_bf16 v[112:127], v[164:167], v[28:31], v[112:127]
    buffer_load_dwordx4 v2, s[20:23], s34 offen offset:1024 sc1 lds
    v_cvt_pk_bf16_f32 v155, v134, v135
    v_exp_f32 v136, v136
    v_exp_f32 v137, v137
    v_exp_f32 v138, v138
    v_exp_f32 v139, v139
    v_cvt_pk_bf16_f32 v156, v136, v137
    v_mfma_f32_32x32x16_bf16 v[48:63], v[200:203], v[152:155], v[48:63]
    v_cvt_pk_bf16_f32 v157, v138, v139
    v_exp_f32 v140, v140
    v_exp_f32 v141, v141
    v_exp_f32 v142, v142
    v_exp_f32 v143, v143
    v_cvt_pk_bf16_f32 v158, v140, v141
    v_cvt_pk_bf16_f32 v159, v142, v143
    v_mfma_f32_32x32x16_bf16 v[128:143], v[160:163], v[32:35], 0
    v_exp_f32 v112, v112
    v_exp_f32 v113, v113
    v_exp_f32 v114, v114
    v_exp_f32 v115, v115
    v_cvt_pk_bf16_f32 v144, v112, v113
    v_mfma_f32_32x32x16_bf16 v[48:63], v[204:207], v[156:159], v[48:63]
    buffer_load_dwordx4 v2, s[20:23], s34 offen offset:2048 sc1 lds
    v_cvt_pk_bf16_f32 v145, v114, v115
    v_exp_f32 v116, v116
    v_exp_f32 v117, v117
    v_exp_f32 v118, v118
    v_exp_f32 v119, v119
    v_cvt_pk_bf16_f32 v146, v116, v117
    v_mfma_f32_32x32x16_bf16 v[128:143], v[164:167], v[36:39], v[128:143]
    buffer_load_dwordx4 v2, s[20:23], s34 offen offset:3072 sc1 lds
    v_cvt_pk_bf16_f32 v147, v118, v119
    v_exp_f32 v120, v120
    v_exp_f32 v121, v121
    v_exp_f32 v122, v122
    v_exp_f32 v123, v123
    v_cvt_pk_bf16_f32 v148, v120, v121
    v_mfma_f32_32x32x16_bf16 v[64:79], v[184:187], v[144:147], v[64:79]
    s_add_u32 m0, m0, 16384
    v_cvt_pk_bf16_f32 v149, v122, v123
    v_exp_f32 v124, v124
    v_exp_f32 v125, v125
    v_exp_f32 v126, v126
    v_exp_f32 v127, v127
    v_cvt_pk_bf16_f32 v150, v124, v125
    v_cvt_pk_bf16_f32 v151, v126, v127
    v_mfma_f32_32x32x16_bf16 v[112:127], v[160:163], v[40:43], 0
    buffer_load_dwordx4 v[200:203], v2, s[20:23], s31 offen offset:2048 sc1
    buffer_load_dwordx4 v[204:207], v2, s[20:23], s31 offen offset:3072 sc1
    v_exp_f32 v128, v128
    v_exp_f32 v129, v129
    v_exp_f32 v130, v130
    v_exp_f32 v131, v131
    v_cvt_pk_bf16_f32 v152, v128, v129
    v_mfma_f32_32x32x16_bf16 v[64:79], v[188:191], v[148:151], v[64:79]
    s_add_u32 s34, s34, 16384
    buffer_load_dwordx4 v2, s[20:23], s34 offen offset:0 sc1 lds
    v_cvt_pk_bf16_f32 v153, v130, v131
    v_exp_f32 v132, v132
    v_exp_f32 v133, v133
    v_exp_f32 v134, v134
    v_exp_f32 v135, v135
    v_cvt_pk_bf16_f32 v154, v132, v133
    v_mfma_f32_32x32x16_bf16 v[112:127], v[164:167], v[44:47], v[112:127]
    buffer_load_dwordx4 v2, s[20:23], s34 offen offset:1024 sc1 lds
    v_cvt_pk_bf16_f32 v155, v134, v135
    v_exp_f32 v136, v136
    v_exp_f32 v137, v137
    v_exp_f32 v138, v138
    v_exp_f32 v139, v139
    v_cvt_pk_bf16_f32 v156, v136, v137
    v_mfma_f32_32x32x16_bf16 v[80:95], v[184:187], v[152:155], v[80:95]
    s_xor_b32 s31, s32, 0x3c000
    v_cvt_pk_bf16_f32 v157, v138, v139
    v_exp_f32 v140, v140
    v_exp_f32 v141, v141
    v_exp_f32 v142, v142
    v_exp_f32 v143, v143
    v_cvt_pk_bf16_f32 v158, v140, v141
    v_cvt_pk_bf16_f32 v159, v142, v143
    v_mfma_f32_32x32x16_bf16 v[128:143], v[160:163], v[16:19], 0
    v_exp_f32 v112, v112
    v_exp_f32 v113, v113
    v_exp_f32 v114, v114
    v_exp_f32 v115, v115
    v_cvt_pk_bf16_f32 v144, v112, v113
    v_mfma_f32_32x32x16_bf16 v[80:95], v[188:191], v[156:159], v[80:95]
    buffer_load_dwordx4 v2, s[20:23], s34 offen offset:2048 sc1 lds
    v_cvt_pk_bf16_f32 v145, v114, v115
    v_exp_f32 v116, v116
    v_exp_f32 v117, v117
    v_exp_f32 v118, v118
    v_exp_f32 v119, v119
    v_cvt_pk_bf16_f32 v146, v116, v117
    v_mfma_f32_32x32x16_bf16 v[128:143], v[164:167], v[20:23], v[128:143]
    buffer_load_dwordx4 v2, s[20:23], s34 offen offset:3072 sc1 lds
    v_cvt_pk_bf16_f32 v147, v118, v119
    v_exp_f32 v120, v120
    v_exp_f32 v121, v121
    v_exp_f32 v122, v122
    v_exp_f32 v123, v123
    v_cvt_pk_bf16_f32 v148, v120, v121
    v_mfma_f32_32x32x16_bf16 v[96:111], v[184:187], v[144:147], v[96:111]
    s_waitcnt vmcnt(15)
    v_cvt_pk_bf16_f32 v149, v122, v123
    v_exp_f32 v124, v124
    v_exp_f32 v125, v125
    v_exp_f32 v126, v126
    v_exp_f32 v127, v127
    v_cvt_pk_bf16_f32 v150, v124, v125
    v_cvt_pk_bf16_f32 v151, v126, v127
    v_mfma_f32_32x32x16_bf16 v[112:127], v[168:171], v[24:27], 0
    buffer_load_dwordx4 v[160:163], v2, s[20:23], s31 offen sc1
    buffer_load_dwordx4 v[164:167], v2, s[20:23], s31 offen offset:1024 sc1
    v_exp_f32 v128, v128
    v_exp_f32 v129, v129
    v_exp_f32 v130, v130
    v_exp_f32 v131, v131
    v_cvt_pk_bf16_f32 v152, v128, v129
    v_mfma_f32_32x32x16_bf16 v[96:111], v[188:191], v[148:151], v[96:111]
    s_add_u32 m0, m0, 16384
    v_cvt_pk_bf16_f32 v153, v130, v131
    v_exp_f32 v132, v132
    v_exp_f32 v133, v133
    v_exp_f32 v134, v134
    v_exp_f32 v135, v135
    v_cvt_pk_bf16_f32 v154, v132, v133
    v_mfma_f32_32x32x16_bf16 v[112:127], v[172:175], v[28:31], v[112:127]
    s_add_u32 s34, s34, 16384
    buffer_load_dwordx4 v2, s[20:23], s34 offen offset:0 sc1 lds
    v_cvt_pk_bf16_f32 v155, v134, v135
    v_exp_f32 v136, v136
    v_exp_f32 v137, v137
    v_exp_f32 v138, v138
    v_exp_f32 v139, v139
    v_cvt_pk_bf16_f32 v156, v136, v137
    v_mfma_f32_32x32x16_bf16 v[48:63], v[184:187], v[152:155], v[48:63]
    v_cvt_pk_bf16_f32 v157, v138, v139
    v_exp_f32 v140, v140
    v_exp_f32 v141, v141
    v_exp_f32 v142, v142
    v_exp_f32 v143, v143
    v_cvt_pk_bf16_f32 v158, v140, v141
    v_cvt_pk_bf16_f32 v159, v142, v143
    v_mfma_f32_32x32x16_bf16 v[128:143], v[168:171], v[32:35], 0
    v_exp_f32 v112, v112
    v_exp_f32 v113, v113
    v_exp_f32 v114, v114
    v_exp_f32 v115, v115
    v_cvt_pk_bf16_f32 v144, v112, v113
    v_mfma_f32_32x32x16_bf16 v[48:63], v[188:191], v[156:159], v[48:63]
    buffer_load_dwordx4 v2, s[20:23], s34 offen offset:1024 sc1 lds
    v_cvt_pk_bf16_f32 v145, v114, v115
    v_exp_f32 v116, v116
    v_exp_f32 v117, v117
    v_exp_f32 v118, v118
    v_exp_f32 v119, v119
    v_cvt_pk_bf16_f32 v146, v116, v117
    v_mfma_f32_32x32x16_bf16 v[128:143], v[172:175], v[36:39], v[128:143]
    buffer_load_dwordx4 v2, s[20:23], s34 offen offset:2048 sc1 lds
    v_cvt_pk_bf16_f32 v147, v118, v119
    v_exp_f32 v120, v120
    v_exp_f32 v121, v121
    v_exp_f32 v122, v122
    v_exp_f32 v123, v123
    v_cvt_pk_bf16_f32 v148, v120, v121
    v_mfma_f32_32x32x16_bf16 v[64:79], v[192:195], v[144:147], v[64:79]
    v_cvt_pk_bf16_f32 v149, v122, v123
    v_exp_f32 v124, v124
    v_exp_f32 v125, v125
    v_exp_f32 v126, v126
    v_exp_f32 v127, v127
    v_cvt_pk_bf16_f32 v150, v124, v125
    v_cvt_pk_bf16_f32 v151, v126, v127
    v_mfma_f32_32x32x16_bf16 v[112:127], v[168:171], v[40:43], 0
    buffer_load_dwordx4 v[184:187], v2, s[20:23], s31 offen offset:2048 sc1
    buffer_load_dwordx4 v[188:191], v2, s[20:23], s31 offen offset:3072 sc1
    v_exp_f32 v128, v128
    v_exp_f32 v129, v129
    v_exp_f32 v130, v130
    v_exp_f32 v131, v131
    v_cvt_pk_bf16_f32 v152, v128, v129
    v_mfma_f32_32x32x16_bf16 v[64:79], v[196:199], v[148:151], v[64:79]
    buffer_load_dwordx4 v2, s[20:23], s34 offen offset:3072 sc1 lds
    v_cvt_pk_bf16_f32 v153, v130, v131
    v_exp_f32 v132, v132
    v_exp_f32 v133, v133
    v_exp_f32 v134, v134
    v_exp_f32 v135, v135
    v_cvt_pk_bf16_f32 v154, v132, v133
    v_mfma_f32_32x32x16_bf16 v[112:127], v[172:175], v[44:47], v[112:127]
    s_add_u32 m0, m0, 16384
    s_add_u32 s34, s34, 16384
    buffer_load_dwordx4 v2, s[20:23], s34 offen offset:0 sc1 lds
    v_cvt_pk_bf16_f32 v155, v134, v135
    v_exp_f32 v136, v136
    v_exp_f32 v137, v137
    v_exp_f32 v138, v138
    v_exp_f32 v139, v139
    v_cvt_pk_bf16_f32 v156, v136, v137
    v_mfma_f32_32x32x16_bf16 v[80:95], v[192:195], v[152:155], v[80:95]
    s_xor_b32 s31, s32, 0x40000
    v_cvt_pk_bf16_f32 v157, v138, v139
    v_exp_f32 v140, v140
    v_exp_f32 v141, v141
    v_exp_f32 v142, v142
    v_exp_f32 v143, v143
    v_cvt_pk_bf16_f32 v158, v140, v141
    v_cvt_pk_bf16_f32 v159, v142, v143
    v_mfma_f32_32x32x16_bf16 v[128:143], v[168:171], v[16:19], 0
    v_exp_f32 v112, v112
    v_exp_f32 v113, v113
    v_exp_f32 v114, v114
    v_exp_f32 v115, v115
    v_cvt_pk_bf16_f32 v144, v112, v113
    v_mfma_f32_32x32x16_bf16 v[80:95], v[196:199], v[156:159], v[80:95]
    buffer_load_dwordx4 v2, s[20:23], s34 offen offset:1024 sc1 lds
    v_cvt_pk_bf16_f32 v145, v114, v115
    v_exp_f32 v116, v116
    v_exp_f32 v117, v117
    v_exp_f32 v118, v118
    v_exp_f32 v119, v119
    v_cvt_pk_bf16_f32 v146, v116, v117
    v_mfma_f32_32x32x16_bf16 v[128:143], v[172:175], v[20:23], v[128:143]
    buffer_load_dwordx4 v2, s[20:23], s34 offen offset:2048 sc1 lds
    v_cvt_pk_bf16_f32 v147, v118, v119
    v_exp_f32 v120, v120
    v_exp_f32 v121, v121
    v_exp_f32 v122, v122
    v_exp_f32 v123, v123
    v_cvt_pk_bf16_f32 v148, v120, v121
    v_mfma_f32_32x32x16_bf16 v[96:111], v[192:195], v[144:147], v[96:111]
    s_waitcnt vmcnt(15)
    v_cvt_pk_bf16_f32 v149, v122, v123
    v_exp_f32 v124, v124
    v_exp_f32 v125, v125
    v_exp_f32 v126, v126
    v_exp_f32 v127, v127
    v_cvt_pk_bf16_f32 v150, v124, v125
    v_cvt_pk_bf16_f32 v151, v126, v127
    v_mfma_f32_32x32x16_bf16 v[112:127], v[176:179], v[24:27], 0
    v_exp_f32 v128, v128
    v_exp_f32 v129, v129
    v_exp_f32 v130, v130
    v_exp_f32 v131, v131
    v_cvt_pk_bf16_f32 v152, v128, v129
    v_mfma_f32_32x32x16_bf16 v[96:111], v[196:199], v[148:151], v[96:111]
    v_cvt_pk_bf16_f32 v153, v130, v131
    v_exp_f32 v132, v132
    v_exp_f32 v133, v133
    v_exp_f32 v134, v134
    v_exp_f32 v135, v135
    v_cvt_pk_bf16_f32 v154, v132, v133
    v_mfma_f32_32x32x16_bf16 v[112:127], v[180:183], v[28:31], v[112:127]
    buffer_load_dwordx4 v2, s[20:23], s34 offen offset:3072 sc1 lds
    v_cvt_pk_bf16_f32 v155, v134, v135
    v_exp_f32 v136, v136
    v_exp_f32 v137, v137
    v_exp_f32 v138, v138
    v_exp_f32 v139, v139
    v_cvt_pk_bf16_f32 v156, v136, v137
    v_mfma_f32_32x32x16_bf16 v[48:63], v[192:195], v[152:155], v[48:63]
    s_add_u32 m0, m0, 16384
    v_cvt_pk_bf16_f32 v157, v138, v139
    v_exp_f32 v140, v140
    v_exp_f32 v141, v141
    v_exp_f32 v142, v142
    v_exp_f32 v143, v143
    v_cvt_pk_bf16_f32 v158, v140, v141
    v_cvt_pk_bf16_f32 v159, v142, v143
    v_mfma_f32_32x32x16_bf16 v[128:143], v[176:179], v[32:35], 0
    s_add_u32 s34, s34, 16384
    v_exp_f32 v112, v112
    v_exp_f32 v113, v113
    v_exp_f32 v114, v114
    v_exp_f32 v115, v115
    v_cvt_pk_bf16_f32 v144, v112, v113
    v_mfma_f32_32x32x16_bf16 v[48:63], v[196:199], v[156:159], v[48:63]
    buffer_load_dwordx4 v2, s[20:23], s34 offen offset:0 sc1 lds
    v_cvt_pk_bf16_f32 v145, v114, v115
    v_exp_f32 v116, v116
    v_exp_f32 v117, v117
    v_exp_f32 v118, v118
    v_exp_f32 v119, v119
    v_cvt_pk_bf16_f32 v146, v116, v117
    v_mfma_f32_32x32x16_bf16 v[128:143], v[180:183], v[36:39], v[128:143]
    buffer_load_dwordx4 v2, s[20:23], s34 offen offset:1024 sc1 lds
    v_cvt_pk_bf16_f32 v147, v118, v119
    v_exp_f32 v120, v120
    v_exp_f32 v121, v121
    v_exp_f32 v122, v122
    v_exp_f32 v123, v123
    v_cvt_pk_bf16_f32 v148, v120, v121
    v_mfma_f32_32x32x16_bf16 v[64:79], v[200:203], v[144:147], v[64:79]
    v_cvt_pk_bf16_f32 v149, v122, v123
    v_exp_f32 v124, v124
    v_exp_f32 v125, v125
    v_exp_f32 v126, v126
    v_exp_f32 v127, v127
    v_cvt_pk_bf16_f32 v150, v124, v125
    v_cvt_pk_bf16_f32 v151, v126, v127
    v_mfma_f32_32x32x16_bf16 v[112:127], v[176:179], v[40:43], 0
    v_exp_f32 v128, v128
    v_exp_f32 v129, v129
    v_exp_f32 v130, v130
    v_exp_f32 v131, v131
    v_cvt_pk_bf16_f32 v152, v128, v129
    v_mfma_f32_32x32x16_bf16 v[64:79], v[204:207], v[148:151], v[64:79]
    buffer_load_dwordx4 v2, s[20:23], s34 offen offset:2048 sc1 lds
    v_cvt_pk_bf16_f32 v153, v130, v131
    v_exp_f32 v132, v132
    v_exp_f32 v133, v133
    v_exp_f32 v134, v134
    v_exp_f32 v135, v135
    v_cvt_pk_bf16_f32 v154, v132, v133
    v_mfma_f32_32x32x16_bf16 v[112:127], v[180:183], v[44:47], v[112:127]
    buffer_load_dwordx4 v2, s[20:23], s34 offen offset:3072 sc1 lds
    v_cvt_pk_bf16_f32 v155, v134, v135
    v_exp_f32 v136, v136
    v_exp_f32 v137, v137
    v_exp_f32 v138, v138
    v_exp_f32 v139, v139
    v_cvt_pk_bf16_f32 v156, v136, v137
    v_mfma_f32_32x32x16_bf16 v[80:95], v[200:203], v[152:155], v[80:95]
    v_cvt_pk_bf16_f32 v157, v138, v139
    v_exp_f32 v140, v140
    v_exp_f32 v141, v141
    v_exp_f32 v142, v142
    v_exp_f32 v143, v143
    v_cvt_pk_bf16_f32 v158, v140, v141
    v_cvt_pk_bf16_f32 v159, v142, v143
    v_mfma_f32_32x32x16_bf16 v[128:143], v[176:179], v[16:19], 0
    v_exp_f32 v112, v112
    v_exp_f32 v113, v113
    v_exp_f32 v114, v114
    v_exp_f32 v115, v115
    v_cvt_pk_bf16_f32 v144, v112, v113
    v_mfma_f32_32x32x16_bf16 v[80:95], v[204:207], v[156:159], v[80:95]
    buffer_load_dwordx4 v[168:171], v2, s[20:23], s33 offen offset:0 sc1
    v_cvt_pk_bf16_f32 v145, v114, v115
    v_exp_f32 v116, v116
    v_exp_f32 v117, v117
    v_exp_f32 v118, v118
    v_exp_f32 v119, v119
    v_cvt_pk_bf16_f32 v146, v116, v117
    v_mfma_f32_32x32x16_bf16 v[128:143], v[180:183], v[20:23], v[128:143]
    buffer_load_dwordx4 v[172:175], v2, s[20:23], s33 offen offset:1024 sc1
    v_cvt_pk_bf16_f32 v147, v118, v119
    v_exp_f32 v120, v120
    v_exp_f32 v121, v121
    v_exp_f32 v122, v122
    v_exp_f32 v123, v123
    v_cvt_pk_bf16_f32 v148, v120, v121
    v_mfma_f32_32x32x16_bf16 v[96:111], v[200:203], v[144:147], v[96:111]
    s_waitcnt vmcnt(11)
    v_cvt_pk_bf16_f32 v149, v122, v123
    v_exp_f32 v124, v124
    v_exp_f32 v125, v125
    v_exp_f32 v126, v126
    v_exp_f32 v127, v127
    v_cvt_pk_bf16_f32 v150, v124, v125
    v_cvt_pk_bf16_f32 v151, v126, v127
    v_mfma_f32_32x32x16_bf16 v[112:127], v[160:163], v[24:27], 0
    v_exp_f32 v128, v128
    v_exp_f32 v129, v129
    v_exp_f32 v130, v130
    v_exp_f32 v131, v131
    v_cvt_pk_bf16_f32 v152, v128, v129
    v_mfma_f32_32x32x16_bf16 v[96:111], v[204:207], v[148:151], v[96:111]
    v_cvt_pk_bf16_f32 v153, v130, v131
    v_exp_f32 v132, v132
    v_exp_f32 v133, v133
    v_exp_f32 v134, v134
    v_exp_f32 v135, v135
    v_cvt_pk_bf16_f32 v154, v132, v133
    v_mfma_f32_32x32x16_bf16 v[112:127], v[164:167], v[28:31], v[112:127]
    buffer_load_dwordx4 v[192:195], v2, s[20:23], s33 offen offset:2048 sc1
    v_cvt_pk_bf16_f32 v155, v134, v135
    v_exp_f32 v136, v136
    v_exp_f32 v137, v137
    v_exp_f32 v138, v138
    v_exp_f32 v139, v139
    v_cvt_pk_bf16_f32 v156, v136, v137
    v_mfma_f32_32x32x16_bf16 v[48:63], v[200:203], v[152:155], v[48:63]
    v_cvt_pk_bf16_f32 v157, v138, v139
    v_exp_f32 v140, v140
    v_exp_f32 v141, v141
    v_exp_f32 v142, v142
    v_exp_f32 v143, v143
    v_cvt_pk_bf16_f32 v158, v140, v141
    v_cvt_pk_bf16_f32 v159, v142, v143
    v_mfma_f32_32x32x16_bf16 v[128:143], v[160:163], v[32:35], 0
    v_exp_f32 v112, v112
    v_exp_f32 v113, v113
    v_exp_f32 v114, v114
    v_exp_f32 v115, v115
    v_cvt_pk_bf16_f32 v144, v112, v113
    v_mfma_f32_32x32x16_bf16 v[48:63], v[204:207], v[156:159], v[48:63]
    buffer_load_dwordx4 v[196:199], v2, s[20:23], s33 offen offset:3072 sc1
    v_cvt_pk_bf16_f32 v145, v114, v115
    v_exp_f32 v116, v116
    v_exp_f32 v117, v117
    v_exp_f32 v118, v118
    v_exp_f32 v119, v119
    v_cvt_pk_bf16_f32 v146, v116, v117
    v_mfma_f32_32x32x16_bf16 v[128:143], v[164:167], v[36:39], v[128:143]
    s_add_u32 s33, s33, 4096
    buffer_load_dwordx4 v[176:179], v2, s[20:23], s33 offen offset:0 sc1
    v_cvt_pk_bf16_f32 v147, v118, v119
    v_exp_f32 v120, v120
    v_exp_f32 v121, v121
    v_exp_f32 v122, v122
    v_exp_f32 v123, v123
    v_cvt_pk_bf16_f32 v148, v120, v121
    v_mfma_f32_32x32x16_bf16 v[64:79], v[184:187], v[144:147], v[64:79]
    v_cvt_pk_bf16_f32 v149, v122, v123
    v_exp_f32 v124, v124
    v_exp_f32 v125, v125
    v_exp_f32 v126, v126
    v_exp_f32 v127, v127
    v_cvt_pk_bf16_f32 v150, v124, v125
    v_cvt_pk_bf16_f32 v151, v126, v127
    v_mfma_f32_32x32x16_bf16 v[112:127], v[160:163], v[40:43], 0
    v_exp_f32 v128, v128
    v_exp_f32 v129, v129
    v_exp_f32 v130, v130
    v_exp_f32 v131, v131
    v_cvt_pk_bf16_f32 v152, v128, v129
    v_mfma_f32_32x32x16_bf16 v[64:79], v[188:191], v[148:151], v[64:79]
    buffer_load_dwordx4 v[180:183], v2, s[20:23], s33 offen offset:1024 sc1
    v_cvt_pk_bf16_f32 v153, v130, v131
    v_exp_f32 v132, v132
    v_exp_f32 v133, v133
    v_exp_f32 v134, v134
    v_exp_f32 v135, v135
    v_cvt_pk_bf16_f32 v154, v132, v133
    v_mfma_f32_32x32x16_bf16 v[112:127], v[164:167], v[44:47], v[112:127]
    buffer_load_dwordx4 v[200:203], v2, s[20:23], s33 offen offset:2048 sc1
    v_cvt_pk_bf16_f32 v155, v134, v135
    v_exp_f32 v136, v136
    v_exp_f32 v137, v137
    v_exp_f32 v138, v138
    v_exp_f32 v139, v139
    v_cvt_pk_bf16_f32 v156, v136, v137
    v_mfma_f32_32x32x16_bf16 v[80:95], v[184:187], v[152:155], v[80:95]
    ds_write_b128 v12, v[64:67] offset:0
    ds_write_b128 v12, v[68:71] offset:1024
    ds_write_b128 v12, v[72:75] offset:2048
    ds_write_b128 v12, v[76:79] offset:3072
    v_cvt_pk_bf16_f32 v157, v138, v139
    v_exp_f32 v140, v140
    v_exp_f32 v141, v141
    v_exp_f32 v142, v142
    v_exp_f32 v143, v143
    v_cvt_pk_bf16_f32 v158, v140, v141
    v_cvt_pk_bf16_f32 v159, v142, v143
    v_mfma_f32_32x32x16_bf16 v[128:143], v[160:163], v[16:19], 0
    v_exp_f32 v112, v112
    v_exp_f32 v113, v113
    v_exp_f32 v114, v114
    v_exp_f32 v115, v115
    v_cvt_pk_bf16_f32 v144, v112, v113
    v_mfma_f32_32x32x16_bf16 v[80:95], v[188:191], v[156:159], v[80:95]
    buffer_load_dwordx4 v[204:207], v2, s[20:23], s33 offen offset:3072 sc1
    v_cvt_pk_bf16_f32 v145, v114, v115
    v_exp_f32 v116, v116
    v_exp_f32 v117, v117
    v_exp_f32 v118, v118
    v_exp_f32 v119, v119
    v_cvt_pk_bf16_f32 v146, v116, v117
    v_mfma_f32_32x32x16_bf16 v[128:143], v[164:167], v[20:23], v[128:143]
    s_add_u32 s33, s33, 4096
    v_cvt_pk_bf16_f32 v147, v118, v119
    v_exp_f32 v120, v120
    v_exp_f32 v121, v121
    v_exp_f32 v122, v122
    v_exp_f32 v123, v123
    v_cvt_pk_bf16_f32 v148, v120, v121
    v_mfma_f32_32x32x16_bf16 v[96:111], v[184:187], v[144:147], v[96:111]
    ds_write_b128 v13, v[80:83] offset:0
    ds_write_b128 v13, v[84:87] offset:1024
    ds_write_b128 v13, v[88:91] offset:2048
    ds_write_b128 v13, v[92:95] offset:3072
    v_cvt_pk_bf16_f32 v149, v122, v123
    v_exp_f32 v124, v124
    v_exp_f32 v125, v125
    v_exp_f32 v126, v126
    v_exp_f32 v127, v127
    v_cvt_pk_bf16_f32 v150, v124, v125
    v_cvt_pk_bf16_f32 v151, v126, v127
    v_exp_f32 v128, v128
    v_exp_f32 v129, v129
    v_exp_f32 v130, v130
    v_exp_f32 v131, v131
    v_cvt_pk_bf16_f32 v152, v128, v129
    v_mfma_f32_32x32x16_bf16 v[96:111], v[188:191], v[148:151], v[96:111]
    buffer_load_dwordx4 v[160:163], v2, s[20:23], s33 offen offset:0 sc1
    v_cvt_pk_bf16_f32 v153, v130, v131
    v_exp_f32 v132, v132
    v_exp_f32 v133, v133
    v_exp_f32 v134, v134
    v_exp_f32 v135, v135
    v_cvt_pk_bf16_f32 v154, v132, v133
    buffer_load_dwordx4 v[164:167], v2, s[20:23], s33 offen offset:1024 sc1
    v_cvt_pk_bf16_f32 v155, v134, v135
    v_exp_f32 v136, v136
    v_exp_f32 v137, v137
    v_exp_f32 v138, v138
    v_exp_f32 v139, v139
    v_cvt_pk_bf16_f32 v156, v136, v137
    s_nop 0
    v_mfma_f32_32x32x16_bf16 v[48:63], v[184:187], v[152:155], v[48:63]
    ds_write_b128 v14, v[96:99] offset:0
    ds_write_b128 v14, v[100:103] offset:1024
    ds_write_b128 v14, v[104:107] offset:2048
    ds_write_b128 v14, v[108:111] offset:3072
    v_cvt_pk_bf16_f32 v157, v138, v139
    v_exp_f32 v140, v140
    v_exp_f32 v141, v141
    v_exp_f32 v142, v142
    v_exp_f32 v143, v143
    v_cvt_pk_bf16_f32 v158, v140, v141
    v_cvt_pk_bf16_f32 v159, v142, v143
    s_waitcnt lgkmcnt(0)
    s_barrier
    v_mfma_f32_32x32x16_bf16 v[48:63], v[188:191], v[156:159], v[48:63]
    ds_read_b128 v[64:67], v11 offset:0
    ds_read_b128 v[68:71], v11 offset:1024
    ds_read_b128 v[72:75], v11 offset:2048
    ds_read_b128 v[76:79], v11 offset:3072
    ds_read_b128 v[80:83], v11 offset:4096
    ds_read_b128 v[84:87], v11 offset:5120
    ds_read_b128 v[88:91], v11 offset:6144
    ds_read_b128 v[92:95], v11 offset:7168
    ds_read_b128 v[96:99], v11 offset:8192
    ds_read_b128 v[100:103], v11 offset:9216
    ds_read_b128 v[104:107], v11 offset:10240
    ds_read_b128 v[108:111], v11 offset:11264
    buffer_load_dwordx4 v[184:187], v2, s[20:23], s33 offen offset:2048 sc1
    buffer_load_dwordx4 v[188:191], v2, s[20:23], s33 offen offset:3072 sc1
    s_add_u32 s33, s33, 4096
    buffer_load_dwordx4 v[112:115], v2, s[20:23], s33 offen offset:0 sc1
    buffer_load_dwordx4 v[116:119], v2, s[20:23], s33 offen offset:1024 sc1
    s_mov_b32 s38, 0x5d800000
    s_mov_b32 s39, 0x21800000
    s_lshl_b32 s37, s16, 2
    s_add_u32 s37, s37, 56704
    s_waitcnt lgkmcnt(8)
    v_pk_add_f32 v[60:61], v[60:61], v[76:77]
    v_pk_add_f32 v[62:63], v[62:63], v[78:79]
    v_pk_add_f32 v[48:49], v[48:49], v[64:65]
    v_pk_add_f32 v[50:51], v[50:51], v[66:67]
    v_pk_add_f32 v[52:53], v[52:53], v[68:69]
    v_pk_add_f32 v[54:55], v[54:55], v[70:71]
    v_pk_add_f32 v[56:57], v[56:57], v[72:73]
    v_pk_add_f32 v[58:59], v[58:59], v[74:75]
    s_waitcnt lgkmcnt(4)
    v_pk_add_f32 v[60:61], v[60:61], v[92:93]
    v_pk_add_f32 v[62:63], v[62:63], v[94:95]
    v_pk_add_f32 v[48:49], v[48:49], v[80:81]
    v_pk_add_f32 v[50:51], v[50:51], v[82:83]
    v_pk_add_f32 v[52:53], v[52:53], v[84:85]
    v_pk_add_f32 v[54:55], v[54:55], v[86:87]
    v_pk_add_f32 v[56:57], v[56:57], v[88:89]
    v_pk_add_f32 v[58:59], v[58:59], v[90:91]
    s_waitcnt lgkmcnt(0)
    v_pk_add_f32 v[60:61], v[60:61], v[108:109]
    v_pk_add_f32 v[62:63], v[62:63], v[110:111]
    v_mov_b32 v12, v60
    v_mov_b32 v13, v60
    v_pk_add_f32 v[48:49], v[48:49], v[96:97]
    v_pk_add_f32 v[50:51], v[50:51], v[98:99]
    v_permlane32_swap_b32 v12, v13
    v_pk_add_f32 v[52:53], v[52:53], v[100:101]
    v_rcp_f32 v12, v13
    v_cmp_nge_f32 vcc, s38, v13
    v_cmp_nle_f32 s[40:41], s39, v13
    v_pk_add_f32 v[54:55], v[54:55], v[102:103]
    v_pk_add_f32 v[56:57], v[56:57], v[104:105]
    v_pk_add_f32 v[58:59], v[58:59], v[106:107]
    v_mov_b32 v13, v12
    s_or_b64 vcc, vcc, s[40:41]
    s_cselect_b32 s39, 1, 0
    v_pk_mul_f32 v[48:49], v[48:49], v[12:13]
    v_pk_mul_f32 v[50:51], v[50:51], v[12:13]
    v_cvt_pk_bf16_f32 v64, v48, v49
    v_cvt_pk_bf16_f32 v65, v50, v51
    ds_write_b64 v4, v[64:65] offset:0
    v_pk_mul_f32 v[52:53], v[52:53], v[12:13]
    v_pk_mul_f32 v[54:55], v[54:55], v[12:13]
    v_cvt_pk_bf16_f32 v66, v52, v53
    v_cvt_pk_bf16_f32 v67, v54, v55
    ds_write_b64 v4, v[66:67] offset:16
    v_pk_mul_f32 v[56:57], v[56:57], v[12:13]
    v_pk_mul_f32 v[58:59], v[58:59], v[12:13]
    v_cvt_pk_bf16_f32 v68, v56, v57
    v_cvt_pk_bf16_f32 v69, v58, v59
    ds_write_b64 v4, v[68:69] offset:32
    v_pk_mul_f32 v[60:61], v[60:61], v[12:13]
    v_pk_mul_f32 v[62:63], v[62:63], v[12:13]
    v_cvt_pk_bf16_f32 v70, v60, v61
    v_cvt_pk_bf16_f32 v71, v62, v63
    s_mov_b32 exec_hi, 0
    ds_write_b64 v4, v[70:71] offset:48
    s_mov_b32 exec_hi, -1
    v_mov_b32 v15, s37
    v_mov_b32 v14, s39
    ds_write_b32 v15, v14
    v_mov_b32 v15, 56704
    v_lshlrev_b32 v84, 16, v208
    v_and_b32 v85, 0xffff0000, v208
    v_lshlrev_b32 v86, 16, v209
    v_and_b32 v87, 0xffff0000, v209
    v_lshlrev_b32 v88, 16, v210
    v_and_b32 v89, 0xffff0000, v210
    v_lshlrev_b32 v90, 16, v211
    v_and_b32 v91, 0xffff0000, v211
    buffer_load_dwordx4 v[120:123], v2, s[20:23], s33 offen offset:2048 sc1
    buffer_load_dwordx4 v[124:127], v2, s[20:23], s33 offen offset:3072 sc1
    s_add_u32 s33, s33, 4096
    s_waitcnt lgkmcnt(0)
    s_barrier
    ds_read_b128 v[12:15], v15
    ds_read_b128 v[48:51], v5 offset:49152
    ds_read_b128 v[52:55], v5 offset:49216
    ds_read_b128 v[56:59], v5 offset:49280
    ds_read_b128 v[60:63], v5 offset:49344
    ds_read_b128 v[64:67], v5 offset:49408
    ds_read_b128 v[68:71], v5 offset:49472
    ds_read_b128 v[72:75], v5 offset:49536
    ds_read_b128 v[76:79], v5 offset:49600
    ds_read_b128 v[80:83], v5 offset:49664
    ds_read_b128 v[24:27], v5 offset:49728
    ds_read_b128 v[28:31], v5 offset:49792
    ds_read_b128 v[32:35], v5 offset:49856
    ds_read_b128 v[36:39], v5 offset:49920
    ds_read_b128 v[40:43], v5 offset:49984
    v_lshlrev_b32 v92, 16, v212
    v_and_b32 v93, 0xffff0000, v212
    v_lshlrev_b32 v94, 16, v213
    v_and_b32 v95, 0xffff0000, v213
    buffer_load_dwordx4 v[128:131], v2, s[20:23], s33 offen offset:0 sc1
    v_lshlrev_b32 v96, 16, v214
    v_and_b32 v97, 0xffff0000, v214
    v_lshlrev_b32 v98, 16, v215
    v_and_b32 v99, 0xffff0000, v215
    buffer_load_dwordx4 v[132:135], v2, s[20:23], s33 offen offset:1024 sc1
    v_lshlrev_b32 v100, 16, v216
    v_and_b32 v101, 0xffff0000, v216
    v_lshlrev_b32 v102, 16, v217
    v_and_b32 v103, 0xffff0000, v217
    buffer_load_dwordx4 v[136:139], v2, s[20:23], s33 offen offset:2048 sc1
    v_lshlrev_b32 v104, 16, v218
    v_and_b32 v105, 0xffff0000, v218
    v_lshlrev_b32 v106, 16, v219
    v_and_b32 v107, 0xffff0000, v219
    v_lshlrev_b32 v108, 16, v220
    v_and_b32 v109, 0xffff0000, v220
    v_lshlrev_b32 v110, 16, v221
    v_and_b32 v111, 0xffff0000, v221
    s_waitcnt lgkmcnt(14)
    v_or3_b32 v12, v12, v13, v14
    v_or_b32 v12, v12, v15
    s_mul_i32 s34, s19, 118784
    v_readfirstlane_b32 s39, v12
    s_mul_i32 s35, s16, 5120
    s_add_u32 s34, s34, s35
    s_add_u32 s34, s34, 0x418000
    s_mov_b32 m0, s35
    s_andn2_b32 s39, s39, s36
    s_cmp_lg_u32 s39, 0
    s_cbranch_scc1 K_att6_fallback
    s_waitcnt lgkmcnt(13)
    v_mfma_f32_16x16x32_bf16 v[84:87], a[0:3], v[48:51], v[84:87]
    s_and_b32 s37, s18, 1
    s_lshl_b32 s44, s17, 1
    s_waitcnt lgkmcnt(12)
    v_mfma_f32_16x16x32_bf16 v[84:87], a[4:7], v[52:55], v[84:87]
    buffer_load_dwordx4 v[140:143], v2, s[20:23], s33 offen offset:3072 sc1
    s_add_u32 s33, s33, 4096
    s_waitcnt lgkmcnt(11)
    v_mfma_f32_16x16x32_bf16 v[84:87], a[8:11], v[56:59], v[84:87]
    s_add_u32 s44, s44, s37
    s_lshl_b32 s44, s44, 1
    s_waitcnt lgkmcnt(10)
    v_mfma_f32_16x16x32_bf16 v[84:87], a[12:15], v[60:63], v[84:87]
    s_lshr_b32 s37, s16, 1
    s_add_u32 s44, s44, s37
    s_waitcnt lgkmcnt(9)
    v_mfma_f32_16x16x32_bf16 v[84:87], a[16:19], v[64:67], v[84:87]
    buffer_load_dwordx4 v[144:147], v2, s[20:23], s33 offen offset:0 sc1
    s_waitcnt lgkmcnt(8)
    v_mfma_f32_16x16x32_bf16 v[84:87], a[20:23], v[68:71], v[84:87]
    s_and_b32 s45, s19, 14
    s_and_b32 s37, s16, 1
    s_waitcnt lgkmcnt(7)
    v_mfma_f32_16x16x32_bf16 v[84:87], a[24:27], v[72:75], v[84:87]
    s_add_u32 s45, s45, s37
    s_mul_i32 s38, s16, 28672
    s_waitcnt lgkmcnt(6)
    v_mfma_f32_16x16x32_bf16 v[84:87], a[28:31], v[76:79], v[84:87]
    buffer_load_dwordx4 v[148:151], v2, s[20:23], s33 offen offset:1024 sc1
    s_waitcnt lgkmcnt(5)
    v_mfma_f32_16x16x32_bf16 v[84:87], a[32:35], v[80:83], v[84:87]
    s_bfe_u32 s37, s18, 0x10001
    s_lshl_b32 s39, s37, 14
    s_waitcnt lgkmcnt(4)
    v_mfma_f32_16x16x32_bf16 v[84:87], a[36:39], v[24:27], v[84:87]
    s_add_u32 s38, s38, s39
    s_mul_i32 s53, s37, -28672
    s_waitcnt lgkmcnt(3)
    v_mfma_f32_16x16x32_bf16 v[84:87], a[40:43], v[28:31], v[84:87]
    buffer_load_dwordx4 v[152:155], v2, s[20:23], s33 offen offset:2048 sc1
    s_waitcnt lgkmcnt(2)
    v_mfma_f32_16x16x32_bf16 v[84:87], a[44:47], v[32:35], v[84:87]
    s_add_u32 s53, s53, 4096
    s_mul_i32 s46, s44, 114688
    s_waitcnt lgkmcnt(1)
    v_mfma_f32_16x16x32_bf16 v[84:87], a[48:51], v[36:39], v[84:87]
    s_xor_b32 s37, s44, 1
    s_mul_i32 s47, s37, 114688
    s_waitcnt lgkmcnt(0)
    v_mfma_f32_16x16x32_bf16 v[84:87], a[52:55], v[40:43], v[84:87]
    buffer_load_dwordx4 v[156:159], v2, s[20:23], s33 offen offset:3072 sc1
    s_add_u32 s33, s33, 4096
    v_mfma_f32_16x16x32_bf16 v[88:91], a[56:59], v[48:51], v[88:91]
    s_add_u32 s39, s38, 0xc00000
    s_add_u32 s46, s46, s39
    v_mfma_f32_16x16x32_bf16 v[88:91], a[60:63], v[52:55], v[88:91]
    s_add_u32 s47, s47, s39
    s_mul_i32 s48, s45, 115712
    v_mfma_f32_16x16x32_bf16 v[88:91], a[64:67], v[56:59], v[88:91]
    buffer_load_dwordx4 v[16:19], v2, s[20:23], s33 offen offset:0 sc1
    v_mfma_f32_16x16x32_bf16 v[88:91], a[68:71], v[60:63], v[88:91]
    s_add_u32 s50, s48, 0x61c000
    s_xor_b32 s37, s45, 1
    v_mfma_f32_16x16x32_bf16 v[88:91], a[72:75], v[64:67], v[88:91]
    s_mul_i32 s49, s37, 115712
    s_add_u32 s39, s38, 0x600000
    v_mfma_f32_16x16x32_bf16 v[88:91], a[76:79], v[68:71], v[88:91]
    buffer_load_dwordx4 v[20:23], v2, s[20:23], s33 offen offset:1024 sc1
    v_mfma_f32_16x16x32_bf16 v[88:91], a[80:83], v[72:75], v[88:91]
    s_add_u32 s48, s48, s39
    s_add_u32 s49, s49, s39
    v_mfma_f32_16x16x32_bf16 v[88:91], a[84:87], v[76:79], v[88:91]
    v_mov_b32 v12, v84
    v_mul_f32 v13, v84, v84
    v_mfma_f32_16x16x32_bf16 v[88:91], a[88:91], v[80:83], v[88:91]
    buffer_load_dwordx4 v2, s[20:23], s34 offen offset:0 sc1 lds
    v_mfma_f32_16x16x32_bf16 v[88:91], a[92:95], v[24:27], v[88:91]
    v_mov_b32 v14, v85
    v_mul_f32 v15, v85, v85
    v_mfma_f32_16x16x32_bf16 v[88:91], a[96:99], v[28:31], v[88:91]
    v_add_f32 v12, v12, v86
    v_fmac_f32 v13, v86, v86
    v_mfma_f32_16x16x32_bf16 v[88:91], a[100:103], v[32:35], v[88:91]
    buffer_load_dwordx4 v2, s[20:23], s34 offen offset:1024 sc1 lds
    v_mfma_f32_16x16x32_bf16 v[88:91], a[104:107], v[36:39], v[88:91]
    v_add_f32 v14, v14, v87
    v_fmac_f32 v15, v87, v87
    v_mfma_f32_16x16x32_bf16 v[88:91], a[108:111], v[40:43], v[88:91]
    s_mul_i32 s51, s44, 28
    s_lshl_b32 s37, s45, 1
    v_mfma_f32_16x16x32_bf16 v[92:95], a[112:115], v[48:51], v[92:95]
    buffer_load_dwordx4 v2, s[20:23], s34 offen offset:2048 sc1 lds
    v_mfma_f32_16x16x32_bf16 v[92:95], a[116:119], v[52:55], v[92:95]
    s_add_u32 s51, s51, s37
    s_lshl_b32 s51, s51, 10
    v_mfma_f32_16x16x32_bf16 v[92:95], a[120:123], v[56:59], v[92:95]
    s_mul_i32 s42, s16, 7168
    s_add_u32 s42, s42, s30
    v_mfma_f32_16x16x32_bf16 v[92:95], a[124:127], v[60:63], v[92:95]
    buffer_load_dwordx4 v2, s[20:23], s34 offen offset:3072 sc1 lds
    v_mfma_f32_16x16x32_bf16 v[92:95], a[128:131], v[64:67], v[92:95]
    s_add_u32 s42, s42, 0x800000
    s_add_u32 s43, s42, 4096
    v_mfma_f32_16x16x32_bf16 v[92:95], a[132:135], v[68:71], v[92:95]
    v_bfe_u32 v11, v1, 3, 1
    v_mul_u32_u24 v9, 0x200000, v11
    v_mfma_f32_16x16x32_bf16 v[92:95], a[136:139], v[72:75], v[92:95]
    s_add_u32 m0, s35, 4096
    s_add_u32 s34, s34, 4096
    buffer_load_dwordx4 v2, s[20:23], s34 offen offset:0 sc1 lds
    v_mfma_f32_16x16x32_bf16 v[92:95], a[140:143], v[76:79], v[92:95]
    v_add_f32 v12, v12, v88
    v_fmac_f32 v13, v88, v88
    v_mfma_f32_16x16x32_bf16 v[92:95], a[144:147], v[80:83], v[92:95]
    v_add_f32 v14, v14, v89
    v_fmac_f32 v15, v89, v89
    v_mfma_f32_16x16x32_bf16 v[92:95], a[148:151], v[24:27], v[92:95]
    v_mfma_f32_16x16x32_bf16 v[92:95], a[152:155], v[28:31], v[92:95]
    v_add_f32 v12, v12, v90
    v_fmac_f32 v13, v90, v90
    v_mfma_f32_16x16x32_bf16 v[92:95], a[156:159], v[32:35], v[92:95]
    v_add_f32 v14, v14, v91
    v_fmac_f32 v15, v91, v91
    v_mfma_f32_16x16x32_bf16 v[92:95], a[160:163], v[36:39], v[92:95]
    v_mfma_f32_16x16x32_bf16 v[92:95], a[164:167], v[40:43], v[92:95]
    v_lshl_add_u32 v9, v7, 9, v9
    v_lshl_add_u32 v9, v8, 4, v9
    v_mfma_f32_16x16x32_bf16 v[96:99], a[168:171], v[48:51], v[96:99]
    v_cmp_ne_u32 vcc, 0, v11
    v_lshlrev_b32 v10, 5, v8
    v_mfma_f32_16x16x32_bf16 v[96:99], a[172:175], v[52:55], v[96:99]
    v_mfma_f32_16x16x32_bf16 v[96:99], a[176:179], v[56:59], v[96:99]
    s_lshl_b32 s37, s16, 3
    s_add_u32 s37, s37, 56448
    v_mfma_f32_16x16x32_bf16 v[96:99], a[180:183], v[60:63], v[96:99]
    v_add_u32 v11, s37, v10
    v_mfma_f32_16x16x32_bf16 v[96:99], a[184:187], v[64:67], v[96:99]
    buffer_load_dwordx4 a[0:3], v2, s[20:23], s48 offen offset:0 sc1
    v_mfma_f32_16x16x32_bf16 v[96:99], a[188:191], v[68:71], v[96:99]
    v_mfma_f32_16x16x32_bf16 v[96:99], a[192:195], v[72:75], v[96:99]
    v_mfma_f32_16x16x32_bf16 v[96:99], a[196:199], v[76:79], v[96:99]
    buffer_load_dwordx4 a[4:7], v2, s[20:23], s49 offen offset:0 sc1
    v_mfma_f32_16x16x32_bf16 v[96:99], a[200:203], v[80:83], v[96:99]
    v_add_f32 v12, v12, v92
    v_fmac_f32 v13, v92, v92
    v_mfma_f32_16x16x32_bf16 v[96:99], a[204:207], v[24:27], v[96:99]
    v_add_f32 v14, v14, v93
    v_fmac_f32 v15, v93, v93
    v_mfma_f32_16x16x32_bf16 v[96:99], a[208:211], v[28:31], v[96:99]
    buffer_load_dwordx4 a[8:11], v2, s[20:23], s48 offen offset:1024 sc1
    v_mfma_f32_16x16x32_bf16 v[96:99], a[212:215], v[32:35], v[96:99]
    v_add_f32 v12, v12, v94
    v_fmac_f32 v13, v94, v94
    v_mfma_f32_16x16x32_bf16 v[96:99], a[216:219], v[36:39], v[96:99]
    v_add_f32 v14, v14, v95
    v_fmac_f32 v15, v95, v95
    v_mfma_f32_16x16x32_bf16 v[96:99], a[220:223], v[40:43], v[96:99]
    buffer_load_dwordx4 a[12:15], v2, s[20:23], s49 offen offset:1024 sc1
    v_mfma_f32_16x16x32_bf16 v[100:103], a[224:227], v[48:51], v[100:103]
    v_mfma_f32_16x16x32_bf16 v[100:103], a[228:231], v[52:55], v[100:103]
    v_mfma_f32_16x16x32_bf16 v[100:103], a[232:235], v[56:59], v[100:103]
    buffer_load_dwordx4 a[16:19], v2, s[20:23], s48 offen offset:2048 sc1
    v_mfma_f32_16x16x32_bf16 v[100:103], a[236:239], v[60:63], v[100:103]
    v_mfma_f32_16x16x32_bf16 v[100:103], a[240:243], v[64:67], v[100:103]
    v_mfma_f32_16x16x32_bf16 v[100:103], a[244:247], v[68:71], v[100:103]
    buffer_load_dwordx4 a[20:23], v2, s[20:23], s49 offen offset:2048 sc1
    v_mfma_f32_16x16x32_bf16 v[100:103], a[248:251], v[72:75], v[100:103]
    v_mfma_f32_16x16x32_bf16 v[100:103], a[252:255], v[76:79], v[100:103]
    v_add_f32 v12, v12, v96
    v_fmac_f32 v13, v96, v96
    v_mfma_f32_16x16x32_bf16 v[100:103], v[224:227], v[80:83], v[100:103]
    buffer_load_dwordx4 a[24:27], v2, s[20:23], s48 offen offset:3072 sc1
    s_add_u32 s48, s48, 4096
    v_mfma_f32_16x16x32_bf16 v[100:103], v[228:231], v[24:27], v[100:103]
    v_add_f32 v14, v14, v97
    v_fmac_f32 v15, v97, v97
    v_mfma_f32_16x16x32_bf16 v[100:103], v[232:235], v[28:31], v[100:103]
    v_add_f32 v12, v12, v98
    v_fmac_f32 v13, v98, v98
    v_mfma_f32_16x16x32_bf16 v[100:103], v[236:239], v[32:35], v[100:103]
    buffer_load_dwordx4 a[28:31], v2, s[20:23], s49 offen offset:3072 sc1
    s_add_u32 s49, s49, 4096
    v_mfma_f32_16x16x32_bf16 v[100:103], v[240:243], v[36:39], v[100:103]
    v_add_f32 v14, v14, v99
    v_fmac_f32 v15, v99, v99
    v_mfma_f32_16x16x32_bf16 v[100:103], v[244:247], v[40:43], v[100:103]
    v_mfma_f32_16x16x32_bf16 v[104:107], v[248:251], v[48:51], v[104:107]
    buffer_load_dwordx4 a[32:35], v2, s[20:23], s48 offen offset:0 sc1
    v_mfma_f32_16x16x32_bf16 v[104:107], v[252:255], v[52:55], v[104:107]
    s_waitcnt vmcnt(36)
    v_mfma_f32_16x16x32_bf16 v[104:107], v[168:171], v[56:59], v[104:107]
    v_mfma_f32_16x16x32_bf16 v[104:107], v[172:175], v[60:63], v[104:107]
    buffer_load_dwordx4 a[36:39], v2, s[20:23], s49 offen offset:0 sc1
    v_mfma_f32_16x16x32_bf16 v[104:107], v[192:195], v[64:67], v[104:107]
    v_mfma_f32_16x16x32_bf16 v[104:107], v[196:199], v[68:71], v[104:107]
    s_waitcnt vmcnt(33)
    v_mfma_f32_16x16x32_bf16 v[104:107], v[176:179], v[72:75], v[104:107]
    v_mfma_f32_16x16x32_bf16 v[104:107], v[180:183], v[76:79], v[104:107]
    v_add_f32 v12, v12, v100
    v_fmac_f32 v13, v100, v100
    v_mfma_f32_16x16x32_bf16 v[104:107], v[200:203], v[80:83], v[104:107]
    v_add_f32 v14, v14, v101
    v_fmac_f32 v15, v101, v101
    v_mfma_f32_16x16x32_bf16 v[104:107], v[204:207], v[24:27], v[104:107]
    s_waitcnt vmcnt(29)
    v_mfma_f32_16x16x32_bf16 v[104:107], v[160:163], v[28:31], v[104:107]
    v_add_f32 v12, v12, v102
    v_fmac_f32 v13, v102, v102
    v_mfma_f32_16x16x32_bf16 v[104:107], v[164:167], v[32:35], v[104:107]
    v_add_f32 v14, v14, v103
    v_fmac_f32 v15, v103, v103
    v_mfma_f32_16x16x32_bf16 v[104:107], v[184:187], v[36:39], v[104:107]
    v_mfma_f32_16x16x32_bf16 v[104:107], v[188:191], v[40:43], v[104:107]
    s_waitcnt vmcnt(25)
    v_mfma_f32_16x16x32_bf16 v[108:111], v[112:115], v[48:51], v[108:111]
    v_mfma_f32_16x16x32_bf16 v[108:111], v[116:119], v[52:55], v[108:111]
    v_mfma_f32_16x16x32_bf16 v[108:111], v[120:123], v[56:59], v[108:111]
    v_mfma_f32_16x16x32_bf16 v[108:111], v[124:127], v[60:63], v[108:111]
    s_waitcnt vmcnt(21)
    v_mfma_f32_16x16x32_bf16 v[108:111], v[128:131], v[64:67], v[108:111]
    v_mfma_f32_16x16x32_bf16 v[108:111], v[132:135], v[68:71], v[108:111]
    v_mfma_f32_16x16x32_bf16 v[108:111], v[136:139], v[72:75], v[108:111]
    v_mfma_f32_16x16x32_bf16 v[108:111], v[140:143], v[76:79], v[108:111]
    s_waitcnt vmcnt(17)
    v_mfma_f32_16x16x32_bf16 v[108:111], v[144:147], v[80:83], v[108:111]
    v_add_f32 v12, v12, v104
    v_fmac_f32 v13, v104, v104
    v_mfma_f32_16x16x32_bf16 v[108:111], v[148:151], v[24:27], v[108:111]
    v_add_f32 v14, v14, v105
    v_fmac_f32 v15, v105, v105
    v_mfma_f32_16x16x32_bf16 v[108:111], v[152:155], v[28:31], v[108:111]
    v_mfma_f32_16x16x32_bf16 v[108:111], v[156:159], v[32:35], v[108:111]
    v_add_f32 v12, v12, v106
    v_fmac_f32 v13, v106, v106
    s_waitcnt vmcnt(15)
    v_mfma_f32_16x16x32_bf16 v[108:111], v[16:19], v[36:39], v[108:111]
    v_add_f32 v14, v14, v107
    v_fmac_f32 v15, v107, v107
    v_mfma_f32_16x16x32_bf16 v[108:111], v[20:23], v[40:43], v[108:111]
    s_nop 7
    v_add_f32 v12, v12, v108
    v_fmac_f32 v13, v108, v108
    v_add_f32 v14, v14, v109
    v_fmac_f32 v15, v109, v109
    v_add_f32 v12, v12, v110
    v_fmac_f32 v13, v110, v110
    v_add_f32 v14, v14, v111
    v_fmac_f32 v15, v111, v111
    v_pk_add_f32 v[12:13], v[12:13], v[14:15]
    s_nop 0
    v_mov_b32 v14, v12
    v_mov_b32 v15, v13
    s_nop 1
    v_permlane32_swap_b32 v12, v14
    v_permlane32_swap_b32 v13, v15
    v_pk_add_f32 v[12:13], v[12:13], v[14:15]
    s_nop 0
    v_mov_b32 v14, v12
    v_mov_b32 v15, v13
    s_nop 1
    v_permlane16_swap_b32 v12, v14
    v_permlane16_swap_b32 v13, v15
    v_pk_add_f32 v[12:13], v[12:13], v[14:15]
    ds_write_b64 v11, v[12:13]
    buffer_load_dwordx4 a[40:43], v2, s[20:23], s48 offen offset:1024 sc1
    buffer_load_dwordx4 a[44:47], v2, s[20:23], s49 offen offset:1024 sc1
    s_waitcnt lgkmcnt(0)
    s_barrier
    ds_read_b128 v[48:51], v10 offset:56448
    ds_read_b128 v[52:55], v10 offset:56464
    buffer_load_dwordx4 a[48:51], v2, s[20:23], s48 offen offset:2048 sc1
    buffer_load_dwordx4 a[52:55], v2, s[20:23], s49 offen offset:2048 sc1
    s_waitcnt lgkmcnt(0)
    v_pk_add_f32 v[12:13], v[48:49], v[50:51]
    v_pk_add_f32 v[14:15], v[52:53], v[54:55]
    v_pk_add_f32 v[12:13], v[12:13], v[14:15]
    v_mul_f32 v12, 0x3b124925, v12
    v_mul_f32 v13, 0x3b124925, v13
    v_fma_f32 v13, -v12, v12, v13
    v_max_f32 v13, 0, v13
    v_add_f32 v13, 0x3727c5ac, v13
    v_rsq_f32 v14, v13
    v_mov_b32 v13, 0
    v_mul_f32 v14, 0x3eeff558, v14
    v_mul_f32_e64 v12, -v12, v14
    v_cndmask_b32 v14, 1.0, v14, vcc
    v_cndmask_b32 v12, v13, v12, vcc
    v_mov_b32 v15, v14
    v_mov_b32 v13, v12
    v_pk_fma_f32 v[84:85], v[84:85], v[14:15], v[12:13]
    v_pk_fma_f32 v[86:87], v[86:87], v[14:15], v[12:13]
    v_pk_fma_f32 v[88:89], v[88:89], v[14:15], v[12:13]
    v_pk_fma_f32 v[90:91], v[90:91], v[14:15], v[12:13]
    v_cvt_pk_bf16_f32 v208, v84, v85
    v_cvt_pk_bf16_f32 v209, v86, v87
    v_cvt_pk_bf16_f32 v210, v88, v89
    v_cvt_pk_bf16_f32 v211, v90, v91
    s_nop 0
    v_permlane32_swap_b32 v208, v210
    v_permlane32_swap_b32 v209, v211
    buffer_store_dwordx4 v[208:211], v9, s[20:23], s42 offen offset:0 sc1
    v_pk_fma_f32 v[92:93], v[92:93], v[14:15], v[12:13]
    v_pk_fma_f32 v[94:95], v[94:95], v[14:15], v[12:13]
    v_pk_fma_f32 v[96:97], v[96:97], v[14:15], v[12:13]
    v_pk_fma_f32 v[98:99], v[98:99], v[14:15], v[12:13]
    v_cvt_pk_bf16_f32 v212, v92, v93
    v_cvt_pk_bf16_f32 v213, v94, v95
    v_cvt_pk_bf16_f32 v214, v96, v97
    v_cvt_pk_bf16_f32 v215, v98, v99
    s_nop 0
    v_permlane32_swap_b32 v212, v214
    v_permlane32_swap_b32 v213, v215
    buffer_store_dwordx4 v[212:215], v9, s[20:23], s42 offen offset:2048 sc1
    v_pk_fma_f32 v[100:101], v[100:101], v[14:15], v[12:13]
    v_pk_fma_f32 v[102:103], v[102:103], v[14:15], v[12:13]
    v_pk_fma_f32 v[104:105], v[104:105], v[14:15], v[12:13]
    v_pk_fma_f32 v[106:107], v[106:107], v[14:15], v[12:13]
    v_cvt_pk_bf16_f32 v216, v100, v101
    v_cvt_pk_bf16_f32 v217, v102, v103
    v_cvt_pk_bf16_f32 v218, v104, v105
    v_cvt_pk_bf16_f32 v219, v106, v107
    s_nop 0
    v_permlane32_swap_b32 v216, v218
    v_permlane32_swap_b32 v217, v219
    buffer_store_dwordx4 v[216:219], v9, s[20:23], s43 offen offset:0 sc1
    v_pk_fma_f32 v[108:109], v[108:109], v[14:15], v[12:13]
    v_pk_fma_f32 v[110:111], v[110:111], v[14:15], v[12:13]
    v_cvt_pk_bf16_f32 v220, v108, v109
    v_cvt_pk_bf16_f32 v221, v110, v111
    s_nop 1
    v_permlane32_swap_b32 v220, v222
    v_permlane32_swap_b32 v221, v223
    s_mov_b32 exec_hi, 0
    buffer_store_dwordx4 v[220:223], v9, s[20:23], s43 offen offset:2048 sc1
    s_mov_b32 exec_hi, -1
    v_add_u32 v14, 0x10000, v2
    v_add_u32 v15, 0x20000, v2
    v_mov_b32 v225, 0
    v_mov_b32 v226, 0
    v_mov_b32 v227, 0
    v_mov_b32 v224, 0xb8ab3ef0
    v_cndmask_b32 v224, v224, v225, s[28:29]
    v_mov_b32 v10, 0x409d30fc
    v_mov_b32 v11, 0x409d30fc
    v_mov_b32 v12, 1.0
    v_mov_b32 v13, 1.0
    s_lshl_b32 s30, s17, 2
    s_add_u32 s30, s30, s16
    s_mul_i32 s31, s30, 28672
    s_add_u32 s31, s31, 0xa00000
    s_mul_i32 s32, s30, 112
    s_lshl_b32 s33, s18, 3
    s_add_u32 s32, s32, s33
    s_lshl_b32 s32, s32, 10
    s_add_u32 s32, s32, 0xc00000
    s_add_u32 s33, s32, 4096
    v_mov_b32 v6, s62
    v_mov_b32 v7, s63
    s_lshl_b32 s40, s17, 8
    s_add_u32 s40, s40, 0x3c0000
    s_lshl_b32 s41, s18, 3
    s_add_u32 s41, s41, s40
    v_min_u32 v4, 15, v1
    v_lshlrev_b32 v4, 3, v4
    buffer_load_dwordx4 a[56:59], v2, s[20:23], s48 offen offset:3072 sc1
    s_add_u32 s48, s48, 4096
    buffer_load_dwordx4 a[60:63], v2, s[20:23], s49 offen offset:3072 sc1
    s_add_u32 s49, s49, 4096
    buffer_load_dwordx4 a[64:67], v2, s[20:23], s48 offen offset:0 sc1
    buffer_load_dwordx4 a[68:71], v2, s[20:23], s49 offen offset:0 sc1
    buffer_load_dwordx4 a[72:75], v2, s[20:23], s48 offen offset:1024 sc1
    buffer_load_dwordx4 a[76:79], v2, s[20:23], s49 offen offset:1024 sc1
    s_cmp_lg_u32 s16, 0
    s_waitcnt vmcnt(6)
    s_barrier
    s_cbranch_scc1 K_sig10
    s_mov_b64 exec, 1
    buffer_store_dwordx2 v[6:7], off, s[20:23], s41
    buffer_store_dwordx2 v[6:7], off, s[20:23], s41 offset:128 sc1
    s_mov_b64 exec, -1
K_sig10:
    s_cmp_ge_u32 s18, 14
    s_cbranch_scc1 K_idle9
K_mlp11:
    s_cmp_lg_u32 s16, 0
    s_cbranch_scc1 K_wdone12
    buffer_load_dwordx2 v[6:7], v4, s[20:23], s40 offen sc1
    s_mov_b64 s[42:43], 0
    s_mov_b32 s3, 0
K_wloop13:
    s_waitcnt vmcnt(0)
    v_cmp_eq_u64 vcc, s[62:63], v[6:7]
    s_or_b64 s[42:43], s[42:43], vcc
    s_cmp_eq_u64 s[42:43], -1
    s_cbranch_scc1 K_wgot15
    s_add_u32 s3, s3, 1
    s_bitcmp1_b32 s3, 3
    s_cbranch_scc0 K_wskip14
    s_add_u32 s3, s3, 7
    buffer_load_dwordx2 v[6:7], v4, s[20:23], s40 offen offset:128 sc1
    s_cmp_gt_u32 s3, 0x40000
    s_cbranch_scc0 K_wloop13
    s_branch K_wgot15
K_wskip14:
    buffer_load_dwordx2 v[6:7], v4, s[20:23], s40 offen sc1
    s_branch K_wloop13
K_wgot15:
    s_waitcnt vmcnt(0)
K_wdone12:
    s_barrier
    buffer_load_dwordx4 v[16:19], v2, s[20:23], s31 offen offset:0 sc1
    buffer_load_dwordx4 v[20:23], v2, s[20:23], s31 offen offset:1024 sc1
    buffer_load_dwordx4 v[24:27], v2, s[20:23], s31 offen offset:2048 sc1
    buffer_load_dwordx4 v[28:31], v2, s[20:23], s31 offen offset:3072 sc1
    s_add_u32 s31, s31, 4096
    buffer_load_dwordx4 v[32:35], v2, s[20:23], s31 offen offset:0 sc1
    buffer_load_dwordx4 v[36:39], v2, s[20:23], s31 offen offset:1024 sc1
    buffer_load_dwordx4 v[40:43], v2, s[20:23], s31 offen offset:2048 sc1
    buffer_load_dwordx4 v[44:47], v2, s[20:23], s31 offen offset:3072 sc1
    s_add_u32 s31, s31, 4096
    ds_read_b128 v[192:195], v14 offset:0
    ds_read_b128 v[196:199], v14 offset:1024
    ds_read_b128 v[200:203], v14 offset:2048
    ds_read_b128 v[204:207], v14 offset:3072
    ds_read_b128 v[208:211], v14 offset:4096
    ds_read_b128 v[212:215], v14 offset:5120
    s_waitcnt lgkmcnt(4)
    v_mfma_f32_32x32x16_bf16 v[128:143], v[192:195], v[224:227], 0
    buffer_load_dwordx4 v[48:51], v2, s[20:23], s31 offen offset:0 sc1
    ds_read_b128 v[216:219], v14 offset:6144
    v_mfma_f32_32x32x16_bf16 v[144:159], v[196:199], v[224:227], 0
    ds_read_b128 v[220:223], v14 offset:7168
    s_waitcnt lgkmcnt(4)
    v_mfma_f32_32x32x16_bf16 v[160:175], v[200:203], v[224:227], 0
    ds_read_b128 v[192:195], v14 offset:8192
    v_mfma_f32_32x32x16_bf16 v[176:191], v[204:207], v[224:227], 0
    ds_read_b128 v[196:199], v14 offset:9216
    s_waitcnt vmcnt(8) lgkmcnt(4)
    v_mfma_f32_32x32x16_bf16 v[128:143], v[208:211], v[16:19], v[128:143]
    buffer_load_dwordx4 v[52:55], v2, s[20:23], s31 offen offset:1024 sc1
    ds_read_b128 v[200:203], v14 offset:10240
    v_mfma_f32_32x32x16_bf16 v[144:159], v[212:215], v[16:19], v[144:159]
    ds_read_b128 v[204:207], v14 offset:11264
    s_waitcnt lgkmcnt(4)
    v_mfma_f32_32x32x16_bf16 v[160:175], v[216:219], v[16:19], v[160:175]
    buffer_load_dwordx4 a[80:83], v2, s[20:23], s48 offen offset:2048 sc1
    ds_read_b128 v[208:211], v14 offset:12288
    v_mfma_f32_32x32x16_bf16 v[176:191], v[220:223], v[16:19], v[176:191]
    ds_read_b128 v[212:215], v14 offset:13312
    s_waitcnt vmcnt(9) lgkmcnt(4)
    v_mfma_f32_32x32x16_bf16 v[128:143], v[192:195], v[20:23], v[128:143]
    buffer_load_dwordx4 v[56:59], v2, s[20:23], s31 offen offset:2048 sc1
    ds_read_b128 v[216:219], v14 offset:14336
    v_mfma_f32_32x32x16_bf16 v[144:159], v[196:199], v[20:23], v[144:159]
    ds_read_b128 v[220:223], v14 offset:15360
    s_waitcnt lgkmcnt(4)
    v_mfma_f32_32x32x16_bf16 v[160:175], v[200:203], v[20:23], v[160:175]
    buffer_load_dwordx4 a[84:87], v2, s[20:23], s49 offen offset:2048 sc1
    ds_read_b128 v[192:195], v14 offset:16384
    v_mfma_f32_32x32x16_bf16 v[176:191], v[204:207], v[20:23], v[176:191]
    ds_read_b128 v[196:199], v14 offset:17408
    s_waitcnt vmcnt(10) lgkmcnt(4)
    v_mfma_f32_32x32x16_bf16 v[128:143], v[208:211], v[24:27], v[128:143]
    buffer_load_dwordx4 v[60:63], v2, s[20:23], s31 offen offset:3072 sc1
    s_add_u32 s31, s31, 4096
    ds_read_b128 v[200:203], v14 offset:18432
    v_mfma_f32_32x32x16_bf16 v[144:159], v[212:215], v[24:27], v[144:159]
    ds_read_b128 v[204:207], v14 offset:19456
    s_waitcnt lgkmcnt(4)
    v_mfma_f32_32x32x16_bf16 v[160:175], v[216:219], v[24:27], v[160:175]
    ds_read_b128 v[208:211], v14 offset:20480
    v_mfma_f32_32x32x16_bf16 v[176:191], v[220:223], v[24:27], v[176:191]
    ds_read_b128 v[212:215], v14 offset:21504
    s_waitcnt vmcnt(10) lgkmcnt(4)
    v_mfma_f32_32x32x16_bf16 v[128:143], v[192:195], v[28:31], v[128:143]
    buffer_load_dwordx4 v[64:67], v2, s[20:23], s31 offen offset:0 sc1
    ds_read_b128 v[216:219], v14 offset:22528
    v_mfma_f32_32x32x16_bf16 v[144:159], v[196:199], v[28:31], v[144:159]
    ds_read_b128 v[220:223], v14 offset:23552
    s_waitcnt lgkmcnt(4)
    v_mfma_f32_32x32x16_bf16 v[160:175], v[200:203], v[28:31], v[160:175]
    buffer_load_dwordx4 a[88:91], v2, s[20:23], s48 offen offset:3072 sc1
    s_add_u32 s48, s48, s53
    ds_read_b128 v[192:195], v14 offset:24576
    v_mfma_f32_32x32x16_bf16 v[176:191], v[204:207], v[28:31], v[176:191]
    ds_read_b128 v[196:199], v14 offset:25600
    s_waitcnt vmcnt(11) lgkmcnt(4)
    v_mfma_f32_32x32x16_bf16 v[128:143], v[208:211], v[32:35], v[128:143]
    buffer_load_dwordx4 v[68:71], v2, s[20:23], s31 offen offset:1024 sc1
    ds_read_b128 v[200:203], v14 offset:26624
    v_mfma_f32_32x32x16_bf16 v[144:159], v[212:215], v[32:35], v[144:159]
    ds_read_b128 v[204:207], v14 offset:27648
    s_waitcnt lgkmcnt(4)
    v_mfma_f32_32x32x16_bf16 v[160:175], v[216:219], v[32:35], v[160:175]
    buffer_load_dwordx4 a[92:95], v2, s[20:23], s49 offen offset:3072 sc1
    s_add_u32 s49, s49, s53
    ds_read_b128 v[208:211], v14 offset:28672
    v_mfma_f32_32x32x16_bf16 v[176:191], v[220:223], v[32:35], v[176:191]
    ds_read_b128 v[212:215], v14 offset:29696
    s_waitcnt vmcnt(12) lgkmcnt(4)
    v_mfma_f32_32x32x16_bf16 v[128:143], v[192:195], v[36:39], v[128:143]
    buffer_load_dwordx4 v[72:75], v2, s[20:23], s31 offen offset:2048 sc1
    ds_read_b128 v[216:219], v14 offset:30720
    v_mfma_f32_32x32x16_bf16 v[144:159], v[196:199], v[36:39], v[144:159]
    ds_read_b128 v[220:223], v14 offset:31744
    s_waitcnt lgkmcnt(4)
    v_mfma_f32_32x32x16_bf16 v[160:175], v[200:203], v[36:39], v[160:175]
    ds_read_b128 v[192:195], v14 offset:32768
    v_mfma_f32_32x32x16_bf16 v[176:191], v[204:207], v[36:39], v[176:191]
    ds_read_b128 v[196:199], v14 offset:33792
    s_waitcnt vmcnt(12) lgkmcnt(4)
    v_mfma_f32_32x32x16_bf16 v[128:143], v[208:211], v[40:43], v[128:143]
    buffer_load_dwordx4 v[76:79], v2, s[20:23], s31 offen offset:3072 sc1
    s_add_u32 s31, s31, 4096
    ds_read_b128 v[200:203], v14 offset:34816
    v_mfma_f32_32x32x16_bf16 v[144:159], v[212:215], v[40:43], v[144:159]
    ds_read_b128 v[204:207], v14 offset:35840
    s_waitcnt lgkmcnt(4)
    v_mfma_f32_32x32x16_bf16 v[160:175], v[216:219], v[40:43], v[160:175]
    buffer_load_dwordx4 a[96:99], v2, s[20:23], s48 offen offset:0 sc1
    ds_read_b128 v[208:211], v14 offset:36864
    v_mfma_f32_32x32x16_bf16 v[176:191], v[220:223], v[40:43], v[176:191]
    ds_read_b128 v[212:215], v14 offset:37888
    s_waitcnt vmcnt(13) lgkmcnt(4)
    v_mfma_f32_32x32x16_bf16 v[128:143], v[192:195], v[44:47], v[128:143]
    buffer_load_dwordx4 v[80:83], v2, s[20:23], s31 offen offset:0 sc1
    ds_read_b128 v[216:219], v14 offset:38912
    v_mfma_f32_32x32x16_bf16 v[144:159], v[196:199], v[44:47], v[144:159]
    ds_read_b128 v[220:223], v14 offset:39936
    s_waitcnt lgkmcnt(4)
    v_mfma_f32_32x32x16_bf16 v[160:175], v[200:203], v[44:47], v[160:175]
    buffer_load_dwordx4 a[100:103], v2, s[20:23], s49 offen offset:0 sc1
    ds_read_b128 v[192:195], v14 offset:40960
    v_mfma_f32_32x32x16_bf16 v[176:191], v[204:207], v[44:47], v[176:191]
    ds_read_b128 v[196:199], v14 offset:41984
    s_waitcnt vmcnt(14) lgkmcnt(4)
    v_mfma_f32_32x32x16_bf16 v[128:143], v[208:211], v[48:51], v[128:143]
    buffer_load_dwordx4 v[84:87], v2, s[20:23], s31 offen offset:1024 sc1
    ds_read_b128 v[200:203], v14 offset:43008
    v_mfma_f32_32x32x16_bf16 v[144:159], v[212:215], v[48:51], v[144:159]
    ds_read_b128 v[204:207], v14 offset:44032
    s_waitcnt lgkmcnt(4)
    v_mfma_f32_32x32x16_bf16 v[160:175], v[216:219], v[48:51], v[160:175]
    ds_read_b128 v[208:211], v14 offset:45056
    v_mfma_f32_32x32x16_bf16 v[176:191], v[220:223], v[48:51], v[176:191]
    ds_read_b128 v[212:215], v14 offset:46080
    s_waitcnt vmcnt(14) lgkmcnt(4)
    v_mfma_f32_32x32x16_bf16 v[128:143], v[192:195], v[52:55], v[128:143]
    buffer_load_dwordx4 v[88:91], v2, s[20:23], s31 offen offset:2048 sc1
    ds_read_b128 v[216:219], v14 offset:47104
    v_mfma_f32_32x32x16_bf16 v[144:159], v[196:199], v[52:55], v[144:159]
    ds_read_b128 v[220:223], v14 offset:48128
    s_waitcnt lgkmcnt(4)
    v_mfma_f32_32x32x16_bf16 v[160:175], v[200:203], v[52:55], v[160:175]
    buffer_load_dwordx4 a[104:107], v2, s[20:23], s48 offen offset:1024 sc1
    ds_read_b128 v[192:195], v14 offset:49152
    v_mfma_f32_32x32x16_bf16 v[176:191], v[204:207], v[52:55], v[176:191]
    ds_read_b128 v[196:199], v14 offset:50176
    s_waitcnt vmcnt(14) lgkmcnt(4)
    v_mfma_f32_32x32x16_bf16 v[128:143], v[208:211], v[56:59], v[128:143]
    buffer_load_dwordx4 v[92:95], v2, s[20:23], s31 offen offset:3072 sc1
    s_add_u32 s31, s31, 4096
    ds_read_b128 v[200:203], v14 offset:51200
    v_mfma_f32_32x32x16_bf16 v[144:159], v[212:215], v[56:59], v[144:159]
    ds_read_b128 v[204:207], v14 offset:52224
    s_waitcnt lgkmcnt(4)
    v_mfma_f32_32x32x16_bf16 v[160:175], v[216:219], v[56:59], v[160:175]
    buffer_load_dwordx4 a[108:111], v2, s[20:23], s49 offen offset:1024 sc1
    ds_read_b128 v[208:211], v14 offset:53248
    v_mfma_f32_32x32x16_bf16 v[176:191], v[220:223], v[56:59], v[176:191]
    ds_read_b128 v[212:215], v14 offset:54272
    s_waitcnt vmcnt(14) lgkmcnt(4)
    v_mfma_f32_32x32x16_bf16 v[128:143], v[192:195], v[60:63], v[128:143]
    buffer_load_dwordx4 v[96:99], v2, s[20:23], s31 offen offset:0 sc1
    ds_read_b128 v[216:219], v14 offset:55296
    v_mfma_f32_32x32x16_bf16 v[144:159], v[196:199], v[60:63], v[144:159]
    ds_read_b128 v[220:223], v14 offset:56320
    s_waitcnt lgkmcnt(4)
    v_mfma_f32_32x32x16_bf16 v[160:175], v[200:203], v[60:63], v[160:175]
    ds_read_b128 v[192:195], v14 offset:57344
    v_mfma_f32_32x32x16_bf16 v[176:191], v[204:207], v[60:63], v[176:191]
    ds_read_b128 v[196:199], v14 offset:58368
    s_waitcnt vmcnt(14) lgkmcnt(4)
    v_mfma_f32_32x32x16_bf16 v[128:143], v[208:211], v[64:67], v[128:143]
    buffer_load_dwordx4 v[100:103], v2, s[20:23], s31 offen offset:1024 sc1
    ds_read_b128 v[200:203], v14 offset:59392
    v_mfma_f32_32x32x16_bf16 v[144:159], v[212:215], v[64:67], v[144:159]
    ds_read_b128 v[204:207], v14 offset:60416
    s_waitcnt lgkmcnt(4)
    v_mfma_f32_32x32x16_bf16 v[160:175], v[216:219], v[64:67], v[160:175]
    buffer_load_dwordx4 a[112:115], v2, s[20:23], s48 offen offset:2048 sc1
    ds_read_b128 v[208:211], v14 offset:61440
    v_mfma_f32_32x32x16_bf16 v[176:191], v[220:223], v[64:67], v[176:191]
    ds_read_b128 v[212:215], v14 offset:62464
    s_waitcnt vmcnt(14) lgkmcnt(4)
    v_mfma_f32_32x32x16_bf16 v[128:143], v[192:195], v[68:71], v[128:143]
    buffer_load_dwordx4 v[104:107], v2, s[20:23], s31 offen offset:2048 sc1
    ds_read_b128 v[216:219], v14 offset:63488
    v_mfma_f32_32x32x16_bf16 v[144:159], v[196:199], v[68:71], v[144:159]
    ds_read_b128 v[220:223], v14 offset:64512
    s_waitcnt lgkmcnt(4)
    v_mfma_f32_32x32x16_bf16 v[160:175], v[200:203], v[68:71], v[160:175]
    buffer_load_dwordx4 a[116:119], v2, s[20:23], s49 offen offset:2048 sc1
    ds_read_b128 v[192:195], v15 offset:0
    v_mfma_f32_32x32x16_bf16 v[176:191], v[204:207], v[68:71], v[176:191]
    ds_read_b128 v[196:199], v15 offset:1024
    s_waitcnt vmcnt(14) lgkmcnt(4)
    v_mfma_f32_32x32x16_bf16 v[128:143], v[208:211], v[72:75], v[128:143]
    buffer_load_dwordx4 v[108:111], v2, s[20:23], s31 offen offset:3072 sc1
    s_add_u32 s31, s31, 4096
    ds_read_b128 v[200:203], v15 offset:2048
    v_mfma_f32_32x32x16_bf16 v[144:159], v[212:215], v[72:75], v[144:159]
    ds_read_b128 v[204:207], v15 offset:3072
    s_waitcnt lgkmcnt(4)
    v_mfma_f32_32x32x16_bf16 v[160:175], v[216:219], v[72:75], v[160:175]
    ds_read_b128 v[208:211], v15 offset:4096
    v_mfma_f32_32x32x16_bf16 v[176:191], v[220:223], v[72:75], v[176:191]
    ds_read_b128 v[212:215], v15 offset:5120
    s_waitcnt vmcnt(14) lgkmcnt(4)
    v_mfma_f32_32x32x16_bf16 v[128:143], v[192:195], v[76:79], v[128:143]
    buffer_load_dwordx4 v[112:115], v2, s[20:23], s31 offen offset:0 sc1
    ds_read_b128 v[216:219], v15 offset:6144
    v_mfma_f32_32x32x16_bf16 v[144:159], v[196:199], v[76:79], v[144:159]
    ds_read_b128 v[220:223], v15 offset:7168
    s_waitcnt lgkmcnt(4)
    v_mfma_f32_32x32x16_bf16 v[160:175], v[200:203], v[76:79], v[160:175]
    buffer_load_dwordx4 a[224:227], v2, s[20:23], s50 offen sc1
    ds_read_b128 v[192:195], v15 offset:8192
    v_mfma_f32_32x32x16_bf16 v[176:191], v[204:207], v[76:79], v[176:191]
    ds_read_b128 v[196:199], v15 offset:9216
    s_waitcnt vmcnt(14) lgkmcnt(4)
    v_mfma_f32_32x32x16_bf16 v[128:143], v[208:211], v[80:83], v[128:143]
    buffer_load_dwordx4 v[116:119], v2, s[20:23], s31 offen offset:1024 sc1
    ds_read_b128 v[200:203], v15 offset:10240
    v_mfma_f32_32x32x16_bf16 v[144:159], v[212:215], v[80:83], v[144:159]
    ds_read_b128 v[204:207], v15 offset:11264
    s_waitcnt lgkmcnt(4)
    v_mfma_f32_32x32x16_bf16 v[160:175], v[216:219], v[80:83], v[160:175]
    buffer_load_dwordx4 a[120:123], v2, s[20:23], s48 offen offset:3072 sc1
    s_add_u32 s48, s48, 4096
    ds_read_b128 v[208:211], v15 offset:12288
    v_mfma_f32_32x32x16_bf16 v[176:191], v[220:223], v[80:83], v[176:191]
    ds_read_b128 v[212:215], v15 offset:13312
    s_waitcnt vmcnt(14) lgkmcnt(4)
    v_mfma_f32_32x32x16_bf16 v[128:143], v[192:195], v[84:87], v[128:143]
    buffer_load_dwordx4 v[120:123], v2, s[20:23], s31 offen offset:2048 sc1
    ds_read_b128 v[216:219], v15 offset:14336
    v_mfma_f32_32x32x16_bf16 v[144:159], v[196:199], v[84:87], v[144:159]
    ds_read_b128 v[220:223], v15 offset:15360
    s_waitcnt lgkmcnt(4)
    v_mfma_f32_32x32x16_bf16 v[160:175], v[200:203], v[84:87], v[160:175]
    ds_read_b128 v[192:195], v15 offset:16384
    v_mfma_f32_32x32x16_bf16 v[176:191], v[204:207], v[84:87], v[176:191]
    ds_read_b128 v[196:199], v15 offset:17408
    s_waitcnt vmcnt(14) lgkmcnt(4)
    v_mfma_f32_32x32x16_bf16 v[128:143], v[208:211], v[88:91], v[128:143]
    buffer_load_dwordx4 v[124:127], v2, s[20:23], s31 offen offset:3072 sc1
    s_add_u32 s31, s31, 4096
    ds_read_b128 v[200:203], v15 offset:18432
    v_mfma_f32_32x32x16_bf16 v[144:159], v[212:215], v[88:91], v[144:159]
    ds_read_b128 v[204:207], v15 offset:19456
    s_waitcnt lgkmcnt(4)
    v_mfma_f32_32x32x16_bf16 v[160:175], v[216:219], v[88:91], v[160:175]
    buffer_load_dwordx4 a[124:127], v2, s[20:23], s49 offen offset:3072 sc1
    s_add_u32 s49, s49, 4096
    ds_read_b128 v[208:211], v15 offset:20480
    v_mfma_f32_32x32x16_bf16 v[176:191], v[220:223], v[88:91], v[176:191]
    ds_read_b128 v[212:215], v15 offset:21504
    s_waitcnt vmcnt(14) lgkmcnt(4)
    v_mfma_f32_32x32x16_bf16 v[128:143], v[192:195], v[92:95], v[128:143]
    buffer_load_dwordx4 a[128:131], v2, s[20:23], s48 offen offset:0 sc1
    ds_read_b128 v[216:219], v15 offset:22528
    v_mfma_f32_32x32x16_bf16 v[144:159], v[196:199], v[92:95], v[144:159]
    ds_read_b128 v[220:223], v15 offset:23552
    s_waitcnt lgkmcnt(4)
    v_mfma_f32_32x32x16_bf16 v[160:175], v[200:203], v[92:95], v[160:175]
    buffer_load_dwordx4 a[132:135], v2, s[20:23], s49 offen offset:0 sc1
    ds_read_b128 v[192:195], v15 offset:24576
    v_mfma_f32_32x32x16_bf16 v[176:191], v[204:207], v[92:95], v[176:191]
    ds_read_b128 v[196:199], v15 offset:25600
    s_waitcnt vmcnt(14) lgkmcnt(4)
    v_mfma_f32_32x32x16_bf16 v[128:143], v[208:211], v[96:99], v[128:143]
    buffer_load_dwordx4 a[136:139], v2, s[20:23], s48 offen offset:1024 sc1
    ds_read_b128 v[200:203], v15 offset:26624
    v_mfma_f32_32x32x16_bf16 v[144:159], v[212:215], v[96:99], v[144:159]
    ds_read_b128 v[204:207], v15 offset:27648
    s_waitcnt lgkmcnt(4)
    v_mfma_f32_32x32x16_bf16 v[160:175], v[216:219], v[96:99], v[160:175]
    buffer_load_dwordx4 a[140:143], v2, s[20:23], s49 offen offset:1024 sc1
    ds_read_b128 v[208:211], v15 offset:28672
    v_mfma_f32_32x32x16_bf16 v[176:191], v[220:223], v[96:99], v[176:191]
    ds_read_b128 v[212:215], v15 offset:29696
    s_waitcnt vmcnt(15) lgkmcnt(4)
    v_mfma_f32_32x32x16_bf16 v[128:143], v[192:195], v[100:103], v[128:143]
    buffer_load_dwordx4 a[144:147], v2, s[20:23], s48 offen offset:2048 sc1
    ds_read_b128 v[216:219], v15 offset:30720
    v_mfma_f32_32x32x16_bf16 v[144:159], v[196:199], v[100:103], v[144:159]
    ds_read_b128 v[220:223], v15 offset:31744
    s_waitcnt lgkmcnt(4)
    v_mfma_f32_32x32x16_bf16 v[160:175], v[200:203], v[100:103], v[160:175]
    buffer_load_dwordx4 a[148:151], v2, s[20:23], s49 offen offset:2048 sc1
    ds_read_b128 v[192:195], v2 offset:0
    v_mfma_f32_32x32x16_bf16 v[176:191], v[204:207], v[100:103], v[176:191]
    ds_read_b128 v[196:199], v2 offset:1024
    s_waitcnt vmcnt(15) lgkmcnt(4)
    v_mfma_f32_32x32x16_bf16 v[128:143], v[208:211], v[104:107], v[128:143]
    buffer_load_dwordx4 a[152:155], v2, s[20:23], s48 offen offset:3072 sc1
    s_add_u32 s48, s48, 4096
    ds_read_b128 v[200:203], v2 offset:2048
    v_mfma_f32_32x32x16_bf16 v[144:159], v[212:215], v[104:107], v[144:159]
    ds_read_b128 v[204:207], v2 offset:3072
    s_waitcnt lgkmcnt(4)
    v_mfma_f32_32x32x16_bf16 v[160:175], v[216:219], v[104:107], v[160:175]
    buffer_load_dwordx4 a[156:159], v2, s[20:23], s49 offen offset:3072 sc1
    s_add_u32 s49, s49, 4096
    ds_read_b128 v[208:211], v2 offset:4096
    v_mfma_f32_32x32x16_bf16 v[176:191], v[220:223], v[104:107], v[176:191]
    ds_read_b128 v[212:215], v2 offset:5120
    s_waitcnt vmcnt(15) lgkmcnt(4)
    v_mfma_f32_32x32x16_bf16 v[128:143], v[192:195], v[108:111], v[128:143]
    buffer_load_dwordx4 a[160:163], v2, s[20:23], s48 offen offset:0 sc1
    ds_read_b128 v[216:219], v2 offset:6144
    v_mfma_f32_32x32x16_bf16 v[144:159], v[196:199], v[108:111], v[144:159]
    ds_read_b128 v[220:223], v2 offset:7168
    s_waitcnt lgkmcnt(4)
    v_mfma_f32_32x32x16_bf16 v[160:175], v[200:203], v[108:111], v[160:175]
    buffer_load_dwordx4 a[164:167], v2, s[20:23], s49 offen offset:0 sc1
    ds_read_b128 v[192:195], v2 offset:8192
    v_mfma_f32_32x32x16_bf16 v[176:191], v[204:207], v[108:111], v[176:191]
    ds_read_b128 v[196:199], v2 offset:9216
    s_waitcnt vmcnt(16) lgkmcnt(4)
    v_mfma_f32_32x32x16_bf16 v[128:143], v[208:211], v[112:115], v[128:143]
    buffer_load_dwordx4 a[168:171], v2, s[20:23], s48 offen offset:1024 sc1
    ds_read_b128 v[200:203], v2 offset:10240
    v_mfma_f32_32x32x16_bf16 v[144:159], v[212:215], v[112:115], v[144:159]
    ds_read_b128 v[204:207], v2 offset:11264
    s_waitcnt lgkmcnt(4)
    v_mfma_f32_32x32x16_bf16 v[160:175], v[216:219], v[112:115], v[160:175]
    buffer_load_dwordx4 a[172:175], v2, s[20:23], s49 offen offset:1024 sc1
    ds_read_b128 v[208:211], v2 offset:12288
    v_mfma_f32_32x32x16_bf16 v[176:191], v[220:223], v[112:115], v[176:191]
    ds_read_b128 v[212:215], v2 offset:13312
    s_waitcnt vmcnt(16) lgkmcnt(4)
    v_mfma_f32_32x32x16_bf16 v[128:143], v[192:195], v[116:119], v[128:143]
    buffer_load_dwordx4 a[176:179], v2, s[20:23], s48 offen offset:2048 sc1
    ds_read_b128 v[216:219], v2 offset:14336
    v_mfma_f32_32x32x16_bf16 v[144:159], v[196:199], v[116:119], v[144:159]
    ds_read_b128 v[220:223], v2 offset:15360
    s_waitcnt lgkmcnt(4)
    v_mfma_f32_32x32x16_bf16 v[160:175], v[200:203], v[116:119], v[160:175]
    buffer_load_dwordx4 a[180:183], v2, s[20:23], s49 offen offset:2048 sc1
    ds_read_b128 v[192:195], v2 offset:16384
    v_mfma_f32_32x32x16_bf16 v[176:191], v[204:207], v[116:119], v[176:191]
    ds_read_b128 v[196:199], v2 offset:17408
    s_waitcnt vmcnt(16) lgkmcnt(4)
    v_mfma_f32_32x32x16_bf16 v[128:143], v[208:211], v[120:123], v[128:143]
    buffer_load_dwordx4 a[184:187], v2, s[20:23], s48 offen offset:3072 sc1
    s_add_u32 s48, s48, 4096
    ds_read_b128 v[200:203], v2 offset:18432
    v_mfma_f32_32x32x16_bf16 v[144:159], v[212:215], v[120:123], v[144:159]
    ds_read_b128 v[204:207], v2 offset:19456
    s_waitcnt lgkmcnt(4)
    v_mfma_f32_32x32x16_bf16 v[160:175], v[216:219], v[120:123], v[160:175]
    buffer_load_dwordx4 a[188:191], v2, s[20:23], s49 offen offset:3072 sc1
    s_add_u32 s49, s49, 4096
    v_mfma_f32_32x32x16_bf16 v[176:191], v[220:223], v[120:123], v[176:191]
    s_waitcnt vmcnt(17) lgkmcnt(2)
    v_mfma_f32_32x32x16_bf16 v[128:143], v[192:195], v[124:127], v[128:143]
    buffer_load_dwordx4 a[192:195], v2, s[20:23], s48 offen offset:0 sc1
    v_mfma_f32_32x32x16_bf16 v[144:159], v[196:199], v[124:127], v[144:159]
    s_waitcnt lgkmcnt(0)
    v_mfma_f32_32x32x16_bf16 v[160:175], v[200:203], v[124:127], v[160:175]
    buffer_load_dwordx4 a[196:199], v2, s[20:23], s49 offen offset:0 sc1
    v_mfma_f32_32x32x16_bf16 v[176:191], v[204:207], v[124:127], v[176:191]
    s_nop 5
    v_pk_fma_f32 v[228:229], v[128:129], v[128:129], v[10:11]
    v_pk_fma_f32 v[230:231], v[130:131], v[130:131], v[10:11]
    v_pk_fma_f32 v[232:233], v[132:133], v[132:133], v[10:11]
    v_pk_fma_f32 v[234:235], v[134:135], v[134:135], v[10:11]
    v_pk_mul_f32 v[228:229], v[128:129], v[228:229]
    v_pk_mul_f32 v[230:231], v[130:131], v[230:231]
    v_pk_mul_f32 v[232:233], v[132:133], v[232:233]
    v_pk_mul_f32 v[234:235], v[134:135], v[234:235]
    v_exp_f32_e64 v228, -v228
    v_exp_f32_e64 v229, -v229
    v_exp_f32_e64 v230, -v230
    v_exp_f32_e64 v231, -v231
    v_exp_f32_e64 v232, -v232
    v_exp_f32_e64 v233, -v233
    v_exp_f32_e64 v234, -v234
    v_exp_f32_e64 v235, -v235
    v_pk_add_f32 v[228:229], v[228:229], v[12:13]
    v_pk_add_f32 v[230:231], v[230:231], v[12:13]
    v_pk_add_f32 v[232:233], v[232:233], v[12:13]
    v_pk_add_f32 v[234:235], v[234:235], v[12:13]
    v_rcp_f32 v228, v228
    v_rcp_f32 v229, v229
    v_rcp_f32 v230, v230
    v_rcp_f32 v231, v231
    v_rcp_f32 v232, v232
    v_rcp_f32 v233, v233
    v_rcp_f32 v234, v234
    v_rcp_f32 v235, v235
    v_pk_mul_f32 v[228:229], v[128:129], v[228:229]
    v_pk_mul_f32 v[230:231], v[130:131], v[230:231]
    v_pk_mul_f32 v[232:233], v[132:133], v[232:233]
    v_pk_mul_f32 v[234:235], v[134:135], v[234:235]
    v_cvt_pk_bf16_f32 v236, v228, v229
    v_cvt_pk_bf16_f32 v237, v230, v231
    v_cvt_pk_bf16_f32 v238, v232, v233
    v_cvt_pk_bf16_f32 v239, v234, v235
    buffer_store_dwordx4 v[236:239], v2, s[20:23], s32 offen offset:0 sc1
    v_pk_fma_f32 v[228:229], v[136:137], v[136:137], v[10:11]
    v_pk_fma_f32 v[230:231], v[138:139], v[138:139], v[10:11]
    v_pk_fma_f32 v[232:233], v[140:141], v[140:141], v[10:11]
    v_pk_fma_f32 v[234:235], v[142:143], v[142:143], v[10:11]
    v_pk_mul_f32 v[228:229], v[136:137], v[228:229]
    v_pk_mul_f32 v[230:231], v[138:139], v[230:231]
    v_pk_mul_f32 v[232:233], v[140:141], v[232:233]
    v_pk_mul_f32 v[234:235], v[142:143], v[234:235]
    v_exp_f32_e64 v228, -v228
    v_exp_f32_e64 v229, -v229
    v_exp_f32_e64 v230, -v230
    v_exp_f32_e64 v231, -v231
    v_exp_f32_e64 v232, -v232
    v_exp_f32_e64 v233, -v233
    v_exp_f32_e64 v234, -v234
    v_exp_f32_e64 v235, -v235
    v_pk_add_f32 v[228:229], v[228:229], v[12:13]
    v_pk_add_f32 v[230:231], v[230:231], v[12:13]
    v_pk_add_f32 v[232:233], v[232:233], v[12:13]
    v_pk_add_f32 v[234:235], v[234:235], v[12:13]
    v_rcp_f32 v228, v228
    v_rcp_f32 v229, v229
    v_rcp_f32 v230, v230
    v_rcp_f32 v231, v231
    v_rcp_f32 v232, v232
    v_rcp_f32 v233, v233
    v_rcp_f32 v234, v234
    v_rcp_f32 v235, v235
    v_pk_mul_f32 v[228:229], v[136:137], v[228:229]
    v_pk_mul_f32 v[230:231], v[138:139], v[230:231]
    v_pk_mul_f32 v[232:233], v[140:141], v[232:233]
    v_pk_mul_f32 v[234:235], v[142:143], v[234:235]
    v_cvt_pk_bf16_f32 v240, v228, v229
    v_cvt_pk_bf16_f32 v241, v230, v231
    v_cvt_pk_bf16_f32 v242, v232, v233
    v_cvt_pk_bf16_f32 v243, v234, v235
    buffer_store_dwordx4 v[240:243], v2, s[20:23], s32 offen offset:1024 sc1
    v_pk_fma_f32 v[228:229], v[144:145], v[144:145], v[10:11]
    v_pk_fma_f32 v[230:231], v[146:147], v[146:147], v[10:11]
    v_pk_fma_f32 v[232:233], v[148:149], v[148:149], v[10:11]
    v_pk_fma_f32 v[234:235], v[150:151], v[150:151], v[10:11]
    v_pk_mul_f32 v[228:229], v[144:145], v[228:229]
    v_pk_mul_f32 v[230:231], v[146:147], v[230:231]
    v_pk_mul_f32 v[232:233], v[148:149], v[232:233]
    v_pk_mul_f32 v[234:235], v[150:151], v[234:235]
    v_exp_f32_e64 v228, -v228
    v_exp_f32_e64 v229, -v229
    v_exp_f32_e64 v230, -v230
    v_exp_f32_e64 v231, -v231
    v_exp_f32_e64 v232, -v232
    v_exp_f32_e64 v233, -v233
    v_exp_f32_e64 v234, -v234
    v_exp_f32_e64 v235, -v235
    v_pk_add_f32 v[228:229], v[228:229], v[12:13]
    v_pk_add_f32 v[230:231], v[230:231], v[12:13]
    v_pk_add_f32 v[232:233], v[232:233], v[12:13]
    v_pk_add_f32 v[234:235], v[234:235], v[12:13]
    v_rcp_f32 v228, v228
    v_rcp_f32 v229, v229
    v_rcp_f32 v230, v230
    v_rcp_f32 v231, v231
    v_rcp_f32 v232, v232
    v_rcp_f32 v233, v233
    v_rcp_f32 v234, v234
    v_rcp_f32 v235, v235
    v_pk_mul_f32 v[228:229], v[144:145], v[228:229]
    v_pk_mul_f32 v[230:231], v[146:147], v[230:231]
    v_pk_mul_f32 v[232:233], v[148:149], v[232:233]
    v_pk_mul_f32 v[234:235], v[150:151], v[234:235]
    v_cvt_pk_bf16_f32 v236, v228, v229
    v_cvt_pk_bf16_f32 v237, v230, v231
    v_cvt_pk_bf16_f32 v238, v232, v233
    v_cvt_pk_bf16_f32 v239, v234, v235
    buffer_store_dwordx4 v[236:239], v2, s[20:23], s32 offen offset:2048 sc1
    v_pk_fma_f32 v[228:229], v[152:153], v[152:153], v[10:11]
    v_pk_fma_f32 v[230:231], v[154:155], v[154:155], v[10:11]
    v_pk_fma_f32 v[232:233], v[156:157], v[156:157], v[10:11]
    v_pk_fma_f32 v[234:235], v[158:159], v[158:159], v[10:11]
    v_pk_mul_f32 v[228:229], v[152:153], v[228:229]
    v_pk_mul_f32 v[230:231], v[154:155], v[230:231]
    v_pk_mul_f32 v[232:233], v[156:157], v[232:233]
    v_pk_mul_f32 v[234:235], v[158:159], v[234:235]
    v_exp_f32_e64 v228, -v228
    v_exp_f32_e64 v229, -v229
    v_exp_f32_e64 v230, -v230
    v_exp_f32_e64 v231, -v231
    v_exp_f32_e64 v232, -v232
    v_exp_f32_e64 v233, -v233
    v_exp_f32_e64 v234, -v234
    v_exp_f32_e64 v235, -v235
    v_pk_add_f32 v[228:229], v[228:229], v[12:13]
    v_pk_add_f32 v[230:231], v[230:231], v[12:13]
    v_pk_add_f32 v[232:233], v[232:233], v[12:13]
    v_pk_add_f32 v[234:235], v[234:235], v[12:13]
    v_rcp_f32 v228, v228
    v_rcp_f32 v229, v229
    v_rcp_f32 v230, v230
    v_rcp_f32 v231, v231
    v_rcp_f32 v232, v232
    v_rcp_f32 v233, v233
    v_rcp_f32 v234, v234
    v_rcp_f32 v235, v235
    v_pk_mul_f32 v[228:229], v[152:153], v[228:229]
    v_pk_mul_f32 v[230:231], v[154:155], v[230:231]
    v_pk_mul_f32 v[232:233], v[156:157], v[232:233]
    v_pk_mul_f32 v[234:235], v[158:159], v[234:235]
    v_cvt_pk_bf16_f32 v240, v228, v229
    v_cvt_pk_bf16_f32 v241, v230, v231
    v_cvt_pk_bf16_f32 v242, v232, v233
    v_cvt_pk_bf16_f32 v243, v234, v235
    buffer_store_dwordx4 v[240:243], v2, s[20:23], s32 offen offset:3072 sc1
    v_pk_fma_f32 v[228:229], v[160:161], v[160:161], v[10:11]
    v_pk_fma_f32 v[230:231], v[162:163], v[162:163], v[10:11]
    v_pk_fma_f32 v[232:233], v[164:165], v[164:165], v[10:11]
    v_pk_fma_f32 v[234:235], v[166:167], v[166:167], v[10:11]
    v_pk_mul_f32 v[228:229], v[160:161], v[228:229]
    v_pk_mul_f32 v[230:231], v[162:163], v[230:231]
    v_pk_mul_f32 v[232:233], v[164:165], v[232:233]
    v_pk_mul_f32 v[234:235], v[166:167], v[234:235]
    v_exp_f32_e64 v228, -v228
    v_exp_f32_e64 v229, -v229
    v_exp_f32_e64 v230, -v230
    v_exp_f32_e64 v231, -v231
    v_exp_f32_e64 v232, -v232
    v_exp_f32_e64 v233, -v233
    v_exp_f32_e64 v234, -v234
    v_exp_f32_e64 v235, -v235
    v_pk_add_f32 v[228:229], v[228:229], v[12:13]
    v_pk_add_f32 v[230:231], v[230:231], v[12:13]
    v_pk_add_f32 v[232:233], v[232:233], v[12:13]
    v_pk_add_f32 v[234:235], v[234:235], v[12:13]
    v_rcp_f32 v228, v228
    v_rcp_f32 v229, v229
    v_rcp_f32 v230, v230
    v_rcp_f32 v231, v231
    v_rcp_f32 v232, v232
    v_rcp_f32 v233, v233
    v_rcp_f32 v234, v234
    v_rcp_f32 v235, v235
    v_pk_mul_f32 v[228:229], v[160:161], v[228:229]
    v_pk_mul_f32 v[230:231], v[162:163], v[230:231]
    v_pk_mul_f32 v[232:233], v[164:165], v[232:233]
    v_pk_mul_f32 v[234:235], v[166:167], v[234:235]
    v_cvt_pk_bf16_f32 v236, v228, v229
    v_cvt_pk_bf16_f32 v237, v230, v231
    v_cvt_pk_bf16_f32 v238, v232, v233
    v_cvt_pk_bf16_f32 v239, v234, v235
    buffer_store_dwordx4 v[236:239], v2, s[20:23], s33 offen offset:0 sc1
    v_pk_fma_f32 v[228:229], v[168:169], v[168:169], v[10:11]
    v_pk_fma_f32 v[230:231], v[170:171], v[170:171], v[10:11]
    v_pk_fma_f32 v[232:233], v[172:173], v[172:173], v[10:11]
    v_pk_fma_f32 v[234:235], v[174:175], v[174:175], v[10:11]
    v_pk_mul_f32 v[228:229], v[168:169], v[228:229]
    v_pk_mul_f32 v[230:231], v[170:171], v[230:231]
    v_pk_mul_f32 v[232:233], v[172:173], v[232:233]
    v_pk_mul_f32 v[234:235], v[174:175], v[234:235]
    v_exp_f32_e64 v228, -v228
    v_exp_f32_e64 v229, -v229
    v_exp_f32_e64 v230, -v230
    v_exp_f32_e64 v231, -v231
    v_exp_f32_e64 v232, -v232
    v_exp_f32_e64 v233, -v233
    v_exp_f32_e64 v234, -v234
    v_exp_f32_e64 v235, -v235
    v_pk_add_f32 v[228:229], v[228:229], v[12:13]
    v_pk_add_f32 v[230:231], v[230:231], v[12:13]
    v_pk_add_f32 v[232:233], v[232:233], v[12:13]
    v_pk_add_f32 v[234:235], v[234:235], v[12:13]
    v_rcp_f32 v228, v228
    v_rcp_f32 v229, v229
    v_rcp_f32 v230, v230
    v_rcp_f32 v231, v231
    v_rcp_f32 v232, v232
    v_rcp_f32 v233, v233
    v_rcp_f32 v234, v234
    v_rcp_f32 v235, v235
    v_pk_mul_f32 v[228:229], v[168:169], v[228:229]
    v_pk_mul_f32 v[230:231], v[170:171], v[230:231]
    v_pk_mul_f32 v[232:233], v[172:173], v[232:233]
    v_pk_mul_f32 v[234:235], v[174:175], v[234:235]
    v_cvt_pk_bf16_f32 v240, v228, v229
    v_cvt_pk_bf16_f32 v241, v230, v231
    v_cvt_pk_bf16_f32 v242, v232, v233
    v_cvt_pk_bf16_f32 v243, v234, v235
    buffer_store_dwordx4 v[240:243], v2, s[20:23], s33 offen offset:1024 sc1
    v_pk_fma_f32 v[228:229], v[176:177], v[176:177], v[10:11]
    v_pk_fma_f32 v[230:231], v[178:179], v[178:179], v[10:11]
    v_pk_fma_f32 v[232:233], v[180:181], v[180:181], v[10:11]
    v_pk_fma_f32 v[234:235], v[182:183], v[182:183], v[10:11]
    v_pk_mul_f32 v[228:229], v[176:177], v[228:229]
    v_pk_mul_f32 v[230:231], v[178:179], v[230:231]
    v_pk_mul_f32 v[232:233], v[180:181], v[232:233]
    v_pk_mul_f32 v[234:235], v[182:183], v[234:235]
    v_exp_f32_e64 v228, -v228
    v_exp_f32_e64 v229, -v229
    v_exp_f32_e64 v230, -v230
    v_exp_f32_e64 v231, -v231
    v_exp_f32_e64 v232, -v232
    v_exp_f32_e64 v233, -v233
    v_exp_f32_e64 v234, -v234
    v_exp_f32_e64 v235, -v235
    v_pk_add_f32 v[228:229], v[228:229], v[12:13]
    v_pk_add_f32 v[230:231], v[230:231], v[12:13]
    v_pk_add_f32 v[232:233], v[232:233], v[12:13]
    v_pk_add_f32 v[234:235], v[234:235], v[12:13]
    v_rcp_f32 v228, v228
    v_rcp_f32 v229, v229
    v_rcp_f32 v230, v230
    v_rcp_f32 v231, v231
    v_rcp_f32 v232, v232
    v_rcp_f32 v233, v233
    v_rcp_f32 v234, v234
    v_rcp_f32 v235, v235
    v_pk_mul_f32 v[228:229], v[176:177], v[228:229]
    v_pk_mul_f32 v[230:231], v[178:179], v[230:231]
    v_pk_mul_f32 v[232:233], v[180:181], v[232:233]
    v_pk_mul_f32 v[234:235], v[182:183], v[234:235]
    v_cvt_pk_bf16_f32 v236, v228, v229
    v_cvt_pk_bf16_f32 v237, v230, v231
    v_cvt_pk_bf16_f32 v238, v232, v233
    v_cvt_pk_bf16_f32 v239, v234, v235
    buffer_store_dwordx4 v[236:239], v2, s[20:23], s33 offen offset:2048 sc1
    v_pk_fma_f32 v[228:229], v[184:185], v[184:185], v[10:11]
    v_pk_fma_f32 v[230:231], v[186:187], v[186:187], v[10:11]
    v_pk_fma_f32 v[232:233], v[188:189], v[188:189], v[10:11]
    v_pk_fma_f32 v[234:235], v[190:191], v[190:191], v[10:11]
    v_pk_mul_f32 v[228:229], v[184:185], v[228:229]
    v_pk_mul_f32 v[230:231], v[186:187], v[230:231]
    v_pk_mul_f32 v[232:233], v[188:189], v[232:233]
    v_pk_mul_f32 v[234:235], v[190:191], v[234:235]
    v_exp_f32_e64 v228, -v228
    v_exp_f32_e64 v229, -v229
    v_exp_f32_e64 v230, -v230
    v_exp_f32_e64 v231, -v231
    v_exp_f32_e64 v232, -v232
    v_exp_f32_e64 v233, -v233
    v_exp_f32_e64 v234, -v234
    v_exp_f32_e64 v235, -v235
    v_pk_add_f32 v[228:229], v[228:229], v[12:13]
    v_pk_add_f32 v[230:231], v[230:231], v[12:13]
    v_pk_add_f32 v[232:233], v[232:233], v[12:13]
    v_pk_add_f32 v[234:235], v[234:235], v[12:13]
    v_rcp_f32 v228, v228
    v_rcp_f32 v229, v229
    v_rcp_f32 v230, v230
    v_rcp_f32 v231, v231
    v_rcp_f32 v232, v232
    v_rcp_f32 v233, v233
    v_rcp_f32 v234, v234
    v_rcp_f32 v235, v235
    v_pk_mul_f32 v[228:229], v[184:185], v[228:229]
    v_pk_mul_f32 v[230:231], v[186:187], v[230:231]
    v_pk_mul_f32 v[232:233], v[188:189], v[232:233]
    v_pk_mul_f32 v[234:235], v[190:191], v[234:235]
    v_cvt_pk_bf16_f32 v240, v228, v229
    v_cvt_pk_bf16_f32 v241, v230, v231
    v_cvt_pk_bf16_f32 v242, v232, v233
    v_cvt_pk_bf16_f32 v243, v234, v235
    buffer_store_dwordx4 v[240:243], v2, s[20:23], s33 offen offset:3072 sc1
    v_mov_b32 v6, s62
    v_mov_b32 v7, s63
    s_lshl_b32 s40, s17, 8
    s_add_u32 s40, s40, 0x3c1000
    s_lshl_b32 s41, s18, 3
    s_add_u32 s41, s41, s40
    v_min_u32 v4, 13, v1
    v_lshlrev_b32 v4, 3, v4
    buffer_load_dwordx4 a[200:203], v2, s[20:23], s48 offen offset:1024 sc1
    buffer_load_dwordx4 a[204:207], v2, s[20:23], s49 offen offset:1024 sc1
    buffer_load_dwordx4 a[208:211], v2, s[20:23], s48 offen offset:2048 sc1
    buffer_load_dwordx4 a[212:215], v2, s[20:23], s49 offen offset:2048 sc1
    buffer_load_dwordx4 a[216:219], v2, s[20:23], s48 offen offset:3072 sc1
    s_add_u32 s48, s48, 4096
    buffer_load_dwordx4 a[220:223], v2, s[20:23], s49 offen offset:3072 sc1
    s_add_u32 s49, s49, 4096
    s_cmp_lg_u32 s16, 0
    s_waitcnt vmcnt(6)
    s_barrier
    s_cbranch_scc1 K_sig16
    s_mov_b64 exec, 1
    buffer_store_dwordx2 v[6:7], off, s[20:23], s41
    buffer_store_dwordx2 v[6:7], off, s[20:23], s41 offset:128 sc1
    s_mov_b64 exec, -1
K_sig16:
    s_cmp_lg_u32 s16, 0
    s_cbranch_scc1 K_wdone17
    buffer_load_dwordx2 v[6:7], v4, s[20:23], s40 offen sc1
    s_mov_b64 s[42:43], 0
    s_mov_b32 s3, 0
K_wloop18:
    s_waitcnt vmcnt(0)
    v_cmp_eq_u64 vcc, s[62:63], v[6:7]
    s_or_b64 s[42:43], s[42:43], vcc
    s_cmp_eq_u64 s[42:43], -1
    s_cbranch_scc1 K_wgot20
    s_add_u32 s3, s3, 1
    s_bitcmp1_b32 s3, 3
    s_cbranch_scc0 K_wskip19
    s_add_u32 s3, s3, 7
    buffer_load_dwordx2 v[6:7], v4, s[20:23], s40 offen offset:128 sc1
    s_cmp_gt_u32 s3, 0x40000
    s_cbranch_scc0 K_wloop18
    s_branch K_wgot20
K_wskip19:
    buffer_load_dwordx2 v[6:7], v4, s[20:23], s40 offen sc1
    s_branch K_wloop18
K_wgot20:
    s_waitcnt vmcnt(0)
K_wdone17:
    s_barrier
    buffer_load_dwordx4 v[80:83], v2, s[20:23], s46 offen offset:0 sc1
    buffer_load_dwordx4 v[84:87], v2, s[20:23], s47 offen offset:0 sc1
    buffer_load_dwordx4 v[88:91], v2, s[20:23], s46 offen offset:1024 sc1
    buffer_load_dwordx4 v[92:95], v2, s[20:23], s47 offen offset:1024 sc1
    buffer_load_dwordx4 v[96:99], v2, s[20:23], s46 offen offset:2048 sc1
    buffer_load_dwordx4 v[100:103], v2, s[20:23], s47 offen offset:2048 sc1
    buffer_load_dwordx4 v[104:107], v2, s[20:23], s46 offen offset:3072 sc1
    s_add_u32 s46, s46, 4096
    buffer_load_dwordx4 v[108:111], v2, s[20:23], s47 offen offset:3072 sc1
    s_add_u32 s47, s47, 4096
    buffer_load_dwordx4 v[112:115], v2, s[20:23], s46 offen offset:0 sc1
    buffer_load_dwordx4 v[116:119], v2, s[20:23], s47 offen offset:0 sc1
    buffer_load_dwordx4 v[120:123], v2, s[20:23], s46 offen offset:1024 sc1
    buffer_load_dwordx4 v[124:127], v2, s[20:23], s47 offen offset:1024 sc1
    v_mfma_f32_32x32x16_bf16 v[16:31], a[224:227], v[224:227], 0
    s_add_u32 s52, s51, 0x800000
    s_cmp_eq_u32 s18, 15
    s_cselect_b32 s24, s10, s8
    s_cselect_b32 s25, s11, s9
    s_cmp_lt_u32 s18, 14
    s_cselect_b32 s24, s6, s24
    s_cselect_b32 s25, s7, s25
    s_movk_i32 s26, 25088
    s_cselect_b32 s26, 401408, s26
    s_mov_b32 s27, 0x20000
    s_cselect_b32 s37, 896, 56
    s_cselect_b32 s38, s18, 0
    s_lshl_b32 s38, s38, 6
    v_lshrrev_b32 v4, 2, v1
    v_and_b32 v5, 3, v1
    v_lshlrev_b32 v5, 4, v5
    v_mul_lo_u32 v4, v4, s37
    v_add3_u32 v4, v4, v5, s38
    s_mul_i32 s39, s16, 7
    s_lshl_b32 s37, s37, 4
    s_mul_i32 s40, s39, s37
    s_lshl_b32 s41, s39, 10
    s_add_u32 m0, s41, 49152
    s_nop 0
    s_waitcnt vmcnt(11)
    v_mfma_f32_32x32x16_bf16 v[16:31], a[0:3], v[80:83], v[16:31]
    buffer_load_dwordx4 v[128:131], v2, s[20:23], s46 offen offset:2048 sc1
    v_mfma_f32_32x32x16_bf16 v[32:47], a[4:7], v[80:83], 0
    s_waitcnt vmcnt(11)
    v_mfma_f32_32x32x16_bf16 v[48:63], a[0:3], v[84:87], 0
    buffer_load_dwordx4 v[132:135], v2, s[20:23], s47 offen offset:2048 sc1
    v_mfma_f32_32x32x16_bf16 v[64:79], a[4:7], v[84:87], 0
    s_waitcnt vmcnt(11)
    v_mfma_f32_32x32x16_bf16 v[16:31], a[8:11], v[88:91], v[16:31]
    buffer_load_dwordx4 v[136:139], v2, s[20:23], s46 offen offset:3072 sc1
    s_add_u32 s46, s46, 4096
    v_mfma_f32_32x32x16_bf16 v[32:47], a[12:15], v[88:91], v[32:47]
    s_waitcnt vmcnt(11)
    v_mfma_f32_32x32x16_bf16 v[48:63], a[8:11], v[92:95], v[48:63]
    buffer_load_dwordx4 v[140:143], v2, s[20:23], s47 offen offset:3072 sc1
    s_add_u32 s47, s47, 4096
    v_mfma_f32_32x32x16_bf16 v[64:79], a[12:15], v[92:95], v[64:79]
    s_waitcnt vmcnt(11)
    v_mfma_f32_32x32x16_bf16 v[16:31], a[16:19], v[96:99], v[16:31]
    buffer_load_dwordx4 v[144:147], v2, s[20:23], s46 offen offset:0 sc1
    v_mfma_f32_32x32x16_bf16 v[32:47], a[20:23], v[96:99], v[32:47]
    s_waitcnt vmcnt(11)
    v_mfma_f32_32x32x16_bf16 v[48:63], a[16:19], v[100:103], v[48:63]
    buffer_load_dwordx4 v[148:151], v2, s[20:23], s47 offen offset:0 sc1
    v_mfma_f32_32x32x16_bf16 v[64:79], a[20:23], v[100:103], v[64:79]
    s_waitcnt vmcnt(11)
    v_mfma_f32_32x32x16_bf16 v[16:31], a[24:27], v[104:107], v[16:31]
    buffer_load_dwordx4 v[152:155], v2, s[20:23], s46 offen offset:1024 sc1
    v_mfma_f32_32x32x16_bf16 v[32:47], a[28:31], v[104:107], v[32:47]
    s_waitcnt vmcnt(11)
    v_mfma_f32_32x32x16_bf16 v[48:63], a[24:27], v[108:111], v[48:63]
    buffer_load_dwordx4 v[156:159], v2, s[20:23], s47 offen offset:1024 sc1
    v_mfma_f32_32x32x16_bf16 v[64:79], a[28:31], v[108:111], v[64:79]
    s_waitcnt vmcnt(11)
    v_mfma_f32_32x32x16_bf16 v[16:31], a[32:35], v[112:115], v[16:31]
    buffer_load_dwordx4 v[160:163], v2, s[20:23], s46 offen offset:2048 sc1
    v_mfma_f32_32x32x16_bf16 v[32:47], a[36:39], v[112:115], v[32:47]
    s_waitcnt vmcnt(11)
    v_mfma_f32_32x32x16_bf16 v[48:63], a[32:35], v[116:119], v[48:63]
    buffer_load_dwordx4 v[164:167], v2, s[20:23], s47 offen offset:2048 sc1
    v_mfma_f32_32x32x16_bf16 v[64:79], a[36:39], v[116:119], v[64:79]
    s_waitcnt vmcnt(11)
    v_mfma_f32_32x32x16_bf16 v[16:31], a[40:43], v[120:123], v[16:31]
    buffer_load_dwordx4 v[168:171], v2, s[20:23], s46 offen offset:3072 sc1
    s_add_u32 s46, s46, s53
    v_mfma_f32_32x32x16_bf16 v[32:47], a[44:47], v[120:123], v[32:47]
    s_waitcnt vmcnt(11)
    v_mfma_f32_32x32x16_bf16 v[48:63], a[40:43], v[124:127], v[48:63]
    buffer_load_dwordx4 v[172:175], v2, s[20:23], s47 offen offset:3072 sc1
    s_add_u32 s47, s47, s53
    v_mfma_f32_32x32x16_bf16 v[64:79], a[44:47], v[124:127], v[64:79]
    s_waitcnt vmcnt(11)
    v_mfma_f32_32x32x16_bf16 v[16:31], a[48:51], v[128:131], v[16:31]
    buffer_load_dwordx4 v[176:179], v2, s[20:23], s46 offen offset:0 sc1
    v_mfma_f32_32x32x16_bf16 v[32:47], a[52:55], v[128:131], v[32:47]
    s_waitcnt vmcnt(11)
    v_mfma_f32_32x32x16_bf16 v[48:63], a[48:51], v[132:135], v[48:63]
    buffer_load_dwordx4 v[180:183], v2, s[20:23], s47 offen offset:0 sc1
    v_mfma_f32_32x32x16_bf16 v[64:79], a[52:55], v[132:135], v[64:79]
    s_waitcnt vmcnt(11)
    v_mfma_f32_32x32x16_bf16 v[16:31], a[56:59], v[136:139], v[16:31]
    buffer_load_dwordx4 v[184:187], v2, s[20:23], s46 offen offset:1024 sc1
    v_mfma_f32_32x32x16_bf16 v[32:47], a[60:63], v[136:139], v[32:47]
    s_waitcnt vmcnt(11)
    v_mfma_f32_32x32x16_bf16 v[48:63], a[56:59], v[140:143], v[48:63]
    buffer_load_dwordx4 v[188:191], v2, s[20:23], s47 offen offset:1024 sc1
    v_mfma_f32_32x32x16_bf16 v[64:79], a[60:63], v[140:143], v[64:79]
    s_waitcnt vmcnt(11)
    v_mfma_f32_32x32x16_bf16 v[16:31], a[64:67], v[144:147], v[16:31]
    buffer_load_dwordx4 v[192:195], v2, s[20:23], s46 offen offset:2048 sc1
    v_mfma_f32_32x32x16_bf16 v[32:47], a[68:71], v[144:147], v[32:47]
    s_waitcnt vmcnt(11)
    v_mfma_f32_32x32x16_bf16 v[48:63], a[64:67], v[148:151], v[48:63]
    buffer_load_dwordx4 v[196:199], v2, s[20:23], s47 offen offset:2048 sc1
    v_mfma_f32_32x32x16_bf16 v[64:79], a[68:71], v[148:151], v[64:79]
    s_waitcnt vmcnt(11)
    v_mfma_f32_32x32x16_bf16 v[16:31], a[72:75], v[152:155], v[16:31]
    buffer_load_dwordx4 v[200:203], v2, s[20:23], s46 offen offset:3072 sc1
    s_add_u32 s46, s46, 4096
    v_mfma_f32_32x32x16_bf16 v[32:47], a[76:79], v[152:155], v[32:47]
    s_waitcnt vmcnt(11)
    v_mfma_f32_32x32x16_bf16 v[48:63], a[72:75], v[156:159], v[48:63]
    buffer_load_dwordx4 v[204:207], v2, s[20:23], s47 offen offset:3072 sc1
    s_add_u32 s47, s47, 4096
    v_mfma_f32_32x32x16_bf16 v[64:79], a[76:79], v[156:159], v[64:79]
    s_waitcnt vmcnt(11)
    v_mfma_f32_32x32x16_bf16 v[16:31], a[80:83], v[160:163], v[16:31]
    buffer_load_dwordx4 v[80:83], v2, s[20:23], s46 offen offset:0 sc1
    v_mfma_f32_32x32x16_bf16 v[32:47], a[84:87], v[160:163], v[32:47]
    s_waitcnt vmcnt(11)
    v_mfma_f32_32x32x16_bf16 v[48:63], a[80:83], v[164:167], v[48:63]
    buffer_load_dwordx4 v[84:87], v2, s[20:23], s47 offen offset:0 sc1
    v_mfma_f32_32x32x16_bf16 v[64:79], a[84:87], v[164:167], v[64:79]
    s_waitcnt vmcnt(11)
    v_mfma_f32_32x32x16_bf16 v[16:31], a[88:91], v[168:171], v[16:31]
    buffer_load_dwordx4 v[88:91], v2, s[20:23], s46 offen offset:1024 sc1
    v_mfma_f32_32x32x16_bf16 v[32:47], a[92:95], v[168:171], v[32:47]
    s_waitcnt vmcnt(11)
    v_mfma_f32_32x32x16_bf16 v[48:63], a[88:91], v[172:175], v[48:63]
    buffer_load_dwordx4 v[92:95], v2, s[20:23], s47 offen offset:1024 sc1
    v_mfma_f32_32x32x16_bf16 v[64:79], a[92:95], v[172:175], v[64:79]
    s_waitcnt vmcnt(11)
    v_mfma_f32_32x32x16_bf16 v[16:31], a[96:99], v[176:179], v[16:31]
    buffer_load_dwordx4 v[96:99], v2, s[20:23], s46 offen offset:2048 sc1
    v_mfma_f32_32x32x16_bf16 v[32:47], a[100:103], v[176:179], v[32:47]
    s_waitcnt vmcnt(11)
    v_mfma_f32_32x32x16_bf16 v[48:63], a[96:99], v[180:183], v[48:63]
    buffer_load_dwordx4 v[100:103], v2, s[20:23], s47 offen offset:2048 sc1
    v_mfma_f32_32x32x16_bf16 v[64:79], a[100:103], v[180:183], v[64:79]
    s_waitcnt vmcnt(11)
    v_mfma_f32_32x32x16_bf16 v[16:31], a[104:107], v[184:187], v[16:31]
    buffer_load_dwordx4 v[104:107], v2, s[20:23], s46 offen offset:3072 sc1
    s_add_u32 s46, s46, 4096
    v_mfma_f32_32x32x16_bf16 v[32:47], a[108:111], v[184:187], v[32:47]
    s_waitcnt vmcnt(11)
    v_mfma_f32_32x32x16_bf16 v[48:63], a[104:107], v[188:191], v[48:63]
    buffer_load_dwordx4 v[108:111], v2, s[20:23], s47 offen offset:3072 sc1
    s_add_u32 s47, s47, 4096
    v_mfma_f32_32x32x16_bf16 v[64:79], a[108:111], v[188:191], v[64:79]
    s_waitcnt vmcnt(11)
    v_mfma_f32_32x32x16_bf16 v[16:31], a[112:115], v[192:195], v[16:31]
    buffer_load_dwordx4 v[112:115], v2, s[20:23], s46 offen offset:0 sc1
    v_mfma_f32_32x32x16_bf16 v[32:47], a[116:119], v[192:195], v[32:47]
    s_waitcnt vmcnt(11)
    v_mfma_f32_32x32x16_bf16 v[48:63], a[112:115], v[196:199], v[48:63]
    buffer_load_dwordx4 v[116:119], v2, s[20:23], s47 offen offset:0 sc1
    v_mfma_f32_32x32x16_bf16 v[64:79], a[116:119], v[196:199], v[64:79]
    s_waitcnt vmcnt(11)
    v_mfma_f32_32x32x16_bf16 v[16:31], a[120:123], v[200:203], v[16:31]
    buffer_load_dwordx4 v[120:123], v2, s[20:23], s46 offen offset:1024 sc1
    v_mfma_f32_32x32x16_bf16 v[32:47], a[124:127], v[200:203], v[32:47]
    s_waitcnt vmcnt(11)
    v_mfma_f32_32x32x16_bf16 v[48:63], a[120:123], v[204:207], v[48:63]
    buffer_load_dwordx4 v[124:127], v2, s[20:23], s47 offen offset:1024 sc1
    v_mfma_f32_32x32x16_bf16 v[64:79], a[124:127], v[204:207], v[64:79]
    s_waitcnt vmcnt(11)
    v_mfma_f32_32x32x16_bf16 v[16:31], a[128:131], v[80:83], v[16:31]
    buffer_load_dwordx4 v[128:131], v2, s[20:23], s46 offen offset:2048 sc1
    v_mfma_f32_32x32x16_bf16 v[32:47], a[132:135], v[80:83], v[32:47]
    s_waitcnt vmcnt(11)
    v_mfma_f32_32x32x16_bf16 v[48:63], a[128:131], v[84:87], v[48:63]
    buffer_load_dwordx4 v[132:135], v2, s[20:23], s47 offen offset:2048 sc1
    v_mfma_f32_32x32x16_bf16 v[64:79], a[132:135], v[84:87], v[64:79]
    s_waitcnt vmcnt(11)
    v_mfma_f32_32x32x16_bf16 v[16:31], a[136:139], v[88:91], v[16:31]
    buffer_load_dwordx4 v[136:139], v2, s[20:23], s46 offen offset:3072 sc1
    s_add_u32 s46, s46, 4096
    v_mfma_f32_32x32x16_bf16 v[32:47], a[140:143], v[88:91], v[32:47]
    s_waitcnt vmcnt(11)
    v_mfma_f32_32x32x16_bf16 v[48:63], a[136:139], v[92:95], v[48:63]
    buffer_load_dwordx4 v[140:143], v2, s[20:23], s47 offen offset:3072 sc1
    s_add_u32 s47, s47, 4096
    v_mfma_f32_32x32x16_bf16 v[64:79], a[140:143], v[92:95], v[64:79]
    s_waitcnt vmcnt(11)
    v_mfma_f32_32x32x16_bf16 v[16:31], a[144:147], v[96:99], v[16:31]
    buffer_load_dwordx4 v[144:147], v2, s[20:23], s46 offen offset:0 sc1
    v_mfma_f32_32x32x16_bf16 v[32:47], a[148:151], v[96:99], v[32:47]
    s_waitcnt vmcnt(11)
    v_mfma_f32_32x32x16_bf16 v[48:63], a[144:147], v[100:103], v[48:63]
    buffer_load_dwordx4 v[148:151], v2, s[20:23], s47 offen offset:0 sc1
    v_mfma_f32_32x32x16_bf16 v[64:79], a[148:151], v[100:103], v[64:79]
    s_waitcnt vmcnt(11)
    v_mfma_f32_32x32x16_bf16 v[16:31], a[152:155], v[104:107], v[16:31]
    buffer_load_dwordx4 v[152:155], v2, s[20:23], s46 offen offset:1024 sc1
    v_mfma_f32_32x32x16_bf16 v[32:47], a[156:159], v[104:107], v[32:47]
    s_waitcnt vmcnt(11)
    v_mfma_f32_32x32x16_bf16 v[48:63], a[152:155], v[108:111], v[48:63]
    buffer_load_dwordx4 v[156:159], v2, s[20:23], s47 offen offset:1024 sc1
    v_mfma_f32_32x32x16_bf16 v[64:79], a[156:159], v[108:111], v[64:79]
    s_waitcnt vmcnt(11)
    v_mfma_f32_32x32x16_bf16 v[16:31], a[160:163], v[112:115], v[16:31]
    buffer_load_dwordx4 v[160:163], v2, s[20:23], s46 offen offset:2048 sc1
    v_mfma_f32_32x32x16_bf16 v[32:47], a[164:167], v[112:115], v[32:47]
    s_waitcnt vmcnt(11)
    v_mfma_f32_32x32x16_bf16 v[48:63], a[160:163], v[116:119], v[48:63]
    buffer_load_dwordx4 v[164:167], v2, s[20:23], s47 offen offset:2048 sc1
    v_mfma_f32_32x32x16_bf16 v[64:79], a[164:167], v[116:119], v[64:79]
    s_waitcnt vmcnt(11)
    v_mfma_f32_32x32x16_bf16 v[16:31], a[168:171], v[120:123], v[16:31]
    buffer_load_dwordx4 v[168:171], v2, s[20:23], s46 offen offset:3072 sc1
    s_add_u32 s46, s46, 4096
    v_mfma_f32_32x32x16_bf16 v[32:47], a[172:175], v[120:123], v[32:47]
    s_waitcnt vmcnt(11)
    v_mfma_f32_32x32x16_bf16 v[48:63], a[168:171], v[124:127], v[48:63]
    buffer_load_dwordx4 v[172:175], v2, s[20:23], s47 offen offset:3072 sc1
    s_add_u32 s47, s47, 4096
    v_mfma_f32_32x32x16_bf16 v[64:79], a[172:175], v[124:127], v[64:79]
    s_waitcnt vmcnt(11)
    v_mfma_f32_32x32x16_bf16 v[16:31], a[176:179], v[128:131], v[16:31]
    buffer_load_dwordx4 v[208:211], v2, s[20:23], s52 offen offset:0 sc1
    v_mfma_f32_32x32x16_bf16 v[32:47], a[180:183], v[128:131], v[32:47]
    s_waitcnt vmcnt(11)
    v_mfma_f32_32x32x16_bf16 v[48:63], a[176:179], v[132:135], v[48:63]
    buffer_load_dwordx4 v[212:215], v2, s[20:23], s52 offen offset:1024 sc1
    v_mfma_f32_32x32x16_bf16 v[64:79], a[180:183], v[132:135], v[64:79]
    s_waitcnt vmcnt(11)
    v_mfma_f32_32x32x16_bf16 v[16:31], a[184:187], v[136:139], v[16:31]
    buffer_load_dwordx4 v4, s[24:27], s40 offen lds
    s_add_u32 m0, m0, 1024
    s_add_u32 s40, s40, s37
    v_mfma_f32_32x32x16_bf16 v[32:47], a[188:191], v[136:139], v[32:47]
    s_waitcnt vmcnt(11)
    v_mfma_f32_32x32x16_bf16 v[48:63], a[184:187], v[140:143], v[48:63]
    buffer_load_dwordx4 v4, s[24:27], s40 offen lds
    s_add_u32 m0, m0, 1024
    s_add_u32 s40, s40, s37
    v_mfma_f32_32x32x16_bf16 v[64:79], a[188:191], v[140:143], v[64:79]
    s_waitcnt vmcnt(11)
    v_mfma_f32_32x32x16_bf16 v[16:31], a[192:195], v[144:147], v[16:31]
    buffer_load_dwordx4 v4, s[24:27], s40 offen lds
    s_add_u32 m0, m0, 1024
    s_add_u32 s40, s40, s37
    v_mfma_f32_32x32x16_bf16 v[32:47], a[196:199], v[144:147], v[32:47]
    s_waitcnt vmcnt(11)
    v_mfma_f32_32x32x16_bf16 v[48:63], a[192:195], v[148:151], v[48:63]
    buffer_load_dwordx4 v4, s[24:27], s40 offen lds
    s_add_u32 m0, m0, 1024
    s_add_u32 s40, s40, s37
    v_mfma_f32_32x32x16_bf16 v[64:79], a[196:199], v[148:151], v[64:79]
    s_waitcnt vmcnt(11)
    v_mfma_f32_32x32x16_bf16 v[16:31], a[200:203], v[152:155], v[16:31]
    buffer_load_dwordx4 v4, s[24:27], s40 offen lds
    s_add_u32 m0, m0, 1024
    s_add_u32 s40, s40, s37
    v_mfma_f32_32x32x16_bf16 v[32:47], a[204:207], v[152:155], v[32:47]
    s_waitcnt vmcnt(11)
    v_mfma_f32_32x32x16_bf16 v[48:63], a[200:203], v[156:159], v[48:63]
    buffer_load_dwordx4 v4, s[24:27], s40 offen lds
    s_add_u32 m0, m0, 1024
    s_add_u32 s40, s40, s37
    v_mfma_f32_32x32x16_bf16 v[64:79], a[204:207], v[156:159], v[64:79]
    s_waitcnt vmcnt(11)
    v_mfma_f32_32x32x16_bf16 v[16:31], a[208:211], v[160:163], v[16:31]
    buffer_load_dwordx4 v4, s[24:27], s40 offen lds
    s_add_u32 m0, m0, 1024
    s_add_u32 s40, s40, s37
    v_mfma_f32_32x32x16_bf16 v[32:47], a[212:215], v[160:163], v[32:47]
    s_waitcnt vmcnt(11)
    v_mfma_f32_32x32x16_bf16 v[48:63], a[208:211], v[164:167], v[48:63]
    v_mfma_f32_32x32x16_bf16 v[64:79], a[212:215], v[164:167], v[64:79]
    s_waitcnt vmcnt(10)
    v_mfma_f32_32x32x16_bf16 v[16:31], a[216:219], v[168:171], v[16:31]
    v_mfma_f32_32x32x16_bf16 v[32:47], a[220:223], v[168:171], v[32:47]
    s_waitcnt vmcnt(9)
    v_mfma_f32_32x32x16_bf16 v[48:63], a[216:219], v[172:175], v[48:63]
    v_mfma_f32_32x32x16_bf16 v[64:79], a[220:223], v[172:175], v[64:79]
    s_xor_b32 s37, s16, 1
    s_mul_i32 s37, s37, 12288
    s_add_u32 s37, s37, 0
    v_add_u32 v10, s37, v2
    s_xor_b32 s37, s16, 2
    s_mul_i32 s37, s37, 12288
    s_add_u32 s37, s37, 4096
    v_add_u32 v11, s37, v2
    s_xor_b32 s37, s16, 3
    s_mul_i32 s37, s37, 12288
    s_add_u32 s37, s37, 8192
    v_add_u32 v12, s37, v2
    ds_write_b128 v10, v[32:35] offset:0
    s_mul_i32 s34, s16, 100352
    s_add_u32 s34, s34, 0x300000
    ds_write_b128 v10, v[36:39] offset:1024
    ds_write_b128 v10, v[40:43] offset:2048
    ds_write_b128 v10, v[44:47] offset:3072
    ds_write_b128 v11, v[48:51] offset:0
    ds_write_b128 v11, v[52:55] offset:1024
    ds_write_b128 v11, v[56:59] offset:2048
    ds_write_b128 v11, v[60:63] offset:3072
    ds_write_b128 v12, v[64:67] offset:0
    ds_write_b128 v12, v[68:71] offset:1024
    ds_write_b128 v12, v[72:75] offset:2048
    ds_write_b128 v12, v[76:79] offset:3072
    s_mul_i32 s37, s16, 12288
    v_add_u32 v10, s37, v2
    s_waitcnt vmcnt(7)
    v_lshlrev_b32 v128, 16, v208
    v_and_b32 v129, 0xffff0000, v208
    v_lshlrev_b32 v130, 16, v209
    v_and_b32 v131, 0xffff0000, v209
    v_lshlrev_b32 v132, 16, v210
    v_and_b32 v133, 0xffff0000, v210
    v_lshlrev_b32 v134, 16, v211
    v_and_b32 v135, 0xffff0000, v211
    v_lshlrev_b32 v136, 16, v212
    v_and_b32 v137, 0xffff0000, v212
    v_lshlrev_b32 v138, 16, v213
    v_and_b32 v139, 0xffff0000, v213
    v_lshlrev_b32 v140, 16, v214
    v_and_b32 v141, 0xffff0000, v214
    v_lshlrev_b32 v142, 16, v215
    v_and_b32 v143, 0xffff0000, v215
    v_mov_b32 v8, 0x40088e99
    v_mov_b32 v9, 0x40088e99
    v_pk_fma_f32 v[16:17], v[16:17], v[8:9], v[128:129]
    v_pk_fma_f32 v[18:19], v[18:19], v[8:9], v[130:131]
    v_pk_fma_f32 v[20:21], v[20:21], v[8:9], v[132:133]
    v_pk_fma_f32 v[22:23], v[22:23], v[8:9], v[134:135]
    v_pk_fma_f32 v[24:25], v[24:25], v[8:9], v[136:137]
    v_pk_fma_f32 v[26:27], v[26:27], v[8:9], v[138:139]
    v_pk_fma_f32 v[28:29], v[28:29], v[8:9], v[140:141]
    v_pk_fma_f32 v[30:31], v[30:31], v[8:9], v[142:143]
    s_waitcnt lgkmcnt(0)
    s_barrier
    ds_read_b128 v[80:83], v10 offset:0
    ds_read_b128 v[84:87], v10 offset:1024
    ds_read_b128 v[88:91], v10 offset:2048
    ds_read_b128 v[92:95], v10 offset:3072
    ds_read_b128 v[96:99], v10 offset:4096
    ds_read_b128 v[100:103], v10 offset:5120
    ds_read_b128 v[104:107], v10 offset:6144
    ds_read_b128 v[108:111], v10 offset:7168
    ds_read_b128 v[112:115], v10 offset:8192
    ds_read_b128 v[116:119], v10 offset:9216
    ds_read_b128 v[120:123], v10 offset:10240
    ds_read_b128 v[124:127], v10 offset:11264
    s_add_u32 s52, s51, 0x1400000
    s_lshl_b32 s38, s45, 14
    s_lshl_b32 s39, s44, 8
    s_add_u32 s38, s38, s39
    s_add_u32 s38, s38, 0x380000
    v_lshlrev_b32 v11, 3, v1
    s_waitcnt lgkmcnt(8)
    v_pk_fma_f32 v[16:17], v[80:81], v[8:9], v[16:17]
    v_pk_fma_f32 v[18:19], v[82:83], v[8:9], v[18:19]
    v_pk_fma_f32 v[20:21], v[84:85], v[8:9], v[20:21]
    v_pk_fma_f32 v[22:23], v[86:87], v[8:9], v[22:23]
    v_pk_fma_f32 v[24:25], v[88:89], v[8:9], v[24:25]
    v_pk_fma_f32 v[26:27], v[90:91], v[8:9], v[26:27]
    v_pk_fma_f32 v[28:29], v[92:93], v[8:9], v[28:29]
    v_pk_fma_f32 v[30:31], v[94:95], v[8:9], v[30:31]
    s_waitcnt lgkmcnt(4)
    v_pk_fma_f32 v[16:17], v[96:97], v[8:9], v[16:17]
    v_pk_fma_f32 v[18:19], v[98:99], v[8:9], v[18:19]
    v_pk_fma_f32 v[20:21], v[100:101], v[8:9], v[20:21]
    v_pk_fma_f32 v[22:23], v[102:103], v[8:9], v[22:23]
    v_pk_fma_f32 v[24:25], v[104:105], v[8:9], v[24:25]
    v_pk_fma_f32 v[26:27], v[106:107], v[8:9], v[26:27]
    v_pk_fma_f32 v[28:29], v[108:109], v[8:9], v[28:29]
    v_pk_fma_f32 v[30:31], v[110:111], v[8:9], v[30:31]
    s_waitcnt lgkmcnt(0)
    v_pk_fma_f32 v[16:17], v[112:113], v[8:9], v[16:17]
    v_pk_fma_f32 v[18:19], v[114:115], v[8:9], v[18:19]
    v_pk_fma_f32 v[20:21], v[116:117], v[8:9], v[20:21]
    v_pk_fma_f32 v[22:23], v[118:119], v[8:9], v[22:23]
    v_pk_fma_f32 v[24:25], v[120:121], v[8:9], v[24:25]
    v_pk_fma_f32 v[26:27], v[122:123], v[8:9], v[26:27]
    v_pk_fma_f32 v[28:29], v[124:125], v[8:9], v[28:29]
    v_pk_fma_f32 v[30:31], v[126:127], v[8:9], v[30:31]
    v_cvt_pk_bf16_f32 v208, v16, v17
    v_cvt_pk_bf16_f32 v209, v18, v19
    v_cvt_pk_bf16_f32 v210, v20, v21
    v_cvt_pk_bf16_f32 v211, v22, v23
    v_cvt_pk_bf16_f32 v212, v24, v25
    v_cvt_pk_bf16_f32 v213, v26, v27
    v_cvt_pk_bf16_f32 v214, v28, v29
    v_cvt_pk_bf16_f32 v215, v30, v31
    buffer_store_dwordx4 v[208:211], v2, s[20:23], s52 offen sc1
    buffer_store_dwordx4 v[212:215], v2, s[20:23], s52 offen offset:1024 sc1
    v_pk_add_f32 v[12:13], v[16:17], v[18:19]
    v_pk_mul_f32 v[14:15], v[16:17], v[16:17]
    v_pk_fma_f32 v[14:15], v[18:19], v[18:19], v[14:15]
    v_pk_add_f32 v[12:13], v[12:13], v[20:21]
    v_pk_fma_f32 v[14:15], v[20:21], v[20:21], v[14:15]
    v_pk_add_f32 v[12:13], v[12:13], v[22:23]
    v_pk_fma_f32 v[14:15], v[22:23], v[22:23], v[14:15]
    v_pk_add_f32 v[12:13], v[12:13], v[24:25]
    v_pk_fma_f32 v[14:15], v[24:25], v[24:25], v[14:15]
    v_pk_add_f32 v[12:13], v[12:13], v[26:27]
    v_pk_fma_f32 v[14:15], v[26:27], v[26:27], v[14:15]
    v_pk_add_f32 v[12:13], v[12:13], v[28:29]
    v_pk_fma_f32 v[14:15], v[28:29], v[28:29], v[14:15]
    v_pk_add_f32 v[12:13], v[12:13], v[30:31]
    v_pk_fma_f32 v[14:15], v[30:31], v[30:31], v[14:15]
    v_add_f32 v12, v12, v13
    v_add_f32 v13, v14, v15
    v_mov_b32 v14, v12
    v_mov_b32 v15, v13
    s_nop 1
    v_permlane32_swap_b32 v12, v14
    v_permlane32_swap_b32 v13, v15
    v_pk_add_f32 v[12:13], v[12:13], v[14:15]
    s_mov_b32 exec_hi, 0
    buffer_store_dwordx2 v[12:13], v11, s[20:23], s38 offen sc1
    s_mov_b32 exec_hi, -1
    s_lshl_b32 s30, s17, 2
    s_add_u32 s30, s30, s16
    s_mul_i32 s31, s30, 28672
    s_add_u32 s32, s31, 0x1400000
    s_lshl_b32 s33, s30, 8
    s_add_u32 s33, s33, 0x380000
    v_bfe_u32 v8, v1, 2, 2
    v_lshl_add_u32 v11, v3, 2, v8
    v_lshlrev_b32 v11, 6, v11
    v_bfe_u32 v8, v1, 4, 1
    v_lshl_add_u32 v11, v8, 5, v11
    v_and_b32 v8, 3, v1
    v_lshl_add_u32 v11, v8, 3, v11
    v_add_u32 v11, 49152, v11
    v_and_b32 v12, 31, v1
    v_lshlrev_b32 v12, 3, v12
    v_mov_b32 v13, 114688
    v_mad_u32_u24 v12, v3, v13, v12
    v_mov_b32 v208, 0x3f803f80
    v_mov_b32 v209, 0x3f803f80
    v_mov_b32 v210, 0x3f803f80
    v_mov_b32 v211, 0x3f803f80
    v_mov_b32 v6, s62
    v_mov_b32 v7, s63
    s_lshl_b32 s40, s17, 8
    s_add_u32 s40, s40, 0x3c2000
    s_lshl_b32 s41, s18, 3
    s_add_u32 s41, s41, s40
    v_min_u32 v4, 13, v1
    v_lshlrev_b32 v4, 3, v4
    buffer_load_dwordx4 a[0:3], v2, s[20:23], s34 offen offset:0 sc1
    buffer_load_dwordx4 a[4:7], v2, s[20:23], s34 offen offset:1024 sc1
    buffer_load_dwordx4 a[8:11], v2, s[20:23], s34 offen offset:2048 sc1
    buffer_load_dwordx4 a[12:15], v2, s[20:23], s34 offen offset:3072 sc1
    s_add_u32 s34, s34, 4096
    s_cmp_lg_u32 s16, 0
    s_waitcnt vmcnt(4)
    s_barrier
    s_cbranch_scc1 K_sig21
    s_mov_b64 exec, 1
    buffer_store_dwordx2 v[6:7], off, s[20:23], s41
    buffer_store_dwordx2 v[6:7], off, s[20:23], s41 offset:128 sc1
    s_mov_b64 exec, -1
K_sig21:
    s_cmp_lg_u32 s16, 0
    s_cbranch_scc1 K_wdone22
    buffer_load_dwordx2 v[6:7], v4, s[20:23], s40 offen sc1
    s_mov_b64 s[42:43], 0
    s_mov_b32 s3, 0
K_wloop23:
    s_waitcnt vmcnt(0)
    v_cmp_eq_u64 vcc, s[62:63], v[6:7]
    s_or_b64 s[42:43], s[42:43], vcc
    s_cmp_eq_u64 s[42:43], -1
    s_cbranch_scc1 K_wgot25
    s_add_u32 s3, s3, 1
    s_bitcmp1_b32 s3, 3
    s_cbranch_scc0 K_wskip24
    s_add_u32 s3, s3, 7
    buffer_load_dwordx2 v[6:7], v4, s[20:23], s40 offen offset:128 sc1
    s_cmp_gt_u32 s3, 0x40000
    s_cbranch_scc0 K_wloop23
    s_branch K_wgot25
K_wskip24:
    buffer_load_dwordx2 v[6:7], v4, s[20:23], s40 offen sc1
    s_branch K_wloop23
K_wgot25:
    s_waitcnt vmcnt(0)
K_wdone22:
    s_barrier
    s_branch K_join26
K_idle9:
    s_and_b32 s37, s17, 1
    s_lshl_b32 s37, s37, 1
    s_add_u32 s37, s37, s18
    s_sub_u32 s37, s37, 14
    s_lshl_b32 s37, s37, 2
    s_add_u32 s37, s37, s16
    s_getpc_b64 s[38:39]
K_cpc27:
    s_sub_u32 s38, s38, K_cpc27-K_mlp11
    s_subb_u32 s39, s39, 0
    s_lshl_b32 s40, s37, 10
    v_lshlrev_b32 v4, 4, v1
    v_add_u32 v4, s40, v4
    v_min_u32 v4, K_idle9-K_mlp11, v4
    v_mov_b32 v5, s39
    v_add_co_u32 v4, vcc, s38, v4
    s_nop 1
    v_addc_co_u32 v5, vcc, 0, v5, vcc
    global_load_dword v60, v[4:5], off
    s_and_b32 s37, s17, 1
    s_lshl_b32 s37, s37, 1
    s_add_u32 s37, s37, s18
    s_sub_u32 s37, s37, 14
    s_lshl_b32 s37, s37, 2
    s_add_u32 s37, s37, s16
    s_min_u32 s38, s37, 13
    s_mul_i32 s38, s38, 115712
    s_add_u32 s38, s38, 0x600000
    v_lshlrev_b32 v4, 7, v1
    s_add_u32 s39, s38, 6144
    buffer_load_dword v16, v4, s[20:23], s39 offen sc1
    s_add_u32 s39, s38, 34816
    buffer_load_dword v17, v4, s[20:23], s39 offen sc1
    s_add_u32 s39, s38, 63488
    buffer_load_dword v18, v4, s[20:23], s39 offen sc1
    s_add_u32 s39, s38, 92160
    buffer_load_dword v19, v4, s[20:23], s39 offen sc1
    s_add_u32 s39, s38, 14336
    buffer_load_dword v20, v4, s[20:23], s39 offen sc1
    s_add_u32 s39, s38, 43008
    buffer_load_dword v21, v4, s[20:23], s39 offen sc1
    s_add_u32 s39, s38, 71680
    buffer_load_dword v22, v4, s[20:23], s39 offen sc1
    s_add_u32 s39, s38, 100352
    buffer_load_dword v23, v4, s[20:23], s39 offen sc1
    s_add_u32 s39, s38, 21504
    buffer_load_dword v24, v4, s[20:23], s39 offen sc1
    s_add_u32 s39, s38, 50176
    buffer_load_dword v25, v4, s[20:23], s39 offen sc1
    s_add_u32 s39, s38, 78848
    buffer_load_dword v26, v4, s[20:23], s39 offen sc1
    s_add_u32 s39, s38, 107520
    buffer_load_dword v27, v4, s[20:23], s39 offen sc1
    s_cmp_eq_u32 s18, 15
    s_cselect_b32 s24, s10, s8
    s_cselect_b32 s25, s11, s9
    s_cmp_lt_u32 s18, 14
    s_cselect_b32 s24, s6, s24
    s_cselect_b32 s25, s7, s25
    s_movk_i32 s26, 25088
    s_cselect_b32 s26, 401408, s26
    s_mov_b32 s27, 0x20000
    s_cselect_b32 s37, 896, 56
    s_cselect_b32 s38, s18, 0
    s_lshl_b32 s38, s38, 6
    v_lshrrev_b32 v4, 2, v1
    v_and_b32 v5, 3, v1
    v_lshlrev_b32 v5, 4, v5
    v_mul_lo_u32 v4, v4, s37
    v_add3_u32 v4, v4, v5, s38
    s_mul_i32 s39, s16, 7
    s_lshl_b32 s37, s37, 4
    s_mul_i32 s40, s39, s37
    s_lshl_b32 s41, s39, 10
    s_add_u32 m0, s41, 49152
    s_nop 0
    buffer_load_dwordx4 v4, s[24:27], s40 offen lds
    s_add_u32 m0, m0, 1024
    s_add_u32 s40, s40, s37
    buffer_load_dwordx4 v4, s[24:27], s40 offen lds
    s_add_u32 m0, m0, 1024
    s_add_u32 s40, s40, s37
    buffer_load_dwordx4 v4, s[24:27], s40 offen lds
    s_add_u32 m0, m0, 1024
    s_add_u32 s40, s40, s37
    buffer_load_dwordx4 v4, s[24:27], s40 offen lds
    s_add_u32 m0, m0, 1024
    s_add_u32 s40, s40, s37
    buffer_load_dwordx4 v4, s[24:27], s40 offen lds
    s_add_u32 m0, m0, 1024
    s_add_u32 s40, s40, s37
    buffer_load_dwordx4 v4, s[24:27], s40 offen lds
    s_add_u32 m0, m0, 1024
    s_add_u32 s40, s40, s37
    buffer_load_dwordx4 v4, s[24:27], s40 offen lds
    s_add_u32 m0, m0, 1024
    s_add_u32 s40, s40, s37
    s_cmp_lg_u32 s16, 0
    s_cbranch_scc1 K_wdone28
    s_lshl_b32 s40, s17, 8
    s_add_u32 s40, s40, 0x3c1000
    v_min_u32 v4, 13, v1
    v_lshlrev_b32 v4, 3, v4
    buffer_load_dwordx2 v[6:7], v4, s[20:23], s40 offen sc1
    s_mov_b64 s[42:43], 0
    s_mov_b32 s3, 0
K_wloop29:
    s_waitcnt vmcnt(0)
    v_cmp_eq_u64 vcc, s[62:63], v[6:7]
    s_or_b64 s[42:43], s[42:43], vcc
    s_cmp_eq_u64 s[42:43], -1
    s_cbranch_scc1 K_wgot31
    s_add_u32 s3, s3, 1
    s_bitcmp1_b32 s3, 3
    s_cbranch_scc0 K_wskip30
    s_add_u32 s3, s3, 7
    buffer_load_dwordx2 v[6:7], v4, s[20:23], s40 offen offset:128 sc1
    s_cmp_gt_u32 s3, 0x40000
    s_cbranch_scc0 K_wloop29
    s_branch K_wgot31
K_wskip30:
    buffer_load_dwordx2 v[6:7], v4, s[20:23], s40 offen sc1
    s_branch K_wloop29
K_wgot31:
    s_waitcnt vmcnt(0)
K_wdone28:
    s_barrier
    s_and_b32 s37, s17, 1
    s_lshl_b32 s37, s37, 1
    s_add_u32 s37, s37, s18
    s_sub_u32 s37, s37, 14
    s_lshl_b32 s37, s37, 2
    s_add_u32 s37, s37, s16
    s_getpc_b64 s[38:39]
K_pc:
    s_lshl_b32 s40, s37, 11
    v_lshlrev_b32 v4, 5, v1
    v_add_u32 v4, s40, v4
    v_min_u32 v4, K_end-K_pc, v4
    v_mov_b32 v5, s39
    v_add_co_u32 v4, vcc, s38, v4
    s_nop 1
    v_addc_co_u32 v5, vcc, 0, v5, vcc
    global_load_dword v6, v[4:5], off
    v_lshlrev_b32 v4, 7, v1
    s_mul_i32 s40, s37, 24576
    s_add_u32 s40, s40, 0x300000
    buffer_load_dword v7, v4, s[20:23], s40 offen sc1
    s_add_u32 s40, s40, 8192
    buffer_load_dword v8, v4, s[20:23], s40 offen sc1
    s_add_u32 s40, s40, 8192
    buffer_load_dword v9, v4, s[20:23], s40 offen sc1
    s_add_u32 s40, s40, 8192
    s_mul_i32 s34, s16, 100352
    s_add_u32 s34, s34, 0x300000
    buffer_load_dwordx4 a[0:3], v2, s[20:23], s34 offen offset:0 sc1
    buffer_load_dwordx4 a[4:7], v2, s[20:23], s34 offen offset:1024 sc1
    buffer_load_dwordx4 a[8:11], v2, s[20:23], s34 offen offset:2048 sc1
    buffer_load_dwordx4 a[12:15], v2, s[20:23], s34 offen offset:3072 sc1
    s_add_u32 s34, s34, 4096
    s_waitcnt vmcnt(0)
    s_lshl_b32 s30, s17, 2
    s_add_u32 s30, s30, s16
    s_mul_i32 s31, s30, 28672
    s_add_u32 s32, s31, 0x1400000
    s_lshl_b32 s33, s30, 8
    s_add_u32 s33, s33, 0x380000
    v_bfe_u32 v8, v1, 2, 2
    v_lshl_add_u32 v11, v3, 2, v8
    v_lshlrev_b32 v11, 6, v11
    v_bfe_u32 v8, v1, 4, 1
    v_lshl_add_u32 v11, v8, 5, v11
    v_and_b32 v8, 3, v1
    v_lshl_add_u32 v11, v8, 3, v11
    v_add_u32 v11, 49152, v11
    v_and_b32 v12, 31, v1
    v_lshlrev_b32 v12, 3, v12
    v_mov_b32 v13, 114688
    v_mad_u32_u24 v12, v3, v13, v12
    v_mov_b32 v208, 0x3f803f80
    v_mov_b32 v209, 0x3f803f80
    v_mov_b32 v210, 0x3f803f80
    v_mov_b32 v211, 0x3f803f80
    s_cmp_lg_u32 s16, 0
    s_cbranch_scc1 K_wdone32
    s_lshl_b32 s40, s17, 8
    s_add_u32 s40, s40, 0x3c2000
    v_min_u32 v4, 13, v1
    v_lshlrev_b32 v4, 3, v4
    buffer_load_dwordx2 v[6:7], v4, s[20:23], s40 offen sc1
    s_mov_b64 s[42:43], 0
    s_mov_b32 s3, 0
K_wloop33:
    s_waitcnt vmcnt(0)
    v_cmp_eq_u64 vcc, s[62:63], v[6:7]
    s_or_b64 s[42:43], s[42:43], vcc
    s_cmp_eq_u64 s[42:43], -1
    s_cbranch_scc1 K_wgot35
    s_add_u32 s3, s3, 1
    s_bitcmp1_b32 s3, 3
    s_cbranch_scc0 K_wskip34
    s_add_u32 s3, s3, 7
    buffer_load_dwordx2 v[6:7], v4, s[20:23], s40 offen offset:128 sc1
    s_cmp_gt_u32 s3, 0x40000
    s_cbranch_scc0 K_wloop33
    s_branch K_wgot35
K_wskip34:
    buffer_load_dwordx2 v[6:7], v4, s[20:23], s40 offen sc1
    s_branch K_wloop33
K_wgot35:
    s_waitcnt vmcnt(0)
K_wdone32:
    s_barrier
K_join26:
    buffer_load_dwordx4 v[16:19], v2, s[20:23], s32 offen offset:0 sc1
    buffer_load_dwordx4 v[20:23], v2, s[20:23], s32 offen offset:1024 sc1
    buffer_load_dwordx4 v[24:27], v2, s[20:23], s32 offen offset:2048 sc1
    buffer_load_dwordx4 v[28:31], v2, s[20:23], s32 offen offset:3072 sc1
    s_add_u32 s32, s32, 4096
    buffer_load_dwordx4 v[32:35], v2, s[20:23], s32 offen offset:0 sc1
    buffer_load_dwordx4 v[36:39], v2, s[20:23], s32 offen offset:1024 sc1
    buffer_load_dwordx4 v[40:43], v2, s[20:23], s32 offen offset:2048 sc1
    buffer_load_dwordx4 v[44:47], v2, s[20:23], s32 offen offset:3072 sc1
    s_add_u32 s32, s32, 4096
    buffer_load_dwordx4 v[48:51], v2, s[20:23], s32 offen offset:0 sc1
    buffer_load_dwordx4 v[52:55], v2, s[20:23], s32 offen offset:1024 sc1
    buffer_load_dwordx4 v[56:59], v2, s[20:23], s32 offen offset:2048 sc1
    buffer_load_dwordx4 v[60:63], v2, s[20:23], s32 offen offset:3072 sc1
    s_add_u32 s32, s32, 4096
    ds_read_b64_tr_b16 v[160:161], v11 offset:0
    ds_read_b64_tr_b16 v[162:163], v11 offset:512
    ds_read_b64_tr_b16 v[164:165], v11 offset:1024
    ds_read_b64_tr_b16 v[166:167], v11 offset:1536
    ds_read_b64_tr_b16 v[168:169], v11 offset:2048
    ds_read_b64_tr_b16 v[170:171], v11 offset:2560
    ds_read_b64_tr_b16 v[172:173], v11 offset:3072
    ds_read_b64_tr_b16 v[174:175], v11 offset:3584
    s_cmp_eq_u32 s18, 15
    s_cbranch_scc1 K_qkv36_v
    s_waitcnt vmcnt(11) lgkmcnt(6)
    v_mfma_f32_32x32x16_bf16 v[128:143], v[160:163], v[16:19], 0
    buffer_load_dwordx4 v[64:67], v2, s[20:23], s32 offen offset:0 sc1
    v_mfma_f32_32x32x16_bf16 v[144:159], v[160:163], v[208:211], 0
    ds_read_b64_tr_b16 v[176:177], v11 offset:4096
    ds_read_b64_tr_b16 v[178:179], v11 offset:4608
    s_waitcnt vmcnt(11) lgkmcnt(6)
    v_mfma_f32_32x32x16_bf16 v[128:143], v[164:167], v[20:23], v[128:143]
    buffer_load_dwordx4 v[68:71], v2, s[20:23], s32 offen offset:1024 sc1
    v_mfma_f32_32x32x16_bf16 v[144:159], v[164:167], v[208:211], v[144:159]
    ds_read_b64_tr_b16 v[180:181], v11 offset:5120
    ds_read_b64_tr_b16 v[182:183], v11 offset:5632
    s_waitcnt vmcnt(11) lgkmcnt(6)
    v_mfma_f32_32x32x16_bf16 v[128:143], v[168:171], v[24:27], v[128:143]
    buffer_load_dwordx4 v[72:75], v2, s[20:23], s32 offen offset:2048 sc1
    v_mfma_f32_32x32x16_bf16 v[144:159], v[168:171], v[208:211], v[144:159]
    ds_read_b64_tr_b16 v[184:185], v11 offset:6144
    ds_read_b64_tr_b16 v[186:187], v11 offset:6656
    s_waitcnt vmcnt(11) lgkmcnt(6)
    v_mfma_f32_32x32x16_bf16 v[128:143], v[172:175], v[28:31], v[128:143]
    buffer_load_dwordx4 v[76:79], v2, s[20:23], s32 offen offset:3072 sc1
    s_add_u32 s32, s32, 4096
    v_mfma_f32_32x32x16_bf16 v[144:159], v[172:175], v[208:211], v[144:159]
    ds_read_b64_tr_b16 v[188:189], v11 offset:7168
    ds_read_b64_tr_b16 v[190:191], v11 offset:7680
    s_waitcnt vmcnt(11) lgkmcnt(6)
    v_mfma_f32_32x32x16_bf16 v[128:143], v[176:179], v[32:35], v[128:143]
    buffer_load_dwordx4 v[80:83], v2, s[20:23], s32 offen offset:0 sc1
    v_mfma_f32_32x32x16_bf16 v[144:159], v[176:179], v[208:211], v[144:159]
    ds_read_b64_tr_b16 v[160:161], v11 offset:8192
    ds_read_b64_tr_b16 v[162:163], v11 offset:8704
    s_waitcnt vmcnt(11) lgkmcnt(6)
    v_mfma_f32_32x32x16_bf16 v[128:143], v[180:183], v[36:39], v[128:143]
    buffer_load_dwordx4 v[84:87], v2, s[20:23], s32 offen offset:1024 sc1
    v_mfma_f32_32x32x16_bf16 v[144:159], v[180:183], v[208:211], v[144:159]
    ds_read_b64_tr_b16 v[164:165], v11 offset:9216
    ds_read_b64_tr_b16 v[166:167], v11 offset:9728
    s_waitcnt vmcnt(11) lgkmcnt(6)
    v_mfma_f32_32x32x16_bf16 v[128:143], v[184:187], v[40:43], v[128:143]
    buffer_load_dwordx4 v[88:91], v2, s[20:23], s32 offen offset:2048 sc1
    v_mfma_f32_32x32x16_bf16 v[144:159], v[184:187], v[208:211], v[144:159]
    ds_read_b64_tr_b16 v[168:169], v11 offset:10240
    ds_read_b64_tr_b16 v[170:171], v11 offset:10752
    s_waitcnt vmcnt(11) lgkmcnt(6)
    v_mfma_f32_32x32x16_bf16 v[128:143], v[188:191], v[44:47], v[128:143]
    buffer_load_dwordx4 v[92:95], v2, s[20:23], s32 offen offset:3072 sc1
    s_add_u32 s32, s32, 4096
    v_mfma_f32_32x32x16_bf16 v[144:159], v[188:191], v[208:211], v[144:159]
    ds_read_b64_tr_b16 v[172:173], v11 offset:11264
    ds_read_b64_tr_b16 v[174:175], v11 offset:11776
    s_waitcnt vmcnt(11) lgkmcnt(6)
    v_mfma_f32_32x32x16_bf16 v[128:143], v[160:163], v[48:51], v[128:143]
    buffer_load_dwordx4 v[96:99], v2, s[20:23], s32 offen offset:0 sc1
    v_mfma_f32_32x32x16_bf16 v[144:159], v[160:163], v[208:211], v[144:159]
    ds_read_b64_tr_b16 v[176:177], v11 offset:12288
    ds_read_b64_tr_b16 v[178:179], v11 offset:12800
    s_waitcnt vmcnt(11) lgkmcnt(6)
    v_mfma_f32_32x32x16_bf16 v[128:143], v[164:167], v[52:55], v[128:143]
    buffer_load_dwordx4 v[100:103], v2, s[20:23], s32 offen offset:1024 sc1
    v_mfma_f32_32x32x16_bf16 v[144:159], v[164:167], v[208:211], v[144:159]
    ds_read_b64_tr_b16 v[180:181], v11 offset:13312
    ds_read_b64_tr_b16 v[182:183], v11 offset:13824
    s_waitcnt vmcnt(11) lgkmcnt(6)
    v_mfma_f32_32x32x16_bf16 v[128:143], v[168:171], v[56:59], v[128:143]
    buffer_load_dwordx4 v[104:107], v2, s[20:23], s32 offen offset:2048 sc1
    v_mfma_f32_32x32x16_bf16 v[144:159], v[168:171], v[208:211], v[144:159]
    ds_read_b64_tr_b16 v[184:185], v11 offset:14336
    ds_read_b64_tr_b16 v[186:187], v11 offset:14848
    s_waitcnt vmcnt(11) lgkmcnt(6)
    v_mfma_f32_32x32x16_bf16 v[128:143], v[172:175], v[60:63], v[128:143]
    buffer_load_dwordx4 v[108:111], v2, s[20:23], s32 offen offset:3072 sc1
    s_add_u32 s32, s32, 4096
    v_mfma_f32_32x32x16_bf16 v[144:159], v[172:175], v[208:211], v[144:159]
    ds_read_b64_tr_b16 v[188:189], v11 offset:15360
    ds_read_b64_tr_b16 v[190:191], v11 offset:15872
    s_waitcnt vmcnt(11) lgkmcnt(6)
    v_mfma_f32_32x32x16_bf16 v[128:143], v[176:179], v[64:67], v[128:143]
    buffer_load_dwordx4 v[112:115], v2, s[20:23], s32 offen offset:0 sc1
    v_mfma_f32_32x32x16_bf16 v[144:159], v[176:179], v[208:211], v[144:159]
    ds_read_b64_tr_b16 v[160:161], v11 offset:16384
    ds_read_b64_tr_b16 v[162:163], v11 offset:16896
    s_waitcnt vmcnt(11) lgkmcnt(6)
    v_mfma_f32_32x32x16_bf16 v[128:143], v[180:183], v[68:71], v[128:143]
    buffer_load_dwordx4 v[116:119], v2, s[20:23], s32 offen offset:1024 sc1
    v_mfma_f32_32x32x16_bf16 v[144:159], v[180:183], v[208:211], v[144:159]
    ds_read_b64_tr_b16 v[164:165], v11 offset:17408
    ds_read_b64_tr_b16 v[166:167], v11 offset:17920
    s_waitcnt vmcnt(11) lgkmcnt(6)
    v_mfma_f32_32x32x16_bf16 v[128:143], v[184:187], v[72:75], v[128:143]
    buffer_load_dwordx4 v[120:123], v2, s[20:23], s32 offen offset:2048 sc1
    v_mfma_f32_32x32x16_bf16 v[144:159], v[184:187], v[208:211], v[144:159]
    ds_read_b64_tr_b16 v[168:169], v11 offset:18432
    ds_read_b64_tr_b16 v[170:171], v11 offset:18944
    s_waitcnt vmcnt(11) lgkmcnt(6)
    v_mfma_f32_32x32x16_bf16 v[128:143], v[188:191], v[76:79], v[128:143]
    buffer_load_dwordx4 v[124:127], v2, s[20:23], s32 offen offset:3072 sc1
    s_add_u32 s32, s32, 4096
    v_mfma_f32_32x32x16_bf16 v[144:159], v[188:191], v[208:211], v[144:159]
    ds_read_b64_tr_b16 v[172:173], v11 offset:19456
    ds_read_b64_tr_b16 v[174:175], v11 offset:19968
    s_waitcnt vmcnt(11) lgkmcnt(6)
    v_mfma_f32_32x32x16_bf16 v[128:143], v[160:163], v[80:83], v[128:143]
    buffer_load_dwordx2 v[192:193], v12, s[20:23], s33 offen sc1
    s_add_u32 s33, s33, 16384
    v_mfma_f32_32x32x16_bf16 v[144:159], v[160:163], v[208:211], v[144:159]
    ds_read_b64_tr_b16 v[176:177], v11 offset:20480
    ds_read_b64_tr_b16 v[178:179], v11 offset:20992
    s_waitcnt vmcnt(11) lgkmcnt(6)
    v_mfma_f32_32x32x16_bf16 v[128:143], v[164:167], v[84:87], v[128:143]
    buffer_load_dwordx2 v[194:195], v12, s[20:23], s33 offen sc1
    s_add_u32 s33, s33, 16384
    v_mfma_f32_32x32x16_bf16 v[144:159], v[164:167], v[208:211], v[144:159]
    ds_read_b64_tr_b16 v[180:181], v11 offset:21504
    ds_read_b64_tr_b16 v[182:183], v11 offset:22016
    s_waitcnt vmcnt(11) lgkmcnt(6)
    v_mfma_f32_32x32x16_bf16 v[128:143], v[168:171], v[88:91], v[128:143]
    buffer_load_dwordx2 v[196:197], v12, s[20:23], s33 offen sc1
    s_add_u32 s33, s33, 16384
    v_mfma_f32_32x32x16_bf16 v[144:159], v[168:171], v[208:211], v[144:159]
    ds_read_b64_tr_b16 v[184:185], v11 offset:22528
    ds_read_b64_tr_b16 v[186:187], v11 offset:23040
    s_waitcnt vmcnt(11) lgkmcnt(6)
    v_mfma_f32_32x32x16_bf16 v[128:143], v[172:175], v[92:95], v[128:143]
    buffer_load_dwordx2 v[198:199], v12, s[20:23], s33 offen sc1
    s_add_u32 s33, s33, 16384
    v_mfma_f32_32x32x16_bf16 v[144:159], v[172:175], v[208:211], v[144:159]
    ds_read_b64_tr_b16 v[188:189], v11 offset:23552
    ds_read_b64_tr_b16 v[190:191], v11 offset:24064
    s_waitcnt vmcnt(11) lgkmcnt(6)
    v_mfma_f32_32x32x16_bf16 v[128:143], v[176:179], v[96:99], v[128:143]
    buffer_load_dwordx2 v[200:201], v12, s[20:23], s33 offen sc1
    s_add_u32 s33, s33, 16384
    v_mfma_f32_32x32x16_bf16 v[144:159], v[176:179], v[208:211], v[144:159]
    ds_read_b64_tr_b16 v[160:161], v11 offset:24576
    ds_read_b64_tr_b16 v[162:163], v11 offset:25088
    s_waitcnt vmcnt(11) lgkmcnt(6)
    v_mfma_f32_32x32x16_bf16 v[128:143], v[180:183], v[100:103], v[128:143]
    buffer_load_dwordx2 v[202:203], v12, s[20:23], s33 offen sc1
    s_add_u32 s33, s33, 16384
    v_mfma_f32_32x32x16_bf16 v[144:159], v[180:183], v[208:211], v[144:159]
    ds_read_b64_tr_b16 v[164:165], v11 offset:25600
    ds_read_b64_tr_b16 v[166:167], v11 offset:26112
    s_waitcnt vmcnt(11) lgkmcnt(6)
    v_mfma_f32_32x32x16_bf16 v[128:143], v[184:187], v[104:107], v[128:143]
    buffer_load_dwordx2 v[204:205], v12, s[20:23], s33 offen sc1
    s_add_u32 s33, s33, 16384
    v_mfma_f32_32x32x16_bf16 v[144:159], v[184:187], v[208:211], v[144:159]
    ds_read_b64_tr_b16 v[168:169], v11 offset:26624
    ds_read_b64_tr_b16 v[170:171], v11 offset:27136
    s_waitcnt vmcnt(11) lgkmcnt(6)
    v_mfma_f32_32x32x16_bf16 v[128:143], v[188:191], v[108:111], v[128:143]
    v_mfma_f32_32x32x16_bf16 v[144:159], v[188:191], v[208:211], v[144:159]
    ds_read_b64_tr_b16 v[172:173], v11 offset:27648
    ds_read_b64_tr_b16 v[174:175], v11 offset:28160
    s_waitcnt vmcnt(10) lgkmcnt(6)
    v_mfma_f32_32x32x16_bf16 v[128:143], v[160:163], v[112:115], v[128:143]
    v_mfma_f32_32x32x16_bf16 v[144:159], v[160:163], v[208:211], v[144:159]
    s_waitcnt vmcnt(9) lgkmcnt(4)
    v_mfma_f32_32x32x16_bf16 v[128:143], v[164:167], v[116:119], v[128:143]
    v_mfma_f32_32x32x16_bf16 v[144:159], v[164:167], v[208:211], v[144:159]
    s_waitcnt vmcnt(8) lgkmcnt(2)
    v_mfma_f32_32x32x16_bf16 v[128:143], v[168:171], v[120:123], v[128:143]
    v_mfma_f32_32x32x16_bf16 v[144:159], v[168:171], v[208:211], v[144:159]
    s_waitcnt vmcnt(7) lgkmcnt(0)
    v_mfma_f32_32x32x16_bf16 v[128:143], v[172:175], v[124:127], v[128:143]
    v_mfma_f32_32x32x16_bf16 v[144:159], v[172:175], v[208:211], v[144:159]
    s_waitcnt vmcnt(0)
    v_add_f32 v192, v192, v194
    v_add_f32 v193, v193, v195
    v_add_f32 v192, v192, v196
    v_add_f32 v193, v193, v197
    v_add_f32 v192, v192, v198
    v_add_f32 v193, v193, v199
    v_add_f32 v192, v192, v200
    v_add_f32 v193, v193, v201
    v_add_f32 v192, v192, v202
    v_add_f32 v193, v193, v203
    v_add_f32 v192, v192, v204
    v_add_f32 v193, v193, v205
    v_mov_b32 v12, v192
    v_mov_b32 v13, v193
    s_nop 1
    v_permlane32_swap_b32 v12, v192
    v_permlane32_swap_b32 v13, v193
    v_add_f32 v12, v12, v192
    v_add_f32 v13, v13, v193
    v_mul_f32 v12, 0x3b124925, v12
    v_mul_f32 v13, 0x3b124925, v13
    v_fma_f32 v13, -v12, v12, v13
    v_max_f32 v13, 0, v13
    v_add_f32 v13, 0x3727c5ac, v13
    v_rsq_f32 v13, v13
    s_nop 0
    s_cmp_eq_u32 s18, 14
    s_cselect_b32 s37, 1.0, 0x3e8b97f6
    s_cselect_b64 s[40:41], s[28:29], 0
    v_mul_f32 v13, s37, v13
    s_lshl_b32 s38, s18, 11
    s_add_u32 s38, s38, s31
    s_add_u32 s38, s38, 0x1600000
    s_lshl_b32 s39, s30, 12
    s_add_u32 s39, s39, 0x1800000
    s_cmp_eq_u32 s18, 14
    s_cselect_b32 s38, s39, s38
    v_mul_f32_e64 v14, -v12, v13
    v_mov_b32 v12, v13
    v_mov_b32 v15, v14
    v_pk_mul_f32 v[128:129], v[128:129], v[12:13]
    v_pk_mul_f32 v[130:131], v[130:131], v[12:13]
    v_pk_mul_f32 v[132:133], v[132:133], v[12:13]
    v_pk_mul_f32 v[134:135], v[134:135], v[12:13]
    v_pk_mul_f32 v[136:137], v[136:137], v[12:13]
    v_pk_mul_f32 v[138:139], v[138:139], v[12:13]
    v_pk_mul_f32 v[140:141], v[140:141], v[12:13]
    v_pk_mul_f32 v[142:143], v[142:143], v[12:13]
    v_pk_fma_f32 v[128:129], v[144:145], v[14:15], v[128:129]
    v_pk_fma_f32 v[130:131], v[146:147], v[14:15], v[130:131]
    v_pk_fma_f32 v[132:133], v[148:149], v[14:15], v[132:133]
    v_pk_fma_f32 v[134:135], v[150:151], v[14:15], v[134:135]
    v_pk_fma_f32 v[136:137], v[152:153], v[14:15], v[136:137]
    v_pk_fma_f32 v[138:139], v[154:155], v[14:15], v[138:139]
    v_pk_fma_f32 v[140:141], v[156:157], v[14:15], v[140:141]
    v_pk_fma_f32 v[142:143], v[158:159], v[14:15], v[142:143]
    v_cvt_pk_bf16_f32 v144, v128, v129
    v_cvt_pk_bf16_f32 v145, v130, v131
    v_cvt_pk_bf16_f32 v146, v132, v133
    v_cvt_pk_bf16_f32 v147, v134, v135
    v_cvt_pk_bf16_f32 v148, v136, v137
    v_cvt_pk_bf16_f32 v149, v138, v139
    v_cvt_pk_bf16_f32 v150, v140, v141
    v_cvt_pk_bf16_f32 v151, v142, v143
    v_mov_b32 v10, 0
    v_cndmask_b32 v150, v150, v208, s[40:41]
    v_cndmask_b32 v151, v151, v10, s[40:41]
    s_branch K_qkv36_st
K_qkv36_v:
    s_waitcnt vmcnt(11) lgkmcnt(6)
    v_mfma_f32_32x32x16_bf16 v[128:143], v[16:19], v[160:163], 0
    buffer_load_dwordx4 v[64:67], v2, s[20:23], s32 offen offset:0 sc1
    v_mfma_f32_32x32x16_bf16 v[144:159], v[208:211], v[160:163], 0
    ds_read_b64_tr_b16 v[176:177], v11 offset:4096
    ds_read_b64_tr_b16 v[178:179], v11 offset:4608
    s_waitcnt vmcnt(11) lgkmcnt(6)
    v_mfma_f32_32x32x16_bf16 v[128:143], v[20:23], v[164:167], v[128:143]
    buffer_load_dwordx4 v[68:71], v2, s[20:23], s32 offen offset:1024 sc1
    v_mfma_f32_32x32x16_bf16 v[144:159], v[208:211], v[164:167], v[144:159]
    ds_read_b64_tr_b16 v[180:181], v11 offset:5120
    ds_read_b64_tr_b16 v[182:183], v11 offset:5632
    s_waitcnt vmcnt(11) lgkmcnt(6)
    v_mfma_f32_32x32x16_bf16 v[128:143], v[24:27], v[168:171], v[128:143]
    buffer_load_dwordx4 v[72:75], v2, s[20:23], s32 offen offset:2048 sc1
    v_mfma_f32_32x32x16_bf16 v[144:159], v[208:211], v[168:171], v[144:159]
    ds_read_b64_tr_b16 v[184:185], v11 offset:6144
    ds_read_b64_tr_b16 v[186:187], v11 offset:6656
    s_waitcnt vmcnt(11) lgkmcnt(6)
    v_mfma_f32_32x32x16_bf16 v[128:143], v[28:31], v[172:175], v[128:143]
    buffer_load_dwordx4 v[76:79], v2, s[20:23], s32 offen offset:3072 sc1
    s_add_u32 s32, s32, 4096
    v_mfma_f32_32x32x16_bf16 v[144:159], v[208:211], v[172:175], v[144:159]
    ds_read_b64_tr_b16 v[188:189], v11 offset:7168
    ds_read_b64_tr_b16 v[190:191], v11 offset:7680
    s_waitcnt vmcnt(11) lgkmcnt(6)
    v_mfma_f32_32x32x16_bf16 v[128:143], v[32:35], v[176:179], v[128:143]
    buffer_load_dwordx4 v[80:83], v2, s[20:23], s32 offen offset:0 sc1
    v_mfma_f32_32x32x16_bf16 v[144:159], v[208:211], v[176:179], v[144:159]
    ds_read_b64_tr_b16 v[160:161], v11 offset:8192
    ds_read_b64_tr_b16 v[162:163], v11 offset:8704
    s_waitcnt vmcnt(11) lgkmcnt(6)
    v_mfma_f32_32x32x16_bf16 v[128:143], v[36:39], v[180:183], v[128:143]
    buffer_load_dwordx4 v[84:87], v2, s[20:23], s32 offen offset:1024 sc1
    v_mfma_f32_32x32x16_bf16 v[144:159], v[208:211], v[180:183], v[144:159]
    ds_read_b64_tr_b16 v[164:165], v11 offset:9216
    ds_read_b64_tr_b16 v[166:167], v11 offset:9728
    s_waitcnt vmcnt(11) lgkmcnt(6)
    v_mfma_f32_32x32x16_bf16 v[128:143], v[40:43], v[184:187], v[128:143]
    buffer_load_dwordx4 v[88:91], v2, s[20:23], s32 offen offset:2048 sc1
    v_mfma_f32_32x32x16_bf16 v[144:159], v[208:211], v[184:187], v[144:159]
    ds_read_b64_tr_b16 v[168:169], v11 offset:10240
    ds_read_b64_tr_b16 v[170:171], v11 offset:10752
    s_waitcnt vmcnt(11) lgkmcnt(6)
    v_mfma_f32_32x32x16_bf16 v[128:143], v[44:47], v[188:191], v[128:143]
    buffer_load_dwordx4 v[92:95], v2, s[20:23], s32 offen offset:3072 sc1
    s_add_u32 s32, s32, 4096
    v_mfma_f32_32x32x16_bf16 v[144:159], v[208:211], v[188:191], v[144:159]
    ds_read_b64_tr_b16 v[172:173], v11 offset:11264
    ds_read_b64_tr_b16 v[174:175], v11 offset:11776
    s_waitcnt vmcnt(11) lgkmcnt(6)
    v_mfma_f32_32x32x16_bf16 v[128:143], v[48:51], v[160:163], v[128:143]
    buffer_load_dwordx4 v[96:99], v2, s[20:23], s32 offen offset:0 sc1
    v_mfma_f32_32x32x16_bf16 v[144:159], v[208:211], v[160:163], v[144:159]
    ds_read_b64_tr_b16 v[176:177], v11 offset:12288
    ds_read_b64_tr_b16 v[178:179], v11 offset:12800
    s_waitcnt vmcnt(11) lgkmcnt(6)
    v_mfma_f32_32x32x16_bf16 v[128:143], v[52:55], v[164:167], v[128:143]
    buffer_load_dwordx4 v[100:103], v2, s[20:23], s32 offen offset:1024 sc1
    v_mfma_f32_32x32x16_bf16 v[144:159], v[208:211], v[164:167], v[144:159]
    ds_read_b64_tr_b16 v[180:181], v11 offset:13312
    ds_read_b64_tr_b16 v[182:183], v11 offset:13824
    s_waitcnt vmcnt(11) lgkmcnt(6)
    v_mfma_f32_32x32x16_bf16 v[128:143], v[56:59], v[168:171], v[128:143]
    buffer_load_dwordx4 v[104:107], v2, s[20:23], s32 offen offset:2048 sc1
    v_mfma_f32_32x32x16_bf16 v[144:159], v[208:211], v[168:171], v[144:159]
    ds_read_b64_tr_b16 v[184:185], v11 offset:14336
    ds_read_b64_tr_b16 v[186:187], v11 offset:14848
    s_waitcnt vmcnt(11) lgkmcnt(6)
    v_mfma_f32_32x32x16_bf16 v[128:143], v[60:63], v[172:175], v[128:143]
    buffer_load_dwordx4 v[108:111], v2, s[20:23], s32 offen offset:3072 sc1
    s_add_u32 s32, s32, 4096
    v_mfma_f32_32x32x16_bf16 v[144:159], v[208:211], v[172:175], v[144:159]
    ds_read_b64_tr_b16 v[188:189], v11 offset:15360
    ds_read_b64_tr_b16 v[190:191], v11 offset:15872
    s_waitcnt vmcnt(11) lgkmcnt(6)
    v_mfma_f32_32x32x16_bf16 v[128:143], v[64:67], v[176:179], v[128:143]
    buffer_load_dwordx4 v[112:115], v2, s[20:23], s32 offen offset:0 sc1
    v_mfma_f32_32x32x16_bf16 v[144:159], v[208:211], v[176:179], v[144:159]
    ds_read_b64_tr_b16 v[160:161], v11 offset:16384
    ds_read_b64_tr_b16 v[162:163], v11 offset:16896
    s_waitcnt vmcnt(11) lgkmcnt(6)
    v_mfma_f32_32x32x16_bf16 v[128:143], v[68:71], v[180:183], v[128:143]
    buffer_load_dwordx4 v[116:119], v2, s[20:23], s32 offen offset:1024 sc1
    v_mfma_f32_32x32x16_bf16 v[144:159], v[208:211], v[180:183], v[144:159]
    ds_read_b64_tr_b16 v[164:165], v11 offset:17408
    ds_read_b64_tr_b16 v[166:167], v11 offset:17920
    s_waitcnt vmcnt(11) lgkmcnt(6)
    v_mfma_f32_32x32x16_bf16 v[128:143], v[72:75], v[184:187], v[128:143]
    buffer_load_dwordx4 v[120:123], v2, s[20:23], s32 offen offset:2048 sc1
    v_mfma_f32_32x32x16_bf16 v[144:159], v[208:211], v[184:187], v[144:159]
    ds_read_b64_tr_b16 v[168:169], v11 offset:18432
    ds_read_b64_tr_b16 v[170:171], v11 offset:18944
    s_waitcnt vmcnt(11) lgkmcnt(6)
    v_mfma_f32_32x32x16_bf16 v[128:143], v[76:79], v[188:191], v[128:143]
    buffer_load_dwordx4 v[124:127], v2, s[20:23], s32 offen offset:3072 sc1
    s_add_u32 s32, s32, 4096
    v_mfma_f32_32x32x16_bf16 v[144:159], v[208:211], v[188:191], v[144:159]
    ds_read_b64_tr_b16 v[172:173], v11 offset:19456
    ds_read_b64_tr_b16 v[174:175], v11 offset:19968
    s_waitcnt vmcnt(11) lgkmcnt(6)
    v_mfma_f32_32x32x16_bf16 v[128:143], v[80:83], v[160:163], v[128:143]
    buffer_load_dwordx2 v[192:193], v12, s[20:23], s33 offen sc1
    s_add_u32 s33, s33, 16384
    v_mfma_f32_32x32x16_bf16 v[144:159], v[208:211], v[160:163], v[144:159]
    ds_read_b64_tr_b16 v[176:177], v11 offset:20480
    ds_read_b64_tr_b16 v[178:179], v11 offset:20992
    s_waitcnt vmcnt(11) lgkmcnt(6)
    v_mfma_f32_32x32x16_bf16 v[128:143], v[84:87], v[164:167], v[128:143]
    buffer_load_dwordx2 v[194:195], v12, s[20:23], s33 offen sc1
    s_add_u32 s33, s33, 16384
    v_mfma_f32_32x32x16_bf16 v[144:159], v[208:211], v[164:167], v[144:159]
    ds_read_b64_tr_b16 v[180:181], v11 offset:21504
    ds_read_b64_tr_b16 v[182:183], v11 offset:22016
    s_waitcnt vmcnt(11) lgkmcnt(6)
    v_mfma_f32_32x32x16_bf16 v[128:143], v[88:91], v[168:171], v[128:143]
    buffer_load_dwordx2 v[196:197], v12, s[20:23], s33 offen sc1
    s_add_u32 s33, s33, 16384
    v_mfma_f32_32x32x16_bf16 v[144:159], v[208:211], v[168:171], v[144:159]
    ds_read_b64_tr_b16 v[184:185], v11 offset:22528
    ds_read_b64_tr_b16 v[186:187], v11 offset:23040
    s_waitcnt vmcnt(11) lgkmcnt(6)
    v_mfma_f32_32x32x16_bf16 v[128:143], v[92:95], v[172:175], v[128:143]
    buffer_load_dwordx2 v[198:199], v12, s[20:23], s33 offen sc1
    s_add_u32 s33, s33, 16384
    v_mfma_f32_32x32x16_bf16 v[144:159], v[208:211], v[172:175], v[144:159]
    ds_read_b64_tr_b16 v[188:189], v11 offset:23552
    ds_read_b64_tr_b16 v[190:191], v11 offset:24064
    s_waitcnt vmcnt(11) lgkmcnt(6)
    v_mfma_f32_32x32x16_bf16 v[128:143], v[96:99], v[176:179], v[128:143]
    buffer_load_dwordx2 v[200:201], v12, s[20:23], s33 offen sc1
    s_add_u32 s33, s33, 16384
    v_mfma_f32_32x32x16_bf16 v[144:159], v[208:211], v[176:179], v[144:159]
    ds_read_b64_tr_b16 v[160:161], v11 offset:24576
    ds_read_b64_tr_b16 v[162:163], v11 offset:25088
    s_waitcnt vmcnt(11) lgkmcnt(6)
    v_mfma_f32_32x32x16_bf16 v[128:143], v[100:103], v[180:183], v[128:143]
    buffer_load_dwordx2 v[202:203], v12, s[20:23], s33 offen sc1
    s_add_u32 s33, s33, 16384
    v_mfma_f32_32x32x16_bf16 v[144:159], v[208:211], v[180:183], v[144:159]
    ds_read_b64_tr_b16 v[164:165], v11 offset:25600
    ds_read_b64_tr_b16 v[166:167], v11 offset:26112
    s_waitcnt vmcnt(11) lgkmcnt(6)
    v_mfma_f32_32x32x16_bf16 v[128:143], v[104:107], v[184:187], v[128:143]
    buffer_load_dwordx2 v[204:205], v12, s[20:23], s33 offen sc1
    s_add_u32 s33, s33, 16384
    v_mfma_f32_32x32x16_bf16 v[144:159], v[208:211], v[184:187], v[144:159]
    ds_read_b64_tr_b16 v[168:169], v11 offset:26624
    ds_read_b64_tr_b16 v[170:171], v11 offset:27136
    s_waitcnt vmcnt(11) lgkmcnt(6)
    v_mfma_f32_32x32x16_bf16 v[128:143], v[108:111], v[188:191], v[128:143]
    v_mfma_f32_32x32x16_bf16 v[144:159], v[208:211], v[188:191], v[144:159]
    ds_read_b64_tr_b16 v[172:173], v11 offset:27648
    ds_read_b64_tr_b16 v[174:175], v11 offset:28160
    s_waitcnt vmcnt(10) lgkmcnt(6)
    v_mfma_f32_32x32x16_bf16 v[128:143], v[112:115], v[160:163], v[128:143]
    v_mfma_f32_32x32x16_bf16 v[144:159], v[208:211], v[160:163], v[144:159]
    s_waitcnt vmcnt(9) lgkmcnt(4)
    v_mfma_f32_32x32x16_bf16 v[128:143], v[116:119], v[164:167], v[128:143]
    v_mfma_f32_32x32x16_bf16 v[144:159], v[208:211], v[164:167], v[144:159]
    s_waitcnt vmcnt(8) lgkmcnt(2)
    v_mfma_f32_32x32x16_bf16 v[128:143], v[120:123], v[168:171], v[128:143]
    v_mfma_f32_32x32x16_bf16 v[144:159], v[208:211], v[168:171], v[144:159]
    s_waitcnt vmcnt(7) lgkmcnt(0)
    v_mfma_f32_32x32x16_bf16 v[128:143], v[124:127], v[172:175], v[128:143]
    v_mfma_f32_32x32x16_bf16 v[144:159], v[208:211], v[172:175], v[144:159]
    s_waitcnt vmcnt(0)
    v_add_f32 v192, v192, v194
    v_add_f32 v193, v193, v195
    v_add_f32 v192, v192, v196
    v_add_f32 v193, v193, v197
    v_add_f32 v192, v192, v198
    v_add_f32 v193, v193, v199
    v_add_f32 v192, v192, v200
    v_add_f32 v193, v193, v201
    v_add_f32 v192, v192, v202
    v_add_f32 v193, v193, v203
    v_add_f32 v192, v192, v204
    v_add_f32 v193, v193, v205
    v_mov_b32 v12, v192
    v_mov_b32 v13, v193
    s_nop 1
    v_permlane32_swap_b32 v12, v192
    v_permlane32_swap_b32 v13, v193
    v_add_f32 v12, v12, v192
    v_add_f32 v13, v13, v193
    v_mul_f32 v12, 0x3b124925, v12
    v_mul_f32 v13, 0x3b124925, v13
    v_fma_f32 v13, -v12, v12, v13
    v_max_f32 v13, 0, v13
    v_add_f32 v13, 0x3727c5ac, v13
    v_rsq_f32 v13, v13
    s_nop 0
    v_mul_f32_e64 v12, -v12, v13
    s_lshl_b32 s37, s16, 8
    s_add_u32 s37, s37, 77824
    v_and_b32 v10, 31, v1
    v_lshlrev_b32 v10, 2, v10
    v_add_u32 v10, s37, v10
    ds_write_b32 v10, v13
    ds_write_b32 v10, v12 offset:128
    v_lshlrev_b32 v10, 4, v3
    v_add_u32 v10, s37, v10
    s_waitcnt lgkmcnt(0)
    ds_read_b128 v[16:19], v10 offset:0
    ds_read_b128 v[32:35], v10 offset:128
    ds_read_b128 v[20:23], v10 offset:32
    ds_read_b128 v[36:39], v10 offset:160
    ds_read_b128 v[24:27], v10 offset:64
    ds_read_b128 v[40:43], v10 offset:192
    ds_read_b128 v[28:31], v10 offset:96
    ds_read_b128 v[44:47], v10 offset:224
    v_and_b32 v14, 31, v1
    v_cmp_eq_u32 vcc, 28, v14
    v_cmp_gt_u32 s[40:41], 28, v14
    v_mov_b32 v12, 0
    s_lshl_b32 s38, s30, 12
    v_cndmask_b32 v14, v12, v208, vcc
    s_add_u32 s38, s38, 0x1800800
    s_waitcnt lgkmcnt(0)
    v_pk_mul_f32 v[128:129], v[16:17], v[128:129]
    v_pk_mul_f32 v[130:131], v[18:19], v[130:131]
    v_pk_mul_f32 v[132:133], v[20:21], v[132:133]
    v_pk_mul_f32 v[134:135], v[22:23], v[134:135]
    v_pk_mul_f32 v[136:137], v[24:25], v[136:137]
    v_pk_mul_f32 v[138:139], v[26:27], v[138:139]
    v_pk_mul_f32 v[140:141], v[28:29], v[140:141]
    v_pk_mul_f32 v[142:143], v[30:31], v[142:143]
    v_pk_fma_f32 v[128:129], v[32:33], v[144:145], v[128:129]
    v_pk_fma_f32 v[130:131], v[34:35], v[146:147], v[130:131]
    v_pk_fma_f32 v[132:133], v[36:37], v[148:149], v[132:133]
    v_pk_fma_f32 v[134:135], v[38:39], v[150:151], v[134:135]
    v_pk_fma_f32 v[136:137], v[40:41], v[152:153], v[136:137]
    v_pk_fma_f32 v[138:139], v[42:43], v[154:155], v[138:139]
    v_pk_fma_f32 v[140:141], v[44:45], v[156:157], v[140:141]
    v_pk_fma_f32 v[142:143], v[46:47], v[158:159], v[142:143]
    v_cvt_pk_bf16_f32 v144, v128, v129
    v_cvt_pk_bf16_f32 v145, v130, v131
    v_cvt_pk_bf16_f32 v146, v132, v133
    v_cvt_pk_bf16_f32 v147, v134, v135
    v_cvt_pk_bf16_f32 v148, v136, v137
    v_cvt_pk_bf16_f32 v149, v138, v139
    v_cvt_pk_bf16_f32 v150, v140, v141
    v_cvt_pk_bf16_f32 v151, v142, v143
    v_cndmask_b32 v144, v14, v144, s[40:41]
    v_cndmask_b32 v145, v14, v145, s[40:41]
    v_cndmask_b32 v146, v14, v146, s[40:41]
    v_cndmask_b32 v147, v14, v147, s[40:41]
    v_cndmask_b32 v148, v14, v148, s[40:41]
    v_cndmask_b32 v149, v14, v149, s[40:41]
    v_cndmask_b32 v150, v14, v150, s[40:41]
    v_cndmask_b32 v151, v14, v151, s[40:41]
K_qkv36_st:
    buffer_store_dwordx4 v[144:147], v2, s[20:23], s38 offen sc1
    buffer_store_dwordx4 v[148:151], v2, s[20:23], s38 offen offset:1024 sc1
    v_and_b32 v8, 7, v1
    v_lshrrev_b32 v9, 3, v1
    v_lshlrev_b32 v9, 9, v9
    v_lshl_add_u32 v9, v8, 4, v9
    s_lshl_b32 s30, s17, 2
    s_lshr_b32 s37, s18, 2
    s_add_u32 s30, s30, s37
    s_mul_i32 s30, s30, 28672
    s_and_b32 s37, s18, 3
    s_lshl_b32 s37, s37, 7
    s_add_u32 s30, s30, s37
    s_mov_b32 s36, 0
    v_bfe_u32 v10, v1, 3, 2
    v_mad_u32_u24 v10, v10, 7, v3
    v_lshrrev_b32 v11, 2, v10
    v_lshlrev_b32 v12, 8, v11
    v_and_b32 v11, 1, v10
    v_lshl_add_u32 v12, v11, 7, v12
    v_bfe_u32 v11, v10, 1, 1
    v_lshl_add_u32 v12, v11, 3, v12
    v_lshl_add_u32 v12, v8, 4, v12
    v_add_u32 v10, 2, v10
    v_lshrrev_b32 v11, 2, v10
    v_lshlrev_b32 v13, 8, v11
    v_and_b32 v11, 1, v10
    v_lshl_add_u32 v13, v11, 7, v13
    v_bfe_u32 v11, v10, 1, 1
    v_lshl_add_u32 v13, v11, 3, v13
    v_lshl_add_u32 v13, v8, 4, v13
    s_xor_b32 s37, s16, 0
    s_mul_i32 s37, s37, 1792
    v_add_u32 v112, s37, v12
    v_add_u32 v113, s37, v13
    s_xor_b32 s37, s16, 1
    s_mul_i32 s37, s37, 1792
    v_add_u32 v114, s37, v12
    v_add_u32 v115, s37, v13
    s_xor_b32 s37, s16, 2
    s_mul_i32 s37, s37, 1792
    v_add_u32 v116, s37, v12
    v_add_u32 v117, s37, v13
    s_xor_b32 s37, s16, 3
    s_mul_i32 s37, s37, 1792
    v_add_u32 v118, s37, v12
    v_add_u32 v119, s37, v13
    v_mov_b32 v6, s62
    v_mov_b32 v7, s63
    s_lshl_b32 s40, s17, 8
    s_add_u32 s40, s40, 0x3c3000
    s_lshl_b32 s41, s18, 3
    s_add_u32 s41, s41, s40
    v_min_u32 v4, 15, v1
    v_lshlrev_b32 v4, 3, v4
    s_and_b32 s3, s40, 0x100
    s_andn2_b32 s40, s40, 0x100
    v_add_u32 v4, s3, v4
    s_xor_b32 s3, s3, 0x170
    v_and_b32 v5, 1, v1
    v_lshl_add_u32 v5, v5, 3, s3
    v_cndmask_b32 v4, v4, v5, s[28:29]
    s_lshl_b32 s3, s17, 1
    s_add_u32 s3, s3, s18
    s_lshl_b32 s3, s3, 3
    s_add_u32 s3, s3, 0x3c6f90
    v_lshlrev_b32 v5, 8, v1
    s_cmp_ge_u32 s18, 14
    s_cselect_b32 s42, 0xffff, 0
    buffer_load_dwordx4 a[16:19], v2, s[20:23], s34 offen offset:0 sc1
    buffer_load_dwordx4 a[20:23], v2, s[20:23], s34 offen offset:1024 sc1
    buffer_load_dwordx4 a[24:27], v2, s[20:23], s34 offen offset:2048 sc1
    buffer_load_dwordx4 a[28:31], v2, s[20:23], s34 offen offset:3072 sc1
    s_add_u32 s34, s34, 4096
    s_cmp_lg_u32 s16, 0
    s_waitcnt vmcnt(4)
    s_barrier
    s_cbranch_scc1 K_sig37
    s_mov_b64 exec, 1
    buffer_store_dwordx2 v[6:7], off, s[20:23], s41
    s_cmp_eq_u32 s42, 0
    s_cbranch_scc1 K_sigkv38
    s_mov_b64 exec, 0xffff
    buffer_store_dwordx2 v[6:7], v5, s[20:23], s3 offen sc1
    s_mov_b64 exec, 1
K_sigkv38:
    buffer_store_dwordx2 v[6:7], off, s[20:23], s41 offset:128 sc1
    s_mov_b64 exec, -1
K_sig37:
    s_mov_b32 s33, s34
    s_cmp_lg_u32 s16, 0
    s_cbranch_scc1 K_wdone39
    buffer_load_dwordx2 v[6:7], v4, s[20:23], s40 offen sc1
    s_mov_b64 s[42:43], 0
    s_mov_b32 s3, 0
K_wloop40:
    s_waitcnt vmcnt(0)
    v_cmp_eq_u64 vcc, s[62:63], v[6:7]
    s_or_b64 s[42:43], s[42:43], vcc
    s_cmp_eq_u64 s[42:43], -1
    s_cbranch_scc1 K_wgot42
    s_add_u32 s3, s3, 1
    s_bitcmp1_b32 s3, 3
    s_cbranch_scc0 K_wskip41
    s_add_u32 s3, s3, 7
    buffer_load_dwordx2 v[6:7], v4, s[20:23], s40 offen offset:128 sc1
    s_cmp_gt_u32 s3, 0x40000
    s_cbranch_scc0 K_wloop40
    s_branch K_wgot42
K_wskip41:
    buffer_load_dwordx2 v[6:7], v4, s[20:23], s40 offen sc1
    s_branch K_wloop40
K_wgot42:
    s_waitcnt vmcnt(0)
K_wdone39:
    s_barrier
    s_lshl_b32 s37, s16, 13
    s_add_u32 s37, s37, s30
    s_add_u32 s37, s37, 0x1600000
    s_lshl_b32 s38, s16, 11
    s_add_u32 m0, s38, 0
    s_add_u32 s39, s37, 4096
    buffer_load_dwordx4 v9, s[20:23], s37 offen sc1 lds
    s_add_u32 m0, s38, 1024
    s_lshl_b32 s31, s17, 14
    buffer_load_dwordx4 v9, s[20:23], s39 offen sc1 lds
    s_add_u32 s31, s31, 0x1800000
    buffer_load_dwordx4 v[144:147], v2, s[20:23], s31 offen sc1
    buffer_load_dwordx4 v[148:151], v2, s[20:23], s31 offen offset:1024 sc1
    s_lshl_b32 s31, s17, 14
    s_lshl_b32 s32, s16, 12
    s_add_u32 s31, s31, s32
    s_add_u32 s31, s31, 0x1800000
    s_mov_b32 s32, s31
    buffer_load_dwordx4 v[160:163], v2, s[20:23], s31 offen sc1
    buffer_load_dwordx4 v[164:167], v2, s[20:23], s31 offen offset:1024 sc1
    s_add_u32 m0, s38, 8192
    s_mul_i32 s37, s16, 7168
    s_add_u32 s37, s37, s30
    s_add_u32 s37, s37, 0x1400000
    s_add_u32 s39, s37, 4096
    buffer_load_dwordx4 v9, s[20:23], s37 offen sc1 lds
    s_add_u32 m0, s38, 9216
    v_bfe_u32 v11, v1, 4, 1
    buffer_load_dwordx4 v9, s[20:23], s39 offen sc1 lds
    v_lshlrev_b32 v10, 7, v11
    v_lshl_add_u32 v10, v8, 4, v10
    v_lshl_add_u32 v10, v3, 3, v10
    v_add_u32 v10, s38, v10
    v_lshrrev_b32 v7, 4, v1
    v_bfe_u32 v6, v1, 3, 2
    v_mul_u32_u24 v4, 912, v8
    v_lshl_add_u32 v5, v7, 4, v4
    v_mad_u32_u24 v4, v6, 56, v4
    v_lshl_add_u32 v4, v3, 3, v4
    s_mul_i32 s37, s16, 224
    s_add_u32 s37, s37, 49152
    v_add_u32 v4, s37, v4
    s_xor_b32 s37, s16, 1
    s_mul_i32 s37, s37, 12288
    s_add_u32 s37, s37, 0
    v_add_u32 v12, s37, v2
    s_xor_b32 s37, s16, 2
    s_mul_i32 s37, s37, 12288
    s_add_u32 s37, s37, 4096
    v_add_u32 v13, s37, v2
    s_xor_b32 s37, s16, 3
    s_mul_i32 s37, s37, 12288
    s_add_u32 s37, s37, 8192
    v_add_u32 v14, s37, v2
    s_mul_i32 s37, s16, 12288
    v_add_u32 v11, s37, v2
    s_mul_i32 s34, s19, 118784
    s_lshl_b32 s35, s16, 12
    s_add_u32 s34, s34, s35
    s_add_u32 s34, s34, 0x400000
    s_add_u32 m0, s35, 65536
    s_lshl_b32 s40, s17, 8
    s_add_u32 s40, s40, 0x3c7000
    v_and_b32 v15, 31, v1
    v_lshlrev_b32 v15, 3, v15
    s_lshl_b32 s37, s16, 7
    s_add_u32 s37, s37, 57344
    v_and_b32 v6, 31, v1
    v_lshl_add_u32 v6, v6, 2, s37
    v_xor_b32 v120, 128, v6
    v_xor_b32 v121, 256, v6
    v_xor_b32 v122, 384, v6
    s_waitcnt vmcnt(6)
    s_barrier
    ds_read_b64 v[16:17], v112 offset:0
    ds_read_b64 v[18:19], v113 offset:0
    ds_read_b64 v[20:21], v112 offset:256
    ds_read_b64 v[22:23], v113 offset:256
    ds_read_b64 v[24:25], v114 offset:0
    ds_read_b64 v[26:27], v115 offset:0
    ds_read_b64 v[28:29], v114 offset:256
    ds_read_b64 v[30:31], v115 offset:256
    ds_read_b64 v[32:33], v116 offset:0
    ds_read_b64 v[34:35], v117 offset:0
    ds_read_b64 v[36:37], v116 offset:256
    ds_read_b64 v[38:39], v117 offset:256
    ds_read_b64 v[40:41], v118 offset:0
    ds_read_b64 v[42:43], v119 offset:0
    ds_read_b64 v[44:45], v118 offset:256
    ds_read_b64 v[46:47], v119 offset:256
    buffer_load_dwordx4 v[184:187], v2, s[20:23], s31 offen offset:2048 sc1
    buffer_load_dwordx4 v[188:191], v2, s[20:23], s31 offen offset:3072 sc1
    s_xor_b32 s31, s32, 0x4000
    s_mov_b32 exec_lo, 0
    s_waitcnt lgkmcnt(12)
    v_mov_b32 v22, 0
    v_mov_b32 v23, 0
    s_mov_b32 exec_lo, -1
    s_waitcnt vmcnt(6)
    v_mfma_f32_32x32x16_bf16 v[48:63], v[144:147], v[16:19], 0
    v_mfma_f32_32x32x16_bf16 v[48:63], v[148:151], v[20:23], v[48:63]
    s_mov_b32 exec_lo, 0
    s_waitcnt lgkmcnt(0)
    v_mov_b32 v31, 0
    v_mov_b32 v39, 0
    v_mov_b32 v47, 0
    s_mov_b32 exec_lo, -1
    s_nop 5
    v_max3_f32 v128, v48, v49, v50
    v_max3_f32 v129, v51, v52, v53
    v_max3_f32 v128, v128, v54, v55
    v_max3_f32 v129, v129, v56, v57
    v_max3_f32 v128, v128, v58, v59
    v_max3_f32 v129, v129, v60, v61
    v_max3_f32 v128, v128, v62, v63
    v_max_f32 v128, v128, v129
    s_mov_b32 exec_lo, 0
    v_cvt_pk_bf16_f32 v22, -v128, 0
    ds_write_b32 v6, v22
    s_mov_b32 exec_lo, -1
    buffer_load_dwordx2 v[222:223], v15, s[20:23], s40 offen sc1
    s_waitcnt lgkmcnt(0)
    s_barrier
    s_mov_b32 exec_lo, 0
    ds_read_b32 v30, v120
    ds_read_b32 v38, v121
    ds_read_b32 v46, v122
    s_mov_b32 exec_lo, -1
    s_waitcnt vmcnt(5)
K_att43_go:
    v_mfma_f32_32x32x16_bf16 v[112:127], v[160:163], v[24:27], 0
    buffer_load_dwordx4 v[168:171], v2, s[20:23], s31 offen sc1
    buffer_load_dwordx4 v[172:175], v2, s[20:23], s31 offen offset:1024 sc1
    s_waitcnt lgkmcnt(0)
    v_mfma_f32_32x32x16_bf16 v[112:127], v[164:167], v[28:31], v[112:127]
    buffer_load_dwordx4 v[192:195], v2, s[20:23], s31 offen offset:2048 sc1
    buffer_load_dwordx4 v[196:199], v2, s[20:23], s31 offen offset:3072 sc1
    s_xor_b32 s31, s32, 0x8000
    s_nop 7
    v_mfma_f32_32x32x16_bf16 v[128:143], v[160:163], v[32:35], 0
    v_exp_f32 v112, v112
    v_exp_f32 v113, v113
    v_exp_f32 v114, v114
    v_exp_f32 v115, v115
    v_cvt_pk_bf16_f32 v144, v112, v113
    v_cvt_pk_bf16_f32 v145, v114, v115
    v_exp_f32 v116, v116
    v_exp_f32 v117, v117
    v_exp_f32 v118, v118
    v_exp_f32 v119, v119
    v_cvt_pk_bf16_f32 v146, v116, v117
    v_mfma_f32_32x32x16_bf16 v[128:143], v[164:167], v[36:39], v[128:143]
    buffer_load_dwordx4 a[32:35], v2, s[20:23], s33 offen offset:0 sc1
    v_cvt_pk_bf16_f32 v147, v118, v119
    v_exp_f32 v120, v120
    v_exp_f32 v121, v121
    v_exp_f32 v122, v122
    v_exp_f32 v123, v123
    v_cvt_pk_bf16_f32 v148, v120, v121
    s_waitcnt vmcnt(6)
    v_mfma_f32_32x32x16_bf16 v[64:79], v[184:187], v[144:147], 0
    v_cvt_pk_bf16_f32 v149, v122, v123
    v_exp_f32 v124, v124
    v_exp_f32 v125, v125
    v_exp_f32 v126, v126
    v_exp_f32 v127, v127
    v_cvt_pk_bf16_f32 v150, v124, v125
    v_cvt_pk_bf16_f32 v151, v126, v127
    v_mfma_f32_32x32x16_bf16 v[112:127], v[160:163], v[40:43], 0
    ds_read_b64 v[208:209], v10 offset:8192
    v_exp_f32 v128, v128
    v_exp_f32 v129, v129
    v_exp_f32 v130, v130
    v_exp_f32 v131, v131
    v_cvt_pk_bf16_f32 v152, v128, v129
    v_mfma_f32_32x32x16_bf16 v[64:79], v[188:191], v[148:151], v[64:79]
    ds_read_b64 v[210:211], v10 offset:8448
    v_cvt_pk_bf16_f32 v153, v130, v131
    v_exp_f32 v132, v132
    v_exp_f32 v133, v133
    v_exp_f32 v134, v134
    v_exp_f32 v135, v135
    v_cvt_pk_bf16_f32 v154, v132, v133
    v_mfma_f32_32x32x16_bf16 v[112:127], v[164:167], v[44:47], v[112:127]
    buffer_load_dwordx4 a[36:39], v2, s[20:23], s33 offen offset:1024 sc1
    v_cvt_pk_bf16_f32 v155, v134, v135
    v_exp_f32 v136, v136
    v_exp_f32 v137, v137
    v_exp_f32 v138, v138
    v_exp_f32 v139, v139
    v_cvt_pk_bf16_f32 v156, v136, v137
    v_mfma_f32_32x32x16_bf16 v[80:95], v[184:187], v[152:155], 0
    ds_read_b64 v[212:213], v10 offset:8704
    v_cvt_pk_bf16_f32 v157, v138, v139
    v_exp_f32 v140, v140
    v_exp_f32 v141, v141
    v_exp_f32 v142, v142
    v_exp_f32 v143, v143
    v_cvt_pk_bf16_f32 v158, v140, v141
    v_cvt_pk_bf16_f32 v159, v142, v143
    v_mfma_f32_32x32x16_bf16 v[128:143], v[160:163], v[16:19], 0
    s_waitcnt vmcnt(6)
    v_cmp_ne_u64 vcc, s[62:63], v[222:223]
    s_cbranch_vccnz K_gslow44
K_gback45:
    buffer_load_dwordx4 v[176:179], v2, s[20:23], s31 offen sc1
    buffer_load_dwordx4 v[180:183], v2, s[20:23], s31 offen offset:1024 sc1
    v_exp_f32 v112, v112
    v_exp_f32 v113, v113
    v_exp_f32 v114, v114
    v_exp_f32 v115, v115
    v_cvt_pk_bf16_f32 v144, v112, v113
    v_mfma_f32_32x32x16_bf16 v[80:95], v[188:191], v[156:159], v[80:95]
    buffer_load_dwordx4 v[200:203], v2, s[20:23], s31 offen offset:2048 sc1
    buffer_load_dwordx4 v[204:207], v2, s[20:23], s31 offen offset:3072 sc1
    v_cvt_pk_bf16_f32 v145, v114, v115
    v_exp_f32 v116, v116
    v_exp_f32 v117, v117
    v_exp_f32 v118, v118
    v_exp_f32 v119, v119
    v_cvt_pk_bf16_f32 v146, v116, v117
    v_mfma_f32_32x32x16_bf16 v[128:143], v[164:167], v[20:23], v[128:143]
    buffer_load_dwordx4 a[40:43], v2, s[20:23], s33 offen offset:2048 sc1
    v_cvt_pk_bf16_f32 v147, v118, v119
    v_exp_f32 v120, v120
    v_exp_f32 v121, v121
    v_exp_f32 v122, v122
    v_exp_f32 v123, v123
    v_cvt_pk_bf16_f32 v148, v120, v121
    v_mfma_f32_32x32x16_bf16 v[96:111], v[184:187], v[144:147], 0
    s_waitcnt vmcnt(7)
    v_cvt_pk_bf16_f32 v149, v122, v123
    v_exp_f32 v124, v124
    v_exp_f32 v125, v125
    v_exp_f32 v126, v126
    v_exp_f32 v127, v127
    v_cvt_pk_bf16_f32 v150, v124, v125
    v_cvt_pk_bf16_f32 v151, v126, v127
    v_mfma_f32_32x32x16_bf16 v[112:127], v[168:171], v[24:27], 0
    s_xor_b32 s31, s32, 0xc000
    buffer_load_dwordx4 v[160:163], v2, s[20:23], s31 offen sc1
    buffer_load_dwordx4 v[164:167], v2, s[20:23], s31 offen offset:1024 sc1
    v_exp_f32 v128, v128
    v_exp_f32 v129, v129
    v_exp_f32 v130, v130
    v_exp_f32 v131, v131
    v_cvt_pk_bf16_f32 v152, v128, v129
    v_mfma_f32_32x32x16_bf16 v[96:111], v[188:191], v[148:151], v[96:111]
    ds_read_b64 v[214:215], v10 offset:8960
    v_cvt_pk_bf16_f32 v153, v130, v131
    v_exp_f32 v132, v132
    v_exp_f32 v133, v133
    v_exp_f32 v134, v134
    v_exp_f32 v135, v135
    v_cvt_pk_bf16_f32 v154, v132, v133
    v_mfma_f32_32x32x16_bf16 v[112:127], v[172:175], v[28:31], v[112:127]
    buffer_load_dwordx4 a[44:47], v2, s[20:23], s33 offen offset:3072 sc1
    v_cvt_pk_bf16_f32 v155, v134, v135
    v_exp_f32 v136, v136
    v_exp_f32 v137, v137
    v_exp_f32 v138, v138
    v_exp_f32 v139, v139
    v_cvt_pk_bf16_f32 v156, v136, v137
    v_mfma_f32_32x32x16_bf16 v[48:63], v[184:187], v[152:155], 0
    ds_read_b64 v[216:217], v10 offset:9216
    v_cvt_pk_bf16_f32 v157, v138, v139
    v_exp_f32 v140, v140
    v_exp_f32 v141, v141
    v_exp_f32 v142, v142
    v_exp_f32 v143, v143
    v_cvt_pk_bf16_f32 v158, v140, v141
    v_cvt_pk_bf16_f32 v159, v142, v143
    v_mfma_f32_32x32x16_bf16 v[128:143], v[168:171], v[32:35], 0
    ds_read_b64 v[218:219], v10 offset:9472
    v_exp_f32 v112, v112
    v_exp_f32 v113, v113
    v_exp_f32 v114, v114
    v_exp_f32 v115, v115
    v_cvt_pk_bf16_f32 v144, v112, v113
    v_mfma_f32_32x32x16_bf16 v[48:63], v[188:191], v[156:159], v[48:63]
    s_add_u32 s33, s33, 4096
    buffer_load_dwordx4 a[48:51], v2, s[20:23], s33 offen offset:0 sc1
    v_cvt_pk_bf16_f32 v145, v114, v115
    v_exp_f32 v116, v116
    v_exp_f32 v117, v117
    v_exp_f32 v118, v118
    v_exp_f32 v119, v119
    v_cvt_pk_bf16_f32 v146, v116, v117
    v_mfma_f32_32x32x16_bf16 v[128:143], v[172:175], v[36:39], v[128:143]
    buffer_load_dwordx4 a[52:55], v2, s[20:23], s33 offen offset:1024 sc1
    v_cvt_pk_bf16_f32 v147, v118, v119
    v_exp_f32 v120, v120
    v_exp_f32 v121, v121
    v_exp_f32 v122, v122
    v_exp_f32 v123, v123
    v_cvt_pk_bf16_f32 v148, v120, v121
    v_mfma_f32_32x32x16_bf16 v[64:79], v[192:195], v[144:147], v[64:79]
    ds_read_b64 v[220:221], v10 offset:9728
    v_cvt_pk_bf16_f32 v149, v122, v123
    v_exp_f32 v124, v124
    v_exp_f32 v125, v125
    v_exp_f32 v126, v126
    v_exp_f32 v127, v127
    v_cvt_pk_bf16_f32 v150, v124, v125
    v_cvt_pk_bf16_f32 v151, v126, v127
    v_mfma_f32_32x32x16_bf16 v[112:127], v[168:171], v[40:43], 0
    buffer_load_dwordx4 v[184:187], v2, s[20:23], s31 offen offset:2048 sc1
    buffer_load_dwordx4 v[188:191], v2, s[20:23], s31 offen offset:3072 sc1
    v_exp_f32 v128, v128
    v_exp_f32 v129, v129
    v_exp_f32 v130, v130
    v_exp_f32 v131, v131
    v_cvt_pk_bf16_f32 v152, v128, v129
    v_mfma_f32_32x32x16_bf16 v[64:79], v[196:199], v[148:151], v[64:79]
    s_xor_b32 s31, s32, 0x10000
    v_cvt_pk_bf16_f32 v153, v130, v131
    v_exp_f32 v132, v132
    v_exp_f32 v133, v133
    v_exp_f32 v134, v134
    v_exp_f32 v135, v135
    v_cvt_pk_bf16_f32 v154, v132, v133
    v_mfma_f32_32x32x16_bf16 v[112:127], v[172:175], v[44:47], v[112:127]
    buffer_load_dwordx4 a[56:59], v2, s[20:23], s33 offen offset:2048 sc1
    v_cvt_pk_bf16_f32 v155, v134, v135
    v_exp_f32 v136, v136
    v_exp_f32 v137, v137
    v_exp_f32 v138, v138
    v_exp_f32 v139, v139
    v_cvt_pk_bf16_f32 v156, v136, v137
    v_mfma_f32_32x32x16_bf16 v[80:95], v[192:195], v[152:155], v[80:95]
    v_cvt_pk_bf16_f32 v157, v138, v139
    v_exp_f32 v140, v140
    v_exp_f32 v141, v141
    v_exp_f32 v142, v142
    v_exp_f32 v143, v143
    v_cvt_pk_bf16_f32 v158, v140, v141
    v_cvt_pk_bf16_f32 v159, v142, v143
    v_mfma_f32_32x32x16_bf16 v[128:143], v[168:171], v[16:19], 0
    v_exp_f32 v112, v112
    v_exp_f32 v113, v113
    v_exp_f32 v114, v114
    v_exp_f32 v115, v115
    v_cvt_pk_bf16_f32 v144, v112, v113
    v_mfma_f32_32x32x16_bf16 v[80:95], v[196:199], v[156:159], v[80:95]
    v_cvt_pk_bf16_f32 v145, v114, v115
    v_exp_f32 v116, v116
    v_exp_f32 v117, v117
    v_exp_f32 v118, v118
    v_exp_f32 v119, v119
    v_cvt_pk_bf16_f32 v146, v116, v117
    v_mfma_f32_32x32x16_bf16 v[128:143], v[172:175], v[20:23], v[128:143]
    buffer_load_dwordx4 a[60:63], v2, s[20:23], s33 offen offset:3072 sc1
    v_cvt_pk_bf16_f32 v147, v118, v119
    v_exp_f32 v120, v120
    v_exp_f32 v121, v121
    v_exp_f32 v122, v122
    v_exp_f32 v123, v123
    v_cvt_pk_bf16_f32 v148, v120, v121
    v_mfma_f32_32x32x16_bf16 v[96:111], v[192:195], v[144:147], v[96:111]
    s_waitcnt vmcnt(10)
    v_cvt_pk_bf16_f32 v149, v122, v123
    v_exp_f32 v124, v124
    v_exp_f32 v125, v125
    v_exp_f32 v126, v126
    v_exp_f32 v127, v127
    v_cvt_pk_bf16_f32 v150, v124, v125
    v_cvt_pk_bf16_f32 v151, v126, v127
    v_mfma_f32_32x32x16_bf16 v[112:127], v[176:179], v[24:27], 0
    buffer_load_dwordx4 v[168:171], v2, s[20:23], s31 offen sc1
    buffer_load_dwordx4 v[172:175], v2, s[20:23], s31 offen offset:1024 sc1
    v_exp_f32 v128, v128
    v_exp_f32 v129, v129
    v_exp_f32 v130, v130
    v_exp_f32 v131, v131
    v_cvt_pk_bf16_f32 v152, v128, v129
    v_mfma_f32_32x32x16_bf16 v[96:111], v[196:199], v[148:151], v[96:111]
    s_add_u32 s33, s33, 4096
    v_cvt_pk_bf16_f32 v153, v130, v131
    v_exp_f32 v132, v132
    v_exp_f32 v133, v133
    v_exp_f32 v134, v134
    v_exp_f32 v135, v135
    v_cvt_pk_bf16_f32 v154, v132, v133
    v_mfma_f32_32x32x16_bf16 v[112:127], v[180:183], v[28:31], v[112:127]
    buffer_load_dwordx4 a[64:67], v2, s[20:23], s33 offen offset:0 sc1
    v_cvt_pk_bf16_f32 v155, v134, v135
    v_exp_f32 v136, v136
    v_exp_f32 v137, v137
    v_exp_f32 v138, v138
    v_exp_f32 v139, v139
    v_cvt_pk_bf16_f32 v156, v136, v137
    v_mfma_f32_32x32x16_bf16 v[48:63], v[192:195], v[152:155], v[48:63]
    v_cvt_pk_bf16_f32 v157, v138, v139
    v_exp_f32 v140, v140
    v_exp_f32 v141, v141
    v_exp_f32 v142, v142
    v_exp_f32 v143, v143
    v_cvt_pk_bf16_f32 v158, v140, v141
    v_cvt_pk_bf16_f32 v159, v142, v143
    v_mfma_f32_32x32x16_bf16 v[128:143], v[176:179], v[32:35], 0
    v_exp_f32 v112, v112
    v_exp_f32 v113, v113
    v_exp_f32 v114, v114
    v_exp_f32 v115, v115
    v_cvt_pk_bf16_f32 v144, v112, v113
    v_mfma_f32_32x32x16_bf16 v[48:63], v[196:199], v[156:159], v[48:63]
    buffer_load_dwordx4 a[68:71], v2, s[20:23], s33 offen offset:1024 sc1
    v_cvt_pk_bf16_f32 v145, v114, v115
    v_exp_f32 v116, v116
    v_exp_f32 v117, v117
    v_exp_f32 v118, v118
    v_exp_f32 v119, v119
    v_cvt_pk_bf16_f32 v146, v116, v117
    v_mfma_f32_32x32x16_bf16 v[128:143], v[180:183], v[36:39], v[128:143]
    buffer_load_dwordx4 a[72:75], v2, s[20:23], s33 offen offset:2048 sc1
    v_cvt_pk_bf16_f32 v147, v118, v119
    v_exp_f32 v120, v120
    v_exp_f32 v121, v121
    v_exp_f32 v122, v122
    v_exp_f32 v123, v123
    v_cvt_pk_bf16_f32 v148, v120, v121
    v_mfma_f32_32x32x16_bf16 v[64:79], v[200:203], v[144:147], v[64:79]
    v_cvt_pk_bf16_f32 v149, v122, v123
    v_exp_f32 v124, v124
    v_exp_f32 v125, v125
    v_exp_f32 v126, v126
    v_exp_f32 v127, v127
    v_cvt_pk_bf16_f32 v150, v124, v125
    v_cvt_pk_bf16_f32 v151, v126, v127
    v_mfma_f32_32x32x16_bf16 v[112:127], v[176:179], v[40:43], 0
    buffer_load_dwordx4 v[192:195], v2, s[20:23], s31 offen offset:2048 sc1
    buffer_load_dwordx4 v[196:199], v2, s[20:23], s31 offen offset:3072 sc1
    v_exp_f32 v128, v128
    v_exp_f32 v129, v129
    v_exp_f32 v130, v130
    v_exp_f32 v131, v131
    v_cvt_pk_bf16_f32 v152, v128, v129
    v_mfma_f32_32x32x16_bf16 v[64:79], v[204:207], v[148:151], v[64:79]
    s_xor_b32 s31, s32, 0x14000
    v_cvt_pk_bf16_f32 v153, v130, v131
    v_exp_f32 v132, v132
    v_exp_f32 v133, v133
    v_exp_f32 v134, v134
    v_exp_f32 v135, v135
    v_cvt_pk_bf16_f32 v154, v132, v133
    v_mfma_f32_32x32x16_bf16 v[112:127], v[180:183], v[44:47], v[112:127]
    buffer_load_dwordx4 a[76:79], v2, s[20:23], s33 offen offset:3072 sc1
    v_cvt_pk_bf16_f32 v155, v134, v135
    v_exp_f32 v136, v136
    v_exp_f32 v137, v137
    v_exp_f32 v138, v138
    v_exp_f32 v139, v139
    v_cvt_pk_bf16_f32 v156, v136, v137
    v_mfma_f32_32x32x16_bf16 v[80:95], v[200:203], v[152:155], v[80:95]
    s_add_u32 s33, s33, 4096
    v_cvt_pk_bf16_f32 v157, v138, v139
    v_exp_f32 v140, v140
    v_exp_f32 v141, v141
    v_exp_f32 v142, v142
    v_exp_f32 v143, v143
    v_cvt_pk_bf16_f32 v158, v140, v141
    v_cvt_pk_bf16_f32 v159, v142, v143
    v_mfma_f32_32x32x16_bf16 v[128:143], v[176:179], v[16:19], 0
    v_exp_f32 v112, v112
    v_exp_f32 v113, v113
    v_exp_f32 v114, v114
    v_exp_f32 v115, v115
    v_cvt_pk_bf16_f32 v144, v112, v113
    v_mfma_f32_32x32x16_bf16 v[80:95], v[204:207], v[156:159], v[80:95]
    v_cvt_pk_bf16_f32 v145, v114, v115
    v_exp_f32 v116, v116
    v_exp_f32 v117, v117
    v_exp_f32 v118, v118
    v_exp_f32 v119, v119
    v_cvt_pk_bf16_f32 v146, v116, v117
    v_mfma_f32_32x32x16_bf16 v[128:143], v[180:183], v[20:23], v[128:143]
    buffer_load_dwordx4 a[80:83], v2, s[20:23], s33 offen offset:0 sc1
    v_cvt_pk_bf16_f32 v147, v118, v119
    v_exp_f32 v120, v120
    v_exp_f32 v121, v121
    v_exp_f32 v122, v122
    v_exp_f32 v123, v123
    v_cvt_pk_bf16_f32 v148, v120, v121
    v_mfma_f32_32x32x16_bf16 v[96:111], v[200:203], v[144:147], v[96:111]
    s_waitcnt vmcnt(11)
    v_cvt_pk_bf16_f32 v149, v122, v123
    v_exp_f32 v124, v124
    v_exp_f32 v125, v125
    v_exp_f32 v126, v126
    v_exp_f32 v127, v127
    v_cvt_pk_bf16_f32 v150, v124, v125
    v_cvt_pk_bf16_f32 v151, v126, v127
    v_mfma_f32_32x32x16_bf16 v[112:127], v[160:163], v[24:27], 0
    buffer_load_dwordx4 v[176:179], v2, s[20:23], s31 offen sc1
    buffer_load_dwordx4 v[180:183], v2, s[20:23], s31 offen offset:1024 sc1
    v_exp_f32 v128, v128
    v_exp_f32 v129, v129
    v_exp_f32 v130, v130
    v_exp_f32 v131, v131
    v_cvt_pk_bf16_f32 v152, v128, v129
    v_mfma_f32_32x32x16_bf16 v[96:111], v[204:207], v[148:151], v[96:111]
    v_cvt_pk_bf16_f32 v153, v130, v131
    v_exp_f32 v132, v132
    v_exp_f32 v133, v133
    v_exp_f32 v134, v134
    v_exp_f32 v135, v135
    v_cvt_pk_bf16_f32 v154, v132, v133
    v_mfma_f32_32x32x16_bf16 v[112:127], v[164:167], v[28:31], v[112:127]
    buffer_load_dwordx4 a[84:87], v2, s[20:23], s33 offen offset:1024 sc1
    v_cvt_pk_bf16_f32 v155, v134, v135
    v_exp_f32 v136, v136
    v_exp_f32 v137, v137
    v_exp_f32 v138, v138
    v_exp_f32 v139, v139
    v_cvt_pk_bf16_f32 v156, v136, v137
    v_mfma_f32_32x32x16_bf16 v[48:63], v[200:203], v[152:155], v[48:63]
    v_cvt_pk_bf16_f32 v157, v138, v139
    v_exp_f32 v140, v140
    v_exp_f32 v141, v141
    v_exp_f32 v142, v142
    v_exp_f32 v143, v143
    v_cvt_pk_bf16_f32 v158, v140, v141
    v_cvt_pk_bf16_f32 v159, v142, v143
    v_mfma_f32_32x32x16_bf16 v[128:143], v[160:163], v[32:35], 0
    v_exp_f32 v112, v112
    v_exp_f32 v113, v113
    v_exp_f32 v114, v114
    v_exp_f32 v115, v115
    v_cvt_pk_bf16_f32 v144, v112, v113
    v_mfma_f32_32x32x16_bf16 v[48:63], v[204:207], v[156:159], v[48:63]
    buffer_load_dwordx4 a[88:91], v2, s[20:23], s33 offen offset:2048 sc1
    v_cvt_pk_bf16_f32 v145, v114, v115
    v_exp_f32 v116, v116
    v_exp_f32 v117, v117
    v_exp_f32 v118, v118
    v_exp_f32 v119, v119
    v_cvt_pk_bf16_f32 v146, v116, v117
    v_mfma_f32_32x32x16_bf16 v[128:143], v[164:167], v[36:39], v[128:143]
    buffer_load_dwordx4 a[92:95], v2, s[20:23], s33 offen offset:3072 sc1
    v_cvt_pk_bf16_f32 v147, v118, v119
    v_exp_f32 v120, v120
    v_exp_f32 v121, v121
    v_exp_f32 v122, v122
    v_exp_f32 v123, v123
    v_cvt_pk_bf16_f32 v148, v120, v121
    v_mfma_f32_32x32x16_bf16 v[64:79], v[184:187], v[144:147], v[64:79]
    s_add_u32 s33, s33, 4096
    v_cvt_pk_bf16_f32 v149, v122, v123
    v_exp_f32 v124, v124
    v_exp_f32 v125, v125
    v_exp_f32 v126, v126
    v_exp_f32 v127, v127
    v_cvt_pk_bf16_f32 v150, v124, v125
    v_cvt_pk_bf16_f32 v151, v126, v127
    v_mfma_f32_32x32x16_bf16 v[112:127], v[160:163], v[40:43], 0
    buffer_load_dwordx4 v[200:203], v2, s[20:23], s31 offen offset:2048 sc1
    buffer_load_dwordx4 v[204:207], v2, s[20:23], s31 offen offset:3072 sc1
    v_exp_f32 v128, v128
    v_exp_f32 v129, v129
    v_exp_f32 v130, v130
    v_exp_f32 v131, v131
    v_cvt_pk_bf16_f32 v152, v128, v129
    v_mfma_f32_32x32x16_bf16 v[64:79], v[188:191], v[148:151], v[64:79]
    s_xor_b32 s31, s32, 0x18000
    v_cvt_pk_bf16_f32 v153, v130, v131
    v_exp_f32 v132, v132
    v_exp_f32 v133, v133
    v_exp_f32 v134, v134
    v_exp_f32 v135, v135
    v_cvt_pk_bf16_f32 v154, v132, v133
    v_mfma_f32_32x32x16_bf16 v[112:127], v[164:167], v[44:47], v[112:127]
    buffer_load_dwordx4 a[96:99], v2, s[20:23], s33 offen offset:0 sc1
    v_cvt_pk_bf16_f32 v155, v134, v135
    v_exp_f32 v136, v136
    v_exp_f32 v137, v137
    v_exp_f32 v138, v138
    v_exp_f32 v139, v139
    v_cvt_pk_bf16_f32 v156, v136, v137
    v_mfma_f32_32x32x16_bf16 v[80:95], v[184:187], v[152:155], v[80:95]
    v_cvt_pk_bf16_f32 v157, v138, v139
    v_exp_f32 v140, v140
    v_exp_f32 v141, v141
    v_exp_f32 v142, v142
    v_exp_f32 v143, v143
    v_cvt_pk_bf16_f32 v158, v140, v141
    v_cvt_pk_bf16_f32 v159, v142, v143
    v_mfma_f32_32x32x16_bf16 v[128:143], v[160:163], v[16:19], 0
    v_exp_f32 v112, v112
    v_exp_f32 v113, v113
    v_exp_f32 v114, v114
    v_exp_f32 v115, v115
    v_cvt_pk_bf16_f32 v144, v112, v113
    v_mfma_f32_32x32x16_bf16 v[80:95], v[188:191], v[156:159], v[80:95]
    v_cvt_pk_bf16_f32 v145, v114, v115
    v_exp_f32 v116, v116
    v_exp_f32 v117, v117
    v_exp_f32 v118, v118
    v_exp_f32 v119, v119
    v_cvt_pk_bf16_f32 v146, v116, v117
    v_mfma_f32_32x32x16_bf16 v[128:143], v[164:167], v[20:23], v[128:143]
    buffer_load_dwordx4 a[100:103], v2, s[20:23], s33 offen offset:1024 sc1
    v_cvt_pk_bf16_f32 v147, v118, v119
    v_exp_f32 v120, v120
    v_exp_f32 v121, v121
    v_exp_f32 v122, v122
    v_exp_f32 v123, v123
    v_cvt_pk_bf16_f32 v148, v120, v121
    v_mfma_f32_32x32x16_bf16 v[96:111], v[184:187], v[144:147], v[96:111]
    s_waitcnt vmcnt(11)
    v_cvt_pk_bf16_f32 v149, v122, v123
    v_exp_f32 v124, v124
    v_exp_f32 v125, v125
    v_exp_f32 v126, v126
    v_exp_f32 v127, v127
    v_cvt_pk_bf16_f32 v150, v124, v125
    v_cvt_pk_bf16_f32 v151, v126, v127
    v_mfma_f32_32x32x16_bf16 v[112:127], v[168:171], v[24:27], 0
    buffer_load_dwordx4 v[160:163], v2, s[20:23], s31 offen sc1
    buffer_load_dwordx4 v[164:167], v2, s[20:23], s31 offen offset:1024 sc1
    v_exp_f32 v128, v128
    v_exp_f32 v129, v129
    v_exp_f32 v130, v130
    v_exp_f32 v131, v131
    v_cvt_pk_bf16_f32 v152, v128, v129
    v_mfma_f32_32x32x16_bf16 v[96:111], v[188:191], v[148:151], v[96:111]
    v_cvt_pk_bf16_f32 v153, v130, v131
    v_exp_f32 v132, v132
    v_exp_f32 v133, v133
    v_exp_f32 v134, v134
    v_exp_f32 v135, v135
    v_cvt_pk_bf16_f32 v154, v132, v133
    v_mfma_f32_32x32x16_bf16 v[112:127], v[172:175], v[28:31], v[112:127]
    buffer_load_dwordx4 a[104:107], v2, s[20:23], s33 offen offset:2048 sc1
    v_cvt_pk_bf16_f32 v155, v134, v135
    v_exp_f32 v136, v136
    v_exp_f32 v137, v137
    v_exp_f32 v138, v138
    v_exp_f32 v139, v139
    v_cvt_pk_bf16_f32 v156, v136, v137
    v_mfma_f32_32x32x16_bf16 v[48:63], v[184:187], v[152:155], v[48:63]
    v_cvt_pk_bf16_f32 v157, v138, v139
    v_exp_f32 v140, v140
    v_exp_f32 v141, v141
    v_exp_f32 v142, v142
    v_exp_f32 v143, v143
    v_cvt_pk_bf16_f32 v158, v140, v141
    v_cvt_pk_bf16_f32 v159, v142, v143
    v_mfma_f32_32x32x16_bf16 v[128:143], v[168:171], v[32:35], 0
    v_exp_f32 v112, v112
    v_exp_f32 v113, v113
    v_exp_f32 v114, v114
    v_exp_f32 v115, v115
    v_cvt_pk_bf16_f32 v144, v112, v113
    v_mfma_f32_32x32x16_bf16 v[48:63], v[188:191], v[156:159], v[48:63]
    v_cvt_pk_bf16_f32 v145, v114, v115
    v_exp_f32 v116, v116
    v_exp_f32 v117, v117
    v_exp_f32 v118, v118
    v_exp_f32 v119, v119
    v_cvt_pk_bf16_f32 v146, v116, v117
    v_mfma_f32_32x32x16_bf16 v[128:143], v[172:175], v[36:39], v[128:143]
    buffer_load_dwordx4 a[108:111], v2, s[20:23], s33 offen offset:3072 sc1
    v_cvt_pk_bf16_f32 v147, v118, v119
    v_exp_f32 v120, v120
    v_exp_f32 v121, v121
    v_exp_f32 v122, v122
    v_exp_f32 v123, v123
    v_cvt_pk_bf16_f32 v148, v120, v121
    v_mfma_f32_32x32x16_bf16 v[64:79], v[192:195], v[144:147], v[64:79]
    s_add_u32 s33, s33, 4096
    v_cvt_pk_bf16_f32 v149, v122, v123
    v_exp_f32 v124, v124
    v_exp_f32 v125, v125
    v_exp_f32 v126, v126
    v_exp_f32 v127, v127
    v_cvt_pk_bf16_f32 v150, v124, v125
    v_cvt_pk_bf16_f32 v151, v126, v127
    v_mfma_f32_32x32x16_bf16 v[112:127], v[168:171], v[40:43], 0
    buffer_load_dwordx4 v[184:187], v2, s[20:23], s31 offen offset:2048 sc1
    buffer_load_dwordx4 v[188:191], v2, s[20:23], s31 offen offset:3072 sc1
    v_exp_f32 v128, v128
    v_exp_f32 v129, v129
    v_exp_f32 v130, v130
    v_exp_f32 v131, v131
    v_cvt_pk_bf16_f32 v152, v128, v129
    v_mfma_f32_32x32x16_bf16 v[64:79], v[196:199], v[148:151], v[64:79]
    buffer_load_dwordx4 a[112:115], v2, s[20:23], s33 offen offset:0 sc1
    v_cvt_pk_bf16_f32 v153, v130, v131
    v_exp_f32 v132, v132
    v_exp_f32 v133, v133
    v_exp_f32 v134, v134
    v_exp_f32 v135, v135
    v_cvt_pk_bf16_f32 v154, v132, v133
    v_mfma_f32_32x32x16_bf16 v[112:127], v[172:175], v[44:47], v[112:127]
    buffer_load_dwordx4 a[116:119], v2, s[20:23], s33 offen offset:1024 sc1
    v_cvt_pk_bf16_f32 v155, v134, v135
    v_exp_f32 v136, v136
    v_exp_f32 v137, v137
    v_exp_f32 v138, v138
    v_exp_f32 v139, v139
    v_cvt_pk_bf16_f32 v156, v136, v137
    v_mfma_f32_32x32x16_bf16 v[80:95], v[192:195], v[152:155], v[80:95]
    s_xor_b32 s31, s32, 0x1c000
    v_cvt_pk_bf16_f32 v157, v138, v139
    v_exp_f32 v140, v140
    v_exp_f32 v141, v141
    v_exp_f32 v142, v142
    v_exp_f32 v143, v143
    v_cvt_pk_bf16_f32 v158, v140, v141
    v_cvt_pk_bf16_f32 v159, v142, v143
    v_mfma_f32_32x32x16_bf16 v[128:143], v[168:171], v[16:19], 0
    v_exp_f32 v112, v112
    v_exp_f32 v113, v113
    v_exp_f32 v114, v114
    v_exp_f32 v115, v115
    v_cvt_pk_bf16_f32 v144, v112, v113
    v_mfma_f32_32x32x16_bf16 v[80:95], v[196:199], v[156:159], v[80:95]
    v_cvt_pk_bf16_f32 v145, v114, v115
    v_exp_f32 v116, v116
    v_exp_f32 v117, v117
    v_exp_f32 v118, v118
    v_exp_f32 v119, v119
    v_cvt_pk_bf16_f32 v146, v116, v117
    v_mfma_f32_32x32x16_bf16 v[128:143], v[172:175], v[20:23], v[128:143]
    buffer_load_dwordx4 a[120:123], v2, s[20:23], s33 offen offset:2048 sc1
    v_cvt_pk_bf16_f32 v147, v118, v119
    v_exp_f32 v120, v120
    v_exp_f32 v121, v121
    v_exp_f32 v122, v122
    v_exp_f32 v123, v123
    v_cvt_pk_bf16_f32 v148, v120, v121
    v_mfma_f32_32x32x16_bf16 v[96:111], v[192:195], v[144:147], v[96:111]
    s_waitcnt vmcnt(11)
    v_cvt_pk_bf16_f32 v149, v122, v123
    v_exp_f32 v124, v124
    v_exp_f32 v125, v125
    v_exp_f32 v126, v126
    v_exp_f32 v127, v127
    v_cvt_pk_bf16_f32 v150, v124, v125
    v_cvt_pk_bf16_f32 v151, v126, v127
    v_mfma_f32_32x32x16_bf16 v[112:127], v[176:179], v[24:27], 0
    buffer_load_dwordx4 v[168:171], v2, s[20:23], s31 offen sc1
    buffer_load_dwordx4 v[172:175], v2, s[20:23], s31 offen offset:1024 sc1
    v_exp_f32 v128, v128
    v_exp_f32 v129, v129
    v_exp_f32 v130, v130
    v_exp_f32 v131, v131
    v_cvt_pk_bf16_f32 v152, v128, v129
    v_mfma_f32_32x32x16_bf16 v[96:111], v[196:199], v[148:151], v[96:111]
    v_cvt_pk_bf16_f32 v153, v130, v131
    v_exp_f32 v132, v132
    v_exp_f32 v133, v133
    v_exp_f32 v134, v134
    v_exp_f32 v135, v135
    v_cvt_pk_bf16_f32 v154, v132, v133
    v_mfma_f32_32x32x16_bf16 v[112:127], v[180:183], v[28:31], v[112:127]
    buffer_load_dwordx4 a[124:127], v2, s[20:23], s33 offen offset:3072 sc1
    v_cvt_pk_bf16_f32 v155, v134, v135
    v_exp_f32 v136, v136
    v_exp_f32 v137, v137
    v_exp_f32 v138, v138
    v_exp_f32 v139, v139
    v_cvt_pk_bf16_f32 v156, v136, v137
    v_mfma_f32_32x32x16_bf16 v[48:63], v[192:195], v[152:155], v[48:63]
    s_add_u32 s33, s33, 4096
    v_cvt_pk_bf16_f32 v157, v138, v139
    v_exp_f32 v140, v140
    v_exp_f32 v141, v141
    v_exp_f32 v142, v142
    v_exp_f32 v143, v143
    v_cvt_pk_bf16_f32 v158, v140, v141
    v_cvt_pk_bf16_f32 v159, v142, v143
    v_mfma_f32_32x32x16_bf16 v[128:143], v[176:179], v[32:35], 0
    v_exp_f32 v112, v112
    v_exp_f32 v113, v113
    v_exp_f32 v114, v114
    v_exp_f32 v115, v115
    v_cvt_pk_bf16_f32 v144, v112, v113
    v_mfma_f32_32x32x16_bf16 v[48:63], v[196:199], v[156:159], v[48:63]
    v_cvt_pk_bf16_f32 v145, v114, v115
    v_exp_f32 v116, v116
    v_exp_f32 v117, v117
    v_exp_f32 v118, v118
    v_exp_f32 v119, v119
    v_cvt_pk_bf16_f32 v146, v116, v117
    v_mfma_f32_32x32x16_bf16 v[128:143], v[180:183], v[36:39], v[128:143]
    buffer_load_dwordx4 a[128:131], v2, s[20:23], s33 offen offset:0 sc1
    v_cvt_pk_bf16_f32 v147, v118, v119
    v_exp_f32 v120, v120
    v_exp_f32 v121, v121
    v_exp_f32 v122, v122
    v_exp_f32 v123, v123
    v_cvt_pk_bf16_f32 v148, v120, v121
    v_mfma_f32_32x32x16_bf16 v[64:79], v[200:203], v[144:147], v[64:79]
    v_cvt_pk_bf16_f32 v149, v122, v123
    v_exp_f32 v124, v124
    v_exp_f32 v125, v125
    v_exp_f32 v126, v126
    v_exp_f32 v127, v127
    v_cvt_pk_bf16_f32 v150, v124, v125
    v_cvt_pk_bf16_f32 v151, v126, v127
    v_mfma_f32_32x32x16_bf16 v[112:127], v[176:179], v[40:43], 0
    buffer_load_dwordx4 v[192:195], v2, s[20:23], s31 offen offset:2048 sc1
    buffer_load_dwordx4 v[196:199], v2, s[20:23], s31 offen offset:3072 sc1
    v_exp_f32 v128, v128
    v_exp_f32 v129, v129
    v_exp_f32 v130, v130
    v_exp_f32 v131, v131
    v_cvt_pk_bf16_f32 v152, v128, v129
    v_mfma_f32_32x32x16_bf16 v[64:79], v[204:207], v[148:151], v[64:79]
    buffer_load_dwordx4 a[132:135], v2, s[20:23], s33 offen offset:1024 sc1
    v_cvt_pk_bf16_f32 v153, v130, v131
    v_exp_f32 v132, v132
    v_exp_f32 v133, v133
    v_exp_f32 v134, v134
    v_exp_f32 v135, v135
    v_cvt_pk_bf16_f32 v154, v132, v133
    v_mfma_f32_32x32x16_bf16 v[112:127], v[180:183], v[44:47], v[112:127]
    buffer_load_dwordx4 a[136:139], v2, s[20:23], s33 offen offset:2048 sc1
    v_cvt_pk_bf16_f32 v155, v134, v135
    v_exp_f32 v136, v136
    v_exp_f32 v137, v137
    v_exp_f32 v138, v138
    v_exp_f32 v139, v139
    v_cvt_pk_bf16_f32 v156, v136, v137
    v_mfma_f32_32x32x16_bf16 v[80:95], v[200:203], v[152:155], v[80:95]
    s_xor_b32 s31, s32, 0x20000
    v_cvt_pk_bf16_f32 v157, v138, v139
    v_exp_f32 v140, v140
    v_exp_f32 v141, v141
    v_exp_f32 v142, v142
    v_exp_f32 v143, v143
    v_cvt_pk_bf16_f32 v158, v140, v141
    v_cvt_pk_bf16_f32 v159, v142, v143
    v_mfma_f32_32x32x16_bf16 v[128:143], v[176:179], v[16:19], 0
    v_exp_f32 v112, v112
    v_exp_f32 v113, v113
    v_exp_f32 v114, v114
    v_exp_f32 v115, v115
    v_cvt_pk_bf16_f32 v144, v112, v113
    v_mfma_f32_32x32x16_bf16 v[80:95], v[204:207], v[156:159], v[80:95]
    v_cvt_pk_bf16_f32 v145, v114, v115
    v_exp_f32 v116, v116
    v_exp_f32 v117, v117
    v_exp_f32 v118, v118
    v_exp_f32 v119, v119
    v_cvt_pk_bf16_f32 v146, v116, v117
    v_mfma_f32_32x32x16_bf16 v[128:143], v[180:183], v[20:23], v[128:143]
    buffer_load_dwordx4 a[140:143], v2, s[20:23], s33 offen offset:3072 sc1
    v_cvt_pk_bf16_f32 v147, v118, v119
    v_exp_f32 v120, v120
    v_exp_f32 v121, v121
    v_exp_f32 v122, v122
    v_exp_f32 v123, v123
    v_cvt_pk_bf16_f32 v148, v120, v121
    v_mfma_f32_32x32x16_bf16 v[96:111], v[200:203], v[144:147], v[96:111]
    s_waitcnt vmcnt(12)
    v_cvt_pk_bf16_f32 v149, v122, v123
    v_exp_f32 v124, v124
    v_exp_f32 v125, v125
    v_exp_f32 v126, v126
    v_exp_f32 v127, v127
    v_cvt_pk_bf16_f32 v150, v124, v125
    v_cvt_pk_bf16_f32 v151, v126, v127
    v_mfma_f32_32x32x16_bf16 v[112:127], v[160:163], v[24:27], 0
    buffer_load_dwordx4 v[176:179], v2, s[20:23], s31 offen sc1
    buffer_load_dwordx4 v[180:183], v2, s[20:23], s31 offen offset:1024 sc1
    v_exp_f32 v128, v128
    v_exp_f32 v129, v129
    v_exp_f32 v130, v130
    v_exp_f32 v131, v131
    v_cvt_pk_bf16_f32 v152, v128, v129
    v_mfma_f32_32x32x16_bf16 v[96:111], v[204:207], v[148:151], v[96:111]
    s_add_u32 s33, s33, 4096
    v_cvt_pk_bf16_f32 v153, v130, v131
    v_exp_f32 v132, v132
    v_exp_f32 v133, v133
    v_exp_f32 v134, v134
    v_exp_f32 v135, v135
    v_cvt_pk_bf16_f32 v154, v132, v133
    v_mfma_f32_32x32x16_bf16 v[112:127], v[164:167], v[28:31], v[112:127]
    buffer_load_dwordx4 a[144:147], v2, s[20:23], s33 offen offset:0 sc1
    v_cvt_pk_bf16_f32 v155, v134, v135
    v_exp_f32 v136, v136
    v_exp_f32 v137, v137
    v_exp_f32 v138, v138
    v_exp_f32 v139, v139
    v_cvt_pk_bf16_f32 v156, v136, v137
    v_mfma_f32_32x32x16_bf16 v[48:63], v[200:203], v[152:155], v[48:63]
    v_cvt_pk_bf16_f32 v157, v138, v139
    v_exp_f32 v140, v140
    v_exp_f32 v141, v141
    v_exp_f32 v142, v142
    v_exp_f32 v143, v143
    v_cvt_pk_bf16_f32 v158, v140, v141
    v_cvt_pk_bf16_f32 v159, v142, v143
    v_mfma_f32_32x32x16_bf16 v[128:143], v[160:163], v[32:35], 0
    v_exp_f32 v112, v112
    v_exp_f32 v113, v113
    v_exp_f32 v114, v114
    v_exp_f32 v115, v115
    v_cvt_pk_bf16_f32 v144, v112, v113
    v_mfma_f32_32x32x16_bf16 v[48:63], v[204:207], v[156:159], v[48:63]
    v_cvt_pk_bf16_f32 v145, v114, v115
    v_exp_f32 v116, v116
    v_exp_f32 v117, v117
    v_exp_f32 v118, v118
    v_exp_f32 v119, v119
    v_cvt_pk_bf16_f32 v146, v116, v117
    v_mfma_f32_32x32x16_bf16 v[128:143], v[164:167], v[36:39], v[128:143]
    buffer_load_dwordx4 a[148:151], v2, s[20:23], s33 offen offset:1024 sc1
    v_cvt_pk_bf16_f32 v147, v118, v119
    v_exp_f32 v120, v120
    v_exp_f32 v121, v121
    v_exp_f32 v122, v122
    v_exp_f32 v123, v123
    v_cvt_pk_bf16_f32 v148, v120, v121
    v_mfma_f32_32x32x16_bf16 v[64:79], v[184:187], v[144:147], v[64:79]
    v_cvt_pk_bf16_f32 v149, v122, v123
    v_exp_f32 v124, v124
    v_exp_f32 v125, v125
    v_exp_f32 v126, v126
    v_exp_f32 v127, v127
    v_cvt_pk_bf16_f32 v150, v124, v125
    v_cvt_pk_bf16_f32 v151, v126, v127
    v_mfma_f32_32x32x16_bf16 v[112:127], v[160:163], v[40:43], 0
    buffer_load_dwordx4 v[200:203], v2, s[20:23], s31 offen offset:2048 sc1
    buffer_load_dwordx4 v[204:207], v2, s[20:23], s31 offen offset:3072 sc1
    v_exp_f32 v128, v128
    v_exp_f32 v129, v129
    v_exp_f32 v130, v130
    v_exp_f32 v131, v131
    v_cvt_pk_bf16_f32 v152, v128, v129
    v_mfma_f32_32x32x16_bf16 v[64:79], v[188:191], v[148:151], v[64:79]
    buffer_load_dwordx4 a[152:155], v2, s[20:23], s33 offen offset:2048 sc1
    v_cvt_pk_bf16_f32 v153, v130, v131
    v_exp_f32 v132, v132
    v_exp_f32 v133, v133
    v_exp_f32 v134, v134
    v_exp_f32 v135, v135
    v_cvt_pk_bf16_f32 v154, v132, v133
    v_mfma_f32_32x32x16_bf16 v[112:127], v[164:167], v[44:47], v[112:127]
    buffer_load_dwordx4 a[156:159], v2, s[20:23], s33 offen offset:3072 sc1
    v_cvt_pk_bf16_f32 v155, v134, v135
    v_exp_f32 v136, v136
    v_exp_f32 v137, v137
    v_exp_f32 v138, v138
    v_exp_f32 v139, v139
    v_cvt_pk_bf16_f32 v156, v136, v137
    v_mfma_f32_32x32x16_bf16 v[80:95], v[184:187], v[152:155], v[80:95]
    s_xor_b32 s31, s32, 0x24000
    v_cvt_pk_bf16_f32 v157, v138, v139
    v_exp_f32 v140, v140
    v_exp_f32 v141, v141
    v_exp_f32 v142, v142
    v_exp_f32 v143, v143
    v_cvt_pk_bf16_f32 v158, v140, v141
    v_cvt_pk_bf16_f32 v159, v142, v143
    v_mfma_f32_32x32x16_bf16 v[128:143], v[160:163], v[16:19], 0
    s_add_u32 s33, s33, 4096
    v_exp_f32 v112, v112
    v_exp_f32 v113, v113
    v_exp_f32 v114, v114
    v_exp_f32 v115, v115
    v_cvt_pk_bf16_f32 v144, v112, v113
    v_mfma_f32_32x32x16_bf16 v[80:95], v[188:191], v[156:159], v[80:95]
    v_cvt_pk_bf16_f32 v145, v114, v115
    v_exp_f32 v116, v116
    v_exp_f32 v117, v117
    v_exp_f32 v118, v118
    v_exp_f32 v119, v119
    v_cvt_pk_bf16_f32 v146, v116, v117
    v_mfma_f32_32x32x16_bf16 v[128:143], v[164:167], v[20:23], v[128:143]
    buffer_load_dwordx4 a[160:163], v2, s[20:23], s33 offen offset:0 sc1
    v_cvt_pk_bf16_f32 v147, v118, v119
    v_exp_f32 v120, v120
    v_exp_f32 v121, v121
    v_exp_f32 v122, v122
    v_exp_f32 v123, v123
    v_cvt_pk_bf16_f32 v148, v120, v121
    v_mfma_f32_32x32x16_bf16 v[96:111], v[184:187], v[144:147], v[96:111]
    s_waitcnt vmcnt(12)
    v_cvt_pk_bf16_f32 v149, v122, v123
    v_exp_f32 v124, v124
    v_exp_f32 v125, v125
    v_exp_f32 v126, v126
    v_exp_f32 v127, v127
    v_cvt_pk_bf16_f32 v150, v124, v125
    v_cvt_pk_bf16_f32 v151, v126, v127
    v_mfma_f32_32x32x16_bf16 v[112:127], v[168:171], v[24:27], 0
    buffer_load_dwordx4 v[160:163], v2, s[20:23], s31 offen sc1
    buffer_load_dwordx4 v[164:167], v2, s[20:23], s31 offen offset:1024 sc1
    v_exp_f32 v128, v128
    v_exp_f32 v129, v129
    v_exp_f32 v130, v130
    v_exp_f32 v131, v131
    v_cvt_pk_bf16_f32 v152, v128, v129
    v_mfma_f32_32x32x16_bf16 v[96:111], v[188:191], v[148:151], v[96:111]
    v_cvt_pk_bf16_f32 v153, v130, v131
    v_exp_f32 v132, v132
    v_exp_f32 v133, v133
    v_exp_f32 v134, v134
    v_exp_f32 v135, v135
    v_cvt_pk_bf16_f32 v154, v132, v133
    v_mfma_f32_32x32x16_bf16 v[112:127], v[172:175], v[28:31], v[112:127]
    buffer_load_dwordx4 a[164:167], v2, s[20:23], s33 offen offset:1024 sc1
    v_cvt_pk_bf16_f32 v155, v134, v135
    v_exp_f32 v136, v136
    v_exp_f32 v137, v137
    v_exp_f32 v138, v138
    v_exp_f32 v139, v139
    v_cvt_pk_bf16_f32 v156, v136, v137
    v_mfma_f32_32x32x16_bf16 v[48:63], v[184:187], v[152:155], v[48:63]
    v_cvt_pk_bf16_f32 v157, v138, v139
    v_exp_f32 v140, v140
    v_exp_f32 v141, v141
    v_exp_f32 v142, v142
    v_exp_f32 v143, v143
    v_cvt_pk_bf16_f32 v158, v140, v141
    v_cvt_pk_bf16_f32 v159, v142, v143
    v_mfma_f32_32x32x16_bf16 v[128:143], v[168:171], v[32:35], 0
    v_exp_f32 v112, v112
    v_exp_f32 v113, v113
    v_exp_f32 v114, v114
    v_exp_f32 v115, v115
    v_cvt_pk_bf16_f32 v144, v112, v113
    v_mfma_f32_32x32x16_bf16 v[48:63], v[188:191], v[156:159], v[48:63]
    v_cvt_pk_bf16_f32 v145, v114, v115
    v_exp_f32 v116, v116
    v_exp_f32 v117, v117
    v_exp_f32 v118, v118
    v_exp_f32 v119, v119
    v_cvt_pk_bf16_f32 v146, v116, v117
    v_mfma_f32_32x32x16_bf16 v[128:143], v[172:175], v[36:39], v[128:143]
    buffer_load_dwordx4 a[168:171], v2, s[20:23], s33 offen offset:2048 sc1
    v_cvt_pk_bf16_f32 v147, v118, v119
    v_exp_f32 v120, v120
    v_exp_f32 v121, v121
    v_exp_f32 v122, v122
    v_exp_f32 v123, v123
    v_cvt_pk_bf16_f32 v148, v120, v121
    v_mfma_f32_32x32x16_bf16 v[64:79], v[192:195], v[144:147], v[64:79]
    v_cvt_pk_bf16_f32 v149, v122, v123
    v_exp_f32 v124, v124
    v_exp_f32 v125, v125
    v_exp_f32 v126, v126
    v_exp_f32 v127, v127
    v_cvt_pk_bf16_f32 v150, v124, v125
    v_cvt_pk_bf16_f32 v151, v126, v127
    v_mfma_f32_32x32x16_bf16 v[112:127], v[168:171], v[40:43], 0
    buffer_load_dwordx4 v[184:187], v2, s[20:23], s31 offen offset:2048 sc1
    buffer_load_dwordx4 v[188:191], v2, s[20:23], s31 offen offset:3072 sc1
    v_exp_f32 v128, v128
    v_exp_f32 v129, v129
    v_exp_f32 v130, v130
    v_exp_f32 v131, v131
    v_cvt_pk_bf16_f32 v152, v128, v129
    v_mfma_f32_32x32x16_bf16 v[64:79], v[196:199], v[148:151], v[64:79]
    buffer_load_dwordx4 a[172:175], v2, s[20:23], s33 offen offset:3072 sc1
    v_cvt_pk_bf16_f32 v153, v130, v131
    v_exp_f32 v132, v132
    v_exp_f32 v133, v133
    v_exp_f32 v134, v134
    v_exp_f32 v135, v135
    v_cvt_pk_bf16_f32 v154, v132, v133
    v_mfma_f32_32x32x16_bf16 v[112:127], v[172:175], v[44:47], v[112:127]
    s_add_u32 s33, s33, 4096
    buffer_load_dwordx4 a[176:179], v2, s[20:23], s33 offen offset:0 sc1
    v_cvt_pk_bf16_f32 v155, v134, v135
    v_exp_f32 v136, v136
    v_exp_f32 v137, v137
    v_exp_f32 v138, v138
    v_exp_f32 v139, v139
    v_cvt_pk_bf16_f32 v156, v136, v137
    v_mfma_f32_32x32x16_bf16 v[80:95], v[192:195], v[152:155], v[80:95]
    s_xor_b32 s31, s32, 0x28000
    v_cvt_pk_bf16_f32 v157, v138, v139
    v_exp_f32 v140, v140
    v_exp_f32 v141, v141
    v_exp_f32 v142, v142
    v_exp_f32 v143, v143
    v_cvt_pk_bf16_f32 v158, v140, v141
    v_cvt_pk_bf16_f32 v159, v142, v143
    v_mfma_f32_32x32x16_bf16 v[128:143], v[168:171], v[16:19], 0
    v_exp_f32 v112, v112
    v_exp_f32 v113, v113
    v_exp_f32 v114, v114
    v_exp_f32 v115, v115
    v_cvt_pk_bf16_f32 v144, v112, v113
    v_mfma_f32_32x32x16_bf16 v[80:95], v[196:199], v[156:159], v[80:95]
    v_cvt_pk_bf16_f32 v145, v114, v115
    v_exp_f32 v116, v116
    v_exp_f32 v117, v117
    v_exp_f32 v118, v118
    v_exp_f32 v119, v119
    v_cvt_pk_bf16_f32 v146, v116, v117
    v_mfma_f32_32x32x16_bf16 v[128:143], v[172:175], v[20:23], v[128:143]
    buffer_load_dwordx4 a[180:183], v2, s[20:23], s33 offen offset:1024 sc1
    v_cvt_pk_bf16_f32 v147, v118, v119
    v_exp_f32 v120, v120
    v_exp_f32 v121, v121
    v_exp_f32 v122, v122
    v_exp_f32 v123, v123
    v_cvt_pk_bf16_f32 v148, v120, v121
    v_mfma_f32_32x32x16_bf16 v[96:111], v[192:195], v[144:147], v[96:111]
    s_waitcnt vmcnt(12)
    v_cvt_pk_bf16_f32 v149, v122, v123
    v_exp_f32 v124, v124
    v_exp_f32 v125, v125
    v_exp_f32 v126, v126
    v_exp_f32 v127, v127
    v_cvt_pk_bf16_f32 v150, v124, v125
    v_cvt_pk_bf16_f32 v151, v126, v127
    v_mfma_f32_32x32x16_bf16 v[112:127], v[176:179], v[24:27], 0
    buffer_load_dwordx4 v[168:171], v2, s[20:23], s31 offen sc1
    buffer_load_dwordx4 v[172:175], v2, s[20:23], s31 offen offset:1024 sc1
    v_exp_f32 v128, v128
    v_exp_f32 v129, v129
    v_exp_f32 v130, v130
    v_exp_f32 v131, v131
    v_cvt_pk_bf16_f32 v152, v128, v129
    v_mfma_f32_32x32x16_bf16 v[96:111], v[196:199], v[148:151], v[96:111]
    v_cvt_pk_bf16_f32 v153, v130, v131
    v_exp_f32 v132, v132
    v_exp_f32 v133, v133
    v_exp_f32 v134, v134
    v_exp_f32 v135, v135
    v_cvt_pk_bf16_f32 v154, v132, v133
    v_mfma_f32_32x32x16_bf16 v[112:127], v[180:183], v[28:31], v[112:127]
    buffer_load_dwordx4 a[184:187], v2, s[20:23], s33 offen offset:2048 sc1
    v_cvt_pk_bf16_f32 v155, v134, v135
    v_exp_f32 v136, v136
    v_exp_f32 v137, v137
    v_exp_f32 v138, v138
    v_exp_f32 v139, v139
    v_cvt_pk_bf16_f32 v156, v136, v137
    v_mfma_f32_32x32x16_bf16 v[48:63], v[192:195], v[152:155], v[48:63]
    v_cvt_pk_bf16_f32 v157, v138, v139
    v_exp_f32 v140, v140
    v_exp_f32 v141, v141
    v_exp_f32 v142, v142
    v_exp_f32 v143, v143
    v_cvt_pk_bf16_f32 v158, v140, v141
    v_cvt_pk_bf16_f32 v159, v142, v143
    v_mfma_f32_32x32x16_bf16 v[128:143], v[176:179], v[32:35], 0
    v_exp_f32 v112, v112
    v_exp_f32 v113, v113
    v_exp_f32 v114, v114
    v_exp_f32 v115, v115
    v_cvt_pk_bf16_f32 v144, v112, v113
    v_mfma_f32_32x32x16_bf16 v[48:63], v[196:199], v[156:159], v[48:63]
    v_cvt_pk_bf16_f32 v145, v114, v115
    v_exp_f32 v116, v116
    v_exp_f32 v117, v117
    v_exp_f32 v118, v118
    v_exp_f32 v119, v119
    v_cvt_pk_bf16_f32 v146, v116, v117
    v_mfma_f32_32x32x16_bf16 v[128:143], v[180:183], v[36:39], v[128:143]
    buffer_load_dwordx4 a[188:191], v2, s[20:23], s33 offen offset:3072 sc1
    v_cvt_pk_bf16_f32 v147, v118, v119
    v_exp_f32 v120, v120
    v_exp_f32 v121, v121
    v_exp_f32 v122, v122
    v_exp_f32 v123, v123
    v_cvt_pk_bf16_f32 v148, v120, v121
    v_mfma_f32_32x32x16_bf16 v[64:79], v[200:203], v[144:147], v[64:79]
    s_add_u32 s33, s33, 4096
    v_cvt_pk_bf16_f32 v149, v122, v123
    v_exp_f32 v124, v124
    v_exp_f32 v125, v125
    v_exp_f32 v126, v126
    v_exp_f32 v127, v127
    v_cvt_pk_bf16_f32 v150, v124, v125
    v_cvt_pk_bf16_f32 v151, v126, v127
    v_mfma_f32_32x32x16_bf16 v[112:127], v[176:179], v[40:43], 0
    buffer_load_dwordx4 v[192:195], v2, s[20:23], s31 offen offset:2048 sc1
    buffer_load_dwordx4 v[196:199], v2, s[20:23], s31 offen offset:3072 sc1
    v_exp_f32 v128, v128
    v_exp_f32 v129, v129
    v_exp_f32 v130, v130
    v_exp_f32 v131, v131
    v_cvt_pk_bf16_f32 v152, v128, v129
    v_mfma_f32_32x32x16_bf16 v[64:79], v[204:207], v[148:151], v[64:79]
    s_xor_b32 s31, s32, 0x2c000
    v_cvt_pk_bf16_f32 v153, v130, v131
    v_exp_f32 v132, v132
    v_exp_f32 v133, v133
    v_exp_f32 v134, v134
    v_exp_f32 v135, v135
    v_cvt_pk_bf16_f32 v154, v132, v133
    v_mfma_f32_32x32x16_bf16 v[112:127], v[180:183], v[44:47], v[112:127]
    buffer_load_dwordx4 a[192:195], v2, s[20:23], s33 offen offset:0 sc1
    v_cvt_pk_bf16_f32 v155, v134, v135
    v_exp_f32 v136, v136
    v_exp_f32 v137, v137
    v_exp_f32 v138, v138
    v_exp_f32 v139, v139
    v_cvt_pk_bf16_f32 v156, v136, v137
    v_mfma_f32_32x32x16_bf16 v[80:95], v[200:203], v[152:155], v[80:95]
    v_cvt_pk_bf16_f32 v157, v138, v139
    v_exp_f32 v140, v140
    v_exp_f32 v141, v141
    v_exp_f32 v142, v142
    v_exp_f32 v143, v143
    v_cvt_pk_bf16_f32 v158, v140, v141
    v_cvt_pk_bf16_f32 v159, v142, v143
    v_mfma_f32_32x32x16_bf16 v[128:143], v[176:179], v[16:19], 0
    v_exp_f32 v112, v112
    v_exp_f32 v113, v113
    v_exp_f32 v114, v114
    v_exp_f32 v115, v115
    v_cvt_pk_bf16_f32 v144, v112, v113
    v_mfma_f32_32x32x16_bf16 v[80:95], v[204:207], v[156:159], v[80:95]
    buffer_load_dwordx4 a[196:199], v2, s[20:23], s33 offen offset:1024 sc1
    v_cvt_pk_bf16_f32 v145, v114, v115
    v_exp_f32 v116, v116
    v_exp_f32 v117, v117
    v_exp_f32 v118, v118
    v_exp_f32 v119, v119
    v_cvt_pk_bf16_f32 v146, v116, v117
    v_mfma_f32_32x32x16_bf16 v[128:143], v[180:183], v[20:23], v[128:143]
    buffer_load_dwordx4 a[200:203], v2, s[20:23], s33 offen offset:2048 sc1
    v_cvt_pk_bf16_f32 v147, v118, v119
    v_exp_f32 v120, v120
    v_exp_f32 v121, v121
    v_exp_f32 v122, v122
    v_exp_f32 v123, v123
    v_cvt_pk_bf16_f32 v148, v120, v121
    v_mfma_f32_32x32x16_bf16 v[96:111], v[200:203], v[144:147], v[96:111]
    s_waitcnt vmcnt(12)
    v_cvt_pk_bf16_f32 v149, v122, v123
    v_exp_f32 v124, v124
    v_exp_f32 v125, v125
    v_exp_f32 v126, v126
    v_exp_f32 v127, v127
    v_cvt_pk_bf16_f32 v150, v124, v125
    v_cvt_pk_bf16_f32 v151, v126, v127
    v_mfma_f32_32x32x16_bf16 v[112:127], v[160:163], v[24:27], 0
    buffer_load_dwordx4 v[176:179], v2, s[20:23], s31 offen sc1
    buffer_load_dwordx4 v[180:183], v2, s[20:23], s31 offen offset:1024 sc1
    v_exp_f32 v128, v128
    v_exp_f32 v129, v129
    v_exp_f32 v130, v130
    v_exp_f32 v131, v131
    v_cvt_pk_bf16_f32 v152, v128, v129
    v_mfma_f32_32x32x16_bf16 v[96:111], v[204:207], v[148:151], v[96:111]
    v_cvt_pk_bf16_f32 v153, v130, v131
    v_exp_f32 v132, v132
    v_exp_f32 v133, v133
    v_exp_f32 v134, v134
    v_exp_f32 v135, v135
    v_cvt_pk_bf16_f32 v154, v132, v133
    v_mfma_f32_32x32x16_bf16 v[112:127], v[164:167], v[28:31], v[112:127]
    buffer_load_dwordx4 a[204:207], v2, s[20:23], s33 offen offset:3072 sc1
    v_cvt_pk_bf16_f32 v155, v134, v135
    v_exp_f32 v136, v136
    v_exp_f32 v137, v137
    v_exp_f32 v138, v138
    v_exp_f32 v139, v139
    v_cvt_pk_bf16_f32 v156, v136, v137
    v_mfma_f32_32x32x16_bf16 v[48:63], v[200:203], v[152:155], v[48:63]
    s_add_u32 s33, s33, 4096
    v_cvt_pk_bf16_f32 v157, v138, v139
    v_exp_f32 v140, v140
    v_exp_f32 v141, v141
    v_exp_f32 v142, v142
    v_exp_f32 v143, v143
    v_cvt_pk_bf16_f32 v158, v140, v141
    v_cvt_pk_bf16_f32 v159, v142, v143
    v_mfma_f32_32x32x16_bf16 v[128:143], v[160:163], v[32:35], 0
    v_exp_f32 v112, v112
    v_exp_f32 v113, v113
    v_exp_f32 v114, v114
    v_exp_f32 v115, v115
    v_cvt_pk_bf16_f32 v144, v112, v113
    v_mfma_f32_32x32x16_bf16 v[48:63], v[204:207], v[156:159], v[48:63]
    v_cvt_pk_bf16_f32 v145, v114, v115
    v_exp_f32 v116, v116
    v_exp_f32 v117, v117
    v_exp_f32 v118, v118
    v_exp_f32 v119, v119
    v_cvt_pk_bf16_f32 v146, v116, v117
    v_mfma_f32_32x32x16_bf16 v[128:143], v[164:167], v[36:39], v[128:143]
    buffer_load_dwordx4 a[208:211], v2, s[20:23], s33 offen offset:0 sc1
    v_cvt_pk_bf16_f32 v147, v118, v119
    v_exp_f32 v120, v120
    v_exp_f32 v121, v121
    v_exp_f32 v122, v122
    v_exp_f32 v123, v123
    v_cvt_pk_bf16_f32 v148, v120, v121
    v_mfma_f32_32x32x16_bf16 v[64:79], v[184:187], v[144:147], v[64:79]
    v_cvt_pk_bf16_f32 v149, v122, v123
    v_exp_f32 v124, v124
    v_exp_f32 v125, v125
    v_exp_f32 v126, v126
    v_exp_f32 v127, v127
    v_cvt_pk_bf16_f32 v150, v124, v125
    v_cvt_pk_bf16_f32 v151, v126, v127
    v_mfma_f32_32x32x16_bf16 v[112:127], v[160:163], v[40:43], 0
    buffer_load_dwordx4 v[200:203], v2, s[20:23], s31 offen offset:2048 sc1
    buffer_load_dwordx4 v[204:207], v2, s[20:23], s31 offen offset:3072 sc1
    v_exp_f32 v128, v128
    v_exp_f32 v129, v129
    v_exp_f32 v130, v130
    v_exp_f32 v131, v131
    v_cvt_pk_bf16_f32 v152, v128, v129
    v_mfma_f32_32x32x16_bf16 v[64:79], v[188:191], v[148:151], v[64:79]
    s_xor_b32 s31, s32, 0x30000
    v_cvt_pk_bf16_f32 v153, v130, v131
    v_exp_f32 v132, v132
    v_exp_f32 v133, v133
    v_exp_f32 v134, v134
    v_exp_f32 v135, v135
    v_cvt_pk_bf16_f32 v154, v132, v133
    v_mfma_f32_32x32x16_bf16 v[112:127], v[164:167], v[44:47], v[112:127]
    buffer_load_dwordx4 a[212:215], v2, s[20:23], s33 offen offset:1024 sc1
    v_cvt_pk_bf16_f32 v155, v134, v135
    v_exp_f32 v136, v136
    v_exp_f32 v137, v137
    v_exp_f32 v138, v138
    v_exp_f32 v139, v139
    v_cvt_pk_bf16_f32 v156, v136, v137
    v_mfma_f32_32x32x16_bf16 v[80:95], v[184:187], v[152:155], v[80:95]
    v_cvt_pk_bf16_f32 v157, v138, v139
    v_exp_f32 v140, v140
    v_exp_f32 v141, v141
    v_exp_f32 v142, v142
    v_exp_f32 v143, v143
    v_cvt_pk_bf16_f32 v158, v140, v141
    v_cvt_pk_bf16_f32 v159, v142, v143
    v_mfma_f32_32x32x16_bf16 v[128:143], v[160:163], v[16:19], 0
    v_exp_f32 v112, v112
    v_exp_f32 v113, v113
    v_exp_f32 v114, v114
    v_exp_f32 v115, v115
    v_cvt_pk_bf16_f32 v144, v112, v113
    v_mfma_f32_32x32x16_bf16 v[80:95], v[188:191], v[156:159], v[80:95]
    buffer_load_dwordx4 a[216:219], v2, s[20:23], s33 offen offset:2048 sc1
    v_cvt_pk_bf16_f32 v145, v114, v115
    v_exp_f32 v116, v116
    v_exp_f32 v117, v117
    v_exp_f32 v118, v118
    v_exp_f32 v119, v119
    v_cvt_pk_bf16_f32 v146, v116, v117
    v_mfma_f32_32x32x16_bf16 v[128:143], v[164:167], v[20:23], v[128:143]
    buffer_load_dwordx4 a[220:223], v2, s[20:23], s33 offen offset:3072 sc1
    v_cvt_pk_bf16_f32 v147, v118, v119
    v_exp_f32 v120, v120
    v_exp_f32 v121, v121
    v_exp_f32 v122, v122
    v_exp_f32 v123, v123
    v_cvt_pk_bf16_f32 v148, v120, v121
    v_mfma_f32_32x32x16_bf16 v[96:111], v[184:187], v[144:147], v[96:111]
    s_waitcnt vmcnt(12)
    v_cvt_pk_bf16_f32 v149, v122, v123
    v_exp_f32 v124, v124
    v_exp_f32 v125, v125
    v_exp_f32 v126, v126
    v_exp_f32 v127, v127
    v_cvt_pk_bf16_f32 v150, v124, v125
    v_cvt_pk_bf16_f32 v151, v126, v127
    v_mfma_f32_32x32x16_bf16 v[112:127], v[168:171], v[24:27], 0
    buffer_load_dwordx4 v[160:163], v2, s[20:23], s31 offen sc1
    buffer_load_dwordx4 v[164:167], v2, s[20:23], s31 offen offset:1024 sc1
    v_exp_f32 v128, v128
    v_exp_f32 v129, v129
    v_exp_f32 v130, v130
    v_exp_f32 v131, v131
    v_cvt_pk_bf16_f32 v152, v128, v129
    v_mfma_f32_32x32x16_bf16 v[96:111], v[188:191], v[148:151], v[96:111]
    s_add_u32 s33, s33, 4096
    v_cvt_pk_bf16_f32 v153, v130, v131
    v_exp_f32 v132, v132
    v_exp_f32 v133, v133
    v_exp_f32 v134, v134
    v_exp_f32 v135, v135
    v_cvt_pk_bf16_f32 v154, v132, v133
    v_mfma_f32_32x32x16_bf16 v[112:127], v[172:175], v[28:31], v[112:127]
    buffer_load_dwordx4 a[224:227], v2, s[20:23], s33 offen offset:0 sc1
    v_cvt_pk_bf16_f32 v155, v134, v135
    v_exp_f32 v136, v136
    v_exp_f32 v137, v137
    v_exp_f32 v138, v138
    v_exp_f32 v139, v139
    v_cvt_pk_bf16_f32 v156, v136, v137
    v_mfma_f32_32x32x16_bf16 v[48:63], v[184:187], v[152:155], v[48:63]
    v_cvt_pk_bf16_f32 v157, v138, v139
    v_exp_f32 v140, v140
    v_exp_f32 v141, v141
    v_exp_f32 v142, v142
    v_exp_f32 v143, v143
    v_cvt_pk_bf16_f32 v158, v140, v141
    v_cvt_pk_bf16_f32 v159, v142, v143
    v_mfma_f32_32x32x16_bf16 v[128:143], v[168:171], v[32:35], 0
    v_exp_f32 v112, v112
    v_exp_f32 v113, v113
    v_exp_f32 v114, v114
    v_exp_f32 v115, v115
    v_cvt_pk_bf16_f32 v144, v112, v113
    v_mfma_f32_32x32x16_bf16 v[48:63], v[188:191], v[156:159], v[48:63]
    v_cvt_pk_bf16_f32 v145, v114, v115
    v_exp_f32 v116, v116
    v_exp_f32 v117, v117
    v_exp_f32 v118, v118
    v_exp_f32 v119, v119
    v_cvt_pk_bf16_f32 v146, v116, v117
    v_mfma_f32_32x32x16_bf16 v[128:143], v[172:175], v[36:39], v[128:143]
    buffer_load_dwordx4 a[228:231], v2, s[20:23], s33 offen offset:1024 sc1
    v_cvt_pk_bf16_f32 v147, v118, v119
    v_exp_f32 v120, v120
    v_exp_f32 v121, v121
    v_exp_f32 v122, v122
    v_exp_f32 v123, v123
    v_cvt_pk_bf16_f32 v148, v120, v121
    v_mfma_f32_32x32x16_bf16 v[64:79], v[192:195], v[144:147], v[64:79]
    v_cvt_pk_bf16_f32 v149, v122, v123
    v_exp_f32 v124, v124
    v_exp_f32 v125, v125
    v_exp_f32 v126, v126
    v_exp_f32 v127, v127
    v_cvt_pk_bf16_f32 v150, v124, v125
    v_cvt_pk_bf16_f32 v151, v126, v127
    v_mfma_f32_32x32x16_bf16 v[112:127], v[168:171], v[40:43], 0
    buffer_load_dwordx4 v[184:187], v2, s[20:23], s31 offen offset:2048 sc1
    buffer_load_dwordx4 v[188:191], v2, s[20:23], s31 offen offset:3072 sc1
    v_exp_f32 v128, v128
    v_exp_f32 v129, v129
    v_exp_f32 v130, v130
    v_exp_f32 v131, v131
    v_cvt_pk_bf16_f32 v152, v128, v129
    v_mfma_f32_32x32x16_bf16 v[64:79], v[196:199], v[148:151], v[64:79]
    s_xor_b32 s31, s32, 0x34000
    v_cvt_pk_bf16_f32 v153, v130, v131
    v_exp_f32 v132, v132
    v_exp_f32 v133, v133
    v_exp_f32 v134, v134
    v_exp_f32 v135, v135
    v_cvt_pk_bf16_f32 v154, v132, v133
    v_mfma_f32_32x32x16_bf16 v[112:127], v[172:175], v[44:47], v[112:127]
    buffer_load_dwordx4 a[232:235], v2, s[20:23], s33 offen offset:2048 sc1
    v_cvt_pk_bf16_f32 v155, v134, v135
    v_exp_f32 v136, v136
    v_exp_f32 v137, v137
    v_exp_f32 v138, v138
    v_exp_f32 v139, v139
    v_cvt_pk_bf16_f32 v156, v136, v137
    v_mfma_f32_32x32x16_bf16 v[80:95], v[192:195], v[152:155], v[80:95]
    v_cvt_pk_bf16_f32 v157, v138, v139
    v_exp_f32 v140, v140
    v_exp_f32 v141, v141
    v_exp_f32 v142, v142
    v_exp_f32 v143, v143
    v_cvt_pk_bf16_f32 v158, v140, v141
    v_cvt_pk_bf16_f32 v159, v142, v143
    v_mfma_f32_32x32x16_bf16 v[128:143], v[168:171], v[16:19], 0
    v_exp_f32 v112, v112
    v_exp_f32 v113, v113
    v_exp_f32 v114, v114
    v_exp_f32 v115, v115
    v_cvt_pk_bf16_f32 v144, v112, v113
    v_mfma_f32_32x32x16_bf16 v[80:95], v[196:199], v[156:159], v[80:95]
    buffer_load_dwordx4 a[236:239], v2, s[20:23], s33 offen offset:3072 sc1
    v_cvt_pk_bf16_f32 v145, v114, v115
    v_exp_f32 v116, v116
    v_exp_f32 v117, v117
    v_exp_f32 v118, v118
    v_exp_f32 v119, v119
    v_cvt_pk_bf16_f32 v146, v116, v117
    v_mfma_f32_32x32x16_bf16 v[128:143], v[172:175], v[20:23], v[128:143]
    s_add_u32 s33, s33, 4096
    buffer_load_dwordx4 a[240:243], v2, s[20:23], s33 offen offset:0 sc1
    v_cvt_pk_bf16_f32 v147, v118, v119
    v_exp_f32 v120, v120
    v_exp_f32 v121, v121
    v_exp_f32 v122, v122
    v_exp_f32 v123, v123
    v_cvt_pk_bf16_f32 v148, v120, v121
    v_mfma_f32_32x32x16_bf16 v[96:111], v[192:195], v[144:147], v[96:111]
    s_waitcnt vmcnt(12)
    v_cvt_pk_bf16_f32 v149, v122, v123
    v_exp_f32 v124, v124
    v_exp_f32 v125, v125
    v_exp_f32 v126, v126
    v_exp_f32 v127, v127
    v_cvt_pk_bf16_f32 v150, v124, v125
    v_cvt_pk_bf16_f32 v151, v126, v127
    v_mfma_f32_32x32x16_bf16 v[112:127], v[176:179], v[24:27], 0
    buffer_load_dwordx4 v[168:171], v2, s[20:23], s31 offen sc1
    buffer_load_dwordx4 v[172:175], v2, s[20:23], s31 offen offset:1024 sc1
    v_exp_f32 v128, v128
    v_exp_f32 v129, v129
    v_exp_f32 v130, v130
    v_exp_f32 v131, v131
    v_cvt_pk_bf16_f32 v152, v128, v129
    v_mfma_f32_32x32x16_bf16 v[96:111], v[196:199], v[148:151], v[96:111]
    v_cvt_pk_bf16_f32 v153, v130, v131
    v_exp_f32 v132, v132
    v_exp_f32 v133, v133
    v_exp_f32 v134, v134
    v_exp_f32 v135, v135
    v_cvt_pk_bf16_f32 v154, v132, v133
    v_mfma_f32_32x32x16_bf16 v[112:127], v[180:183], v[28:31], v[112:127]
    buffer_load_dwordx4 a[244:247], v2, s[20:23], s33 offen offset:1024 sc1
    v_cvt_pk_bf16_f32 v155, v134, v135
    v_exp_f32 v136, v136
    v_exp_f32 v137, v137
    v_exp_f32 v138, v138
    v_exp_f32 v139, v139
    v_cvt_pk_bf16_f32 v156, v136, v137
    v_mfma_f32_32x32x16_bf16 v[48:63], v[192:195], v[152:155], v[48:63]
    v_cvt_pk_bf16_f32 v157, v138, v139
    v_exp_f32 v140, v140
    v_exp_f32 v141, v141
    v_exp_f32 v142, v142
    v_exp_f32 v143, v143
    v_cvt_pk_bf16_f32 v158, v140, v141
    v_cvt_pk_bf16_f32 v159, v142, v143
    v_mfma_f32_32x32x16_bf16 v[128:143], v[176:179], v[32:35], 0
    v_exp_f32 v112, v112
    v_exp_f32 v113, v113
    v_exp_f32 v114, v114
    v_exp_f32 v115, v115
    v_cvt_pk_bf16_f32 v144, v112, v113
    v_mfma_f32_32x32x16_bf16 v[48:63], v[196:199], v[156:159], v[48:63]
    v_cvt_pk_bf16_f32 v145, v114, v115
    v_exp_f32 v116, v116
    v_exp_f32 v117, v117
    v_exp_f32 v118, v118
    v_exp_f32 v119, v119
    v_cvt_pk_bf16_f32 v146, v116, v117
    v_mfma_f32_32x32x16_bf16 v[128:143], v[180:183], v[36:39], v[128:143]
    buffer_load_dwordx4 a[248:251], v2, s[20:23], s33 offen offset:2048 sc1
    v_cvt_pk_bf16_f32 v147, v118, v119
    v_exp_f32 v120, v120
    v_exp_f32 v121, v121
    v_exp_f32 v122, v122
    v_exp_f32 v123, v123
    v_cvt_pk_bf16_f32 v148, v120, v121
    v_mfma_f32_32x32x16_bf16 v[64:79], v[200:203], v[144:147], v[64:79]
    v_cvt_pk_bf16_f32 v149, v122, v123
    v_exp_f32 v124, v124
    v_exp_f32 v125, v125
    v_exp_f32 v126, v126
    v_exp_f32 v127, v127
    v_cvt_pk_bf16_f32 v150, v124, v125
    v_cvt_pk_bf16_f32 v151, v126, v127
    v_mfma_f32_32x32x16_bf16 v[112:127], v[176:179], v[40:43], 0
    buffer_load_dwordx4 v[192:195], v2, s[20:23], s31 offen offset:2048 sc1
    buffer_load_dwordx4 v[196:199], v2, s[20:23], s31 offen offset:3072 sc1
    v_exp_f32 v128, v128
    v_exp_f32 v129, v129
    v_exp_f32 v130, v130
    v_exp_f32 v131, v131
    v_cvt_pk_bf16_f32 v152, v128, v129
    v_mfma_f32_32x32x16_bf16 v[64:79], v[204:207], v[148:151], v[64:79]
    s_xor_b32 s31, s32, 0x38000
    v_cvt_pk_bf16_f32 v153, v130, v131
    v_exp_f32 v132, v132
    v_exp_f32 v133, v133
    v_exp_f32 v134, v134
    v_exp_f32 v135, v135
    v_cvt_pk_bf16_f32 v154, v132, v133
    v_mfma_f32_32x32x16_bf16 v[112:127], v[180:183], v[44:47], v[112:127]
    buffer_load_dwordx4 a[252:255], v2, s[20:23], s33 offen offset:3072 sc1
    v_cvt_pk_bf16_f32 v155, v134, v135
    v_exp_f32 v136, v136
    v_exp_f32 v137, v137
    v_exp_f32 v138, v138
    v_exp_f32 v139, v139
    v_cvt_pk_bf16_f32 v156, v136, v137
    v_mfma_f32_32x32x16_bf16 v[80:95], v[200:203], v[152:155], v[80:95]
    s_add_u32 s33, s33, 4096
    v_cvt_pk_bf16_f32 v157, v138, v139
    v_exp_f32 v140, v140
    v_exp_f32 v141, v141
    v_exp_f32 v142, v142
    v_exp_f32 v143, v143
    v_cvt_pk_bf16_f32 v158, v140, v141
    v_cvt_pk_bf16_f32 v159, v142, v143
    v_mfma_f32_32x32x16_bf16 v[128:143], v[176:179], v[16:19], 0
    v_exp_f32 v112, v112
    v_exp_f32 v113, v113
    v_exp_f32 v114, v114
    v_exp_f32 v115, v115
    v_cvt_pk_bf16_f32 v144, v112, v113
    v_mfma_f32_32x32x16_bf16 v[80:95], v[204:207], v[156:159], v[80:95]
    buffer_load_dwordx4 v[224:227], v2, s[20:23], s33 offen offset:0 sc1
    v_cvt_pk_bf16_f32 v145, v114, v115
    v_exp_f32 v116, v116
    v_exp_f32 v117, v117
    v_exp_f32 v118, v118
    v_exp_f32 v119, v119
    v_cvt_pk_bf16_f32 v146, v116, v117
    v_mfma_f32_32x32x16_bf16 v[128:143], v[180:183], v[20:23], v[128:143]
    buffer_load_dwordx4 v[228:231], v2, s[20:23], s33 offen offset:1024 sc1
    v_cvt_pk_bf16_f32 v147, v118, v119
    v_exp_f32 v120, v120
    v_exp_f32 v121, v121
    v_exp_f32 v122, v122
    v_exp_f32 v123, v123
    v_cvt_pk_bf16_f32 v148, v120, v121
    v_mfma_f32_32x32x16_bf16 v[96:111], v[200:203], v[144:147], v[96:111]
    s_waitcnt vmcnt(12)
    v_cvt_pk_bf16_f32 v149, v122, v123
    v_exp_f32 v124, v124
    v_exp_f32 v125, v125
    v_exp_f32 v126, v126
    v_exp_f32 v127, v127
    v_cvt_pk_bf16_f32 v150, v124, v125
    v_cvt_pk_bf16_f32 v151, v126, v127
    v_mfma_f32_32x32x16_bf16 v[112:127], v[160:163], v[24:27], 0
    buffer_load_dwordx4 v[176:179], v2, s[20:23], s31 offen sc1
    buffer_load_dwordx4 v[180:183], v2, s[20:23], s31 offen offset:1024 sc1
    v_exp_f32 v128, v128
    v_exp_f32 v129, v129
    v_exp_f32 v130, v130
    v_exp_f32 v131, v131
    v_cvt_pk_bf16_f32 v152, v128, v129
    v_mfma_f32_32x32x16_bf16 v[96:111], v[204:207], v[148:151], v[96:111]
    v_cvt_pk_bf16_f32 v153, v130, v131
    v_exp_f32 v132, v132
    v_exp_f32 v133, v133
    v_exp_f32 v134, v134
    v_exp_f32 v135, v135
    v_cvt_pk_bf16_f32 v154, v132, v133
    v_mfma_f32_32x32x16_bf16 v[112:127], v[164:167], v[28:31], v[112:127]
    buffer_load_dwordx4 v[232:235], v2, s[20:23], s33 offen offset:2048 sc1
    v_cvt_pk_bf16_f32 v155, v134, v135
    v_exp_f32 v136, v136
    v_exp_f32 v137, v137
    v_exp_f32 v138, v138
    v_exp_f32 v139, v139
    v_cvt_pk_bf16_f32 v156, v136, v137
    v_mfma_f32_32x32x16_bf16 v[48:63], v[200:203], v[152:155], v[48:63]
    v_cvt_pk_bf16_f32 v157, v138, v139
    v_exp_f32 v140, v140
    v_exp_f32 v141, v141
    v_exp_f32 v142, v142
    v_exp_f32 v143, v143
    v_cvt_pk_bf16_f32 v158, v140, v141
    v_cvt_pk_bf16_f32 v159, v142, v143
    v_mfma_f32_32x32x16_bf16 v[128:143], v[160:163], v[32:35], 0
    v_exp_f32 v112, v112
    v_exp_f32 v113, v113
    v_exp_f32 v114, v114
    v_exp_f32 v115, v115
    v_cvt_pk_bf16_f32 v144, v112, v113
    v_mfma_f32_32x32x16_bf16 v[48:63], v[204:207], v[156:159], v[48:63]
    v_cvt_pk_bf16_f32 v145, v114, v115
    v_exp_f32 v116, v116
    v_exp_f32 v117, v117
    v_exp_f32 v118, v118
    v_exp_f32 v119, v119
    v_cvt_pk_bf16_f32 v146, v116, v117
    v_mfma_f32_32x32x16_bf16 v[128:143], v[164:167], v[36:39], v[128:143]
    buffer_load_dwordx4 v[236:239], v2, s[20:23], s33 offen offset:3072 sc1
    v_cvt_pk_bf16_f32 v147, v118, v119
    v_exp_f32 v120, v120
    v_exp_f32 v121, v121
    v_exp_f32 v122, v122
    v_exp_f32 v123, v123
    v_cvt_pk_bf16_f32 v148, v120, v121
    v_mfma_f32_32x32x16_bf16 v[64:79], v[184:187], v[144:147], v[64:79]
    s_add_u32 s33, s33, 4096
    v_cvt_pk_bf16_f32 v149, v122, v123
    v_exp_f32 v124, v124
    v_exp_f32 v125, v125
    v_exp_f32 v126, v126
    v_exp_f32 v127, v127
    v_cvt_pk_bf16_f32 v150, v124, v125
    v_cvt_pk_bf16_f32 v151, v126, v127
    v_mfma_f32_32x32x16_bf16 v[112:127], v[160:163], v[40:43], 0
    buffer_load_dwordx4 v[200:203], v2, s[20:23], s31 offen offset:2048 sc1
    buffer_load_dwordx4 v[204:207], v2, s[20:23], s31 offen offset:3072 sc1
    v_exp_f32 v128, v128
    v_exp_f32 v129, v129
    v_exp_f32 v130, v130
    v_exp_f32 v131, v131
    v_cvt_pk_bf16_f32 v152, v128, v129
    v_mfma_f32_32x32x16_bf16 v[64:79], v[188:191], v[148:151], v[64:79]
    s_xor_b32 s31, s32, 0x3c000
    v_cvt_pk_bf16_f32 v153, v130, v131
    v_exp_f32 v132, v132
    v_exp_f32 v133, v133
    v_exp_f32 v134, v134
    v_exp_f32 v135, v135
    v_cvt_pk_bf16_f32 v154, v132, v133
    v_mfma_f32_32x32x16_bf16 v[112:127], v[164:167], v[44:47], v[112:127]
    buffer_load_dwordx4 v[240:243], v2, s[20:23], s33 offen offset:0 sc1
    v_cvt_pk_bf16_f32 v155, v134, v135
    v_exp_f32 v136, v136
    v_exp_f32 v137, v137
    v_exp_f32 v138, v138
    v_exp_f32 v139, v139
    v_cvt_pk_bf16_f32 v156, v136, v137
    v_mfma_f32_32x32x16_bf16 v[80:95], v[184:187], v[152:155], v[80:95]
    v_cvt_pk_bf16_f32 v157, v138, v139
    v_exp_f32 v140, v140
    v_exp_f32 v141, v141
    v_exp_f32 v142, v142
    v_exp_f32 v143, v143
    v_cvt_pk_bf16_f32 v158, v140, v141
    v_cvt_pk_bf16_f32 v159, v142, v143
    v_mfma_f32_32x32x16_bf16 v[128:143], v[160:163], v[16:19], 0
    v_exp_f32 v112, v112
    v_exp_f32 v113, v113
    v_exp_f32 v114, v114
    v_exp_f32 v115, v115
    v_cvt_pk_bf16_f32 v144, v112, v113
    v_mfma_f32_32x32x16_bf16 v[80:95], v[188:191], v[156:159], v[80:95]
    v_cvt_pk_bf16_f32 v145, v114, v115
    v_exp_f32 v116, v116
    v_exp_f32 v117, v117
    v_exp_f32 v118, v118
    v_exp_f32 v119, v119
    v_cvt_pk_bf16_f32 v146, v116, v117
    v_mfma_f32_32x32x16_bf16 v[128:143], v[164:167], v[20:23], v[128:143]
    buffer_load_dwordx4 v[244:247], v2, s[20:23], s33 offen offset:1024 sc1
    v_cvt_pk_bf16_f32 v147, v118, v119
    v_exp_f32 v120, v120
    v_exp_f32 v121, v121
    v_exp_f32 v122, v122
    v_exp_f32 v123, v123
    v_cvt_pk_bf16_f32 v148, v120, v121
    v_mfma_f32_32x32x16_bf16 v[96:111], v[184:187], v[144:147], v[96:111]
    s_waitcnt vmcnt(11)
    v_cvt_pk_bf16_f32 v149, v122, v123
    v_exp_f32 v124, v124
    v_exp_f32 v125, v125
    v_exp_f32 v126, v126
    v_exp_f32 v127, v127
    v_cvt_pk_bf16_f32 v150, v124, v125
    v_cvt_pk_bf16_f32 v151, v126, v127
    v_mfma_f32_32x32x16_bf16 v[112:127], v[168:171], v[24:27], 0
    buffer_load_dwordx4 v[160:163], v2, s[20:23], s31 offen sc1
    buffer_load_dwordx4 v[164:167], v2, s[20:23], s31 offen offset:1024 sc1
    v_exp_f32 v128, v128
    v_exp_f32 v129, v129
    v_exp_f32 v130, v130
    v_exp_f32 v131, v131
    v_cvt_pk_bf16_f32 v152, v128, v129
    v_mfma_f32_32x32x16_bf16 v[96:111], v[188:191], v[148:151], v[96:111]
    buffer_load_dwordx4 v[248:251], v2, s[20:23], s33 offen offset:2048 sc1
    v_cvt_pk_bf16_f32 v153, v130, v131
    v_exp_f32 v132, v132
    v_exp_f32 v133, v133
    v_exp_f32 v134, v134
    v_exp_f32 v135, v135
    v_cvt_pk_bf16_f32 v154, v132, v133
    v_mfma_f32_32x32x16_bf16 v[112:127], v[172:175], v[28:31], v[112:127]
    buffer_load_dwordx4 v[252:255], v2, s[20:23], s33 offen offset:3072 sc1
    v_cvt_pk_bf16_f32 v155, v134, v135
    v_exp_f32 v136, v136
    v_exp_f32 v137, v137
    v_exp_f32 v138, v138
    v_exp_f32 v139, v139
    v_cvt_pk_bf16_f32 v156, v136, v137
    v_mfma_f32_32x32x16_bf16 v[48:63], v[184:187], v[152:155], v[48:63]
    s_add_u32 s33, s33, 4096
    v_cvt_pk_bf16_f32 v157, v138, v139
    v_exp_f32 v140, v140
    v_exp_f32 v141, v141
    v_exp_f32 v142, v142
    v_exp_f32 v143, v143
    v_cvt_pk_bf16_f32 v158, v140, v141
    v_cvt_pk_bf16_f32 v159, v142, v143
    v_mfma_f32_32x32x16_bf16 v[128:143], v[168:171], v[32:35], 0
    v_exp_f32 v112, v112
    v_exp_f32 v113, v113
    v_exp_f32 v114, v114
    v_exp_f32 v115, v115
    v_cvt_pk_bf16_f32 v144, v112, v113
    v_mfma_f32_32x32x16_bf16 v[48:63], v[188:191], v[156:159], v[48:63]
    v_cvt_pk_bf16_f32 v145, v114, v115
    v_exp_f32 v116, v116
    v_exp_f32 v117, v117
    v_exp_f32 v118, v118
    v_exp_f32 v119, v119
    v_cvt_pk_bf16_f32 v146, v116, v117
    v_mfma_f32_32x32x16_bf16 v[128:143], v[172:175], v[36:39], v[128:143]
    buffer_load_dwordx4 v2, s[20:23], s34 offen offset:0 sc1 lds
    v_cvt_pk_bf16_f32 v147, v118, v119
    v_exp_f32 v120, v120
    v_exp_f32 v121, v121
    v_exp_f32 v122, v122
    v_exp_f32 v123, v123
    v_cvt_pk_bf16_f32 v148, v120, v121
    v_mfma_f32_32x32x16_bf16 v[64:79], v[192:195], v[144:147], v[64:79]
    v_cvt_pk_bf16_f32 v149, v122, v123
    v_exp_f32 v124, v124
    v_exp_f32 v125, v125
    v_exp_f32 v126, v126
    v_exp_f32 v127, v127
    v_cvt_pk_bf16_f32 v150, v124, v125
    v_cvt_pk_bf16_f32 v151, v126, v127
    v_mfma_f32_32x32x16_bf16 v[112:127], v[168:171], v[40:43], 0
    buffer_load_dwordx4 v[184:187], v2, s[20:23], s31 offen offset:2048 sc1
    buffer_load_dwordx4 v[188:191], v2, s[20:23], s31 offen offset:3072 sc1
    v_exp_f32 v128, v128
    v_exp_f32 v129, v129
    v_exp_f32 v130, v130
    v_exp_f32 v131, v131
    v_cvt_pk_bf16_f32 v152, v128, v129
    v_mfma_f32_32x32x16_bf16 v[64:79], v[196:199], v[148:151], v[64:79]
    s_xor_b32 s31, s32, 0x40000
    v_cvt_pk_bf16_f32 v153, v130, v131
    v_exp_f32 v132, v132
    v_exp_f32 v133, v133
    v_exp_f32 v134, v134
    v_exp_f32 v135, v135
    v_cvt_pk_bf16_f32 v154, v132, v133
    v_mfma_f32_32x32x16_bf16 v[112:127], v[172:175], v[44:47], v[112:127]
    buffer_load_dwordx4 v2, s[20:23], s34 offen offset:1024 sc1 lds
    v_cvt_pk_bf16_f32 v155, v134, v135
    v_exp_f32 v136, v136
    v_exp_f32 v137, v137
    v_exp_f32 v138, v138
    v_exp_f32 v139, v139
    v_cvt_pk_bf16_f32 v156, v136, v137
    v_mfma_f32_32x32x16_bf16 v[80:95], v[192:195], v[152:155], v[80:95]
    v_cvt_pk_bf16_f32 v157, v138, v139
    v_exp_f32 v140, v140
    v_exp_f32 v141, v141
    v_exp_f32 v142, v142
    v_exp_f32 v143, v143
    v_cvt_pk_bf16_f32 v158, v140, v141
    v_cvt_pk_bf16_f32 v159, v142, v143
    v_mfma_f32_32x32x16_bf16 v[128:143], v[168:171], v[16:19], 0
    v_exp_f32 v112, v112
    v_exp_f32 v113, v113
    v_exp_f32 v114, v114
    v_exp_f32 v115, v115
    v_cvt_pk_bf16_f32 v144, v112, v113
    v_mfma_f32_32x32x16_bf16 v[80:95], v[196:199], v[156:159], v[80:95]
    v_cvt_pk_bf16_f32 v145, v114, v115
    v_exp_f32 v116, v116
    v_exp_f32 v117, v117
    v_exp_f32 v118, v118
    v_exp_f32 v119, v119
    v_cvt_pk_bf16_f32 v146, v116, v117
    v_mfma_f32_32x32x16_bf16 v[128:143], v[172:175], v[20:23], v[128:143]
    buffer_load_dwordx4 v2, s[20:23], s34 offen offset:2048 sc1 lds
    v_cvt_pk_bf16_f32 v147, v118, v119
    v_exp_f32 v120, v120
    v_exp_f32 v121, v121
    v_exp_f32 v122, v122
    v_exp_f32 v123, v123
    v_cvt_pk_bf16_f32 v148, v120, v121
    v_mfma_f32_32x32x16_bf16 v[96:111], v[192:195], v[144:147], v[96:111]
    s_waitcnt vmcnt(11)
    v_cvt_pk_bf16_f32 v149, v122, v123
    v_exp_f32 v124, v124
    v_exp_f32 v125, v125
    v_exp_f32 v126, v126
    v_exp_f32 v127, v127
    v_cvt_pk_bf16_f32 v150, v124, v125
    v_cvt_pk_bf16_f32 v151, v126, v127
    v_mfma_f32_32x32x16_bf16 v[112:127], v[176:179], v[24:27], 0
    v_exp_f32 v128, v128
    v_exp_f32 v129, v129
    v_exp_f32 v130, v130
    v_exp_f32 v131, v131
    v_cvt_pk_bf16_f32 v152, v128, v129
    v_mfma_f32_32x32x16_bf16 v[96:111], v[196:199], v[148:151], v[96:111]
    buffer_load_dwordx4 v2, s[20:23], s34 offen offset:3072 sc1 lds
    v_cvt_pk_bf16_f32 v153, v130, v131
    v_exp_f32 v132, v132
    v_exp_f32 v133, v133
    v_exp_f32 v134, v134
    v_exp_f32 v135, v135
    v_cvt_pk_bf16_f32 v154, v132, v133
    v_mfma_f32_32x32x16_bf16 v[112:127], v[180:183], v[28:31], v[112:127]
    buffer_load_dwordx4 v[168:171], v2, s[20:23], s33 offen offset:0 sc1
    v_cvt_pk_bf16_f32 v155, v134, v135
    v_exp_f32 v136, v136
    v_exp_f32 v137, v137
    v_exp_f32 v138, v138
    v_exp_f32 v139, v139
    v_cvt_pk_bf16_f32 v156, v136, v137
    v_mfma_f32_32x32x16_bf16 v[48:63], v[192:195], v[152:155], v[48:63]
    s_add_u32 m0, m0, 16384
    v_cvt_pk_bf16_f32 v157, v138, v139
    v_exp_f32 v140, v140
    v_exp_f32 v141, v141
    v_exp_f32 v142, v142
    v_exp_f32 v143, v143
    v_cvt_pk_bf16_f32 v158, v140, v141
    v_cvt_pk_bf16_f32 v159, v142, v143
    v_mfma_f32_32x32x16_bf16 v[128:143], v[176:179], v[32:35], 0
    s_add_u32 s34, s34, 16384
    v_exp_f32 v112, v112
    v_exp_f32 v113, v113
    v_exp_f32 v114, v114
    v_exp_f32 v115, v115
    v_cvt_pk_bf16_f32 v144, v112, v113
    v_mfma_f32_32x32x16_bf16 v[48:63], v[196:199], v[156:159], v[48:63]
    v_cvt_pk_bf16_f32 v145, v114, v115
    v_exp_f32 v116, v116
    v_exp_f32 v117, v117
    v_exp_f32 v118, v118
    v_exp_f32 v119, v119
    v_cvt_pk_bf16_f32 v146, v116, v117
    v_mfma_f32_32x32x16_bf16 v[128:143], v[180:183], v[36:39], v[128:143]
    buffer_load_dwordx4 v[172:175], v2, s[20:23], s33 offen offset:1024 sc1
    v_cvt_pk_bf16_f32 v147, v118, v119
    v_exp_f32 v120, v120
    v_exp_f32 v121, v121
    v_exp_f32 v122, v122
    v_exp_f32 v123, v123
    v_cvt_pk_bf16_f32 v148, v120, v121
    v_mfma_f32_32x32x16_bf16 v[64:79], v[200:203], v[144:147], v[64:79]
    v_cvt_pk_bf16_f32 v149, v122, v123
    v_exp_f32 v124, v124
    v_exp_f32 v125, v125
    v_exp_f32 v126, v126
    v_exp_f32 v127, v127
    v_cvt_pk_bf16_f32 v150, v124, v125
    v_cvt_pk_bf16_f32 v151, v126, v127
    v_mfma_f32_32x32x16_bf16 v[112:127], v[176:179], v[40:43], 0
    v_exp_f32 v128, v128
    v_exp_f32 v129, v129
    v_exp_f32 v130, v130
    v_exp_f32 v131, v131
    v_cvt_pk_bf16_f32 v152, v128, v129
    v_mfma_f32_32x32x16_bf16 v[64:79], v[204:207], v[148:151], v[64:79]
    v_cvt_pk_bf16_f32 v153, v130, v131
    v_exp_f32 v132, v132
    v_exp_f32 v133, v133
    v_exp_f32 v134, v134
    v_exp_f32 v135, v135
    v_cvt_pk_bf16_f32 v154, v132, v133
    v_mfma_f32_32x32x16_bf16 v[112:127], v[180:183], v[44:47], v[112:127]
    buffer_load_dwordx4 v[192:195], v2, s[20:23], s33 offen offset:2048 sc1
    v_cvt_pk_bf16_f32 v155, v134, v135
    v_exp_f32 v136, v136
    v_exp_f32 v137, v137
    v_exp_f32 v138, v138
    v_exp_f32 v139, v139
    v_cvt_pk_bf16_f32 v156, v136, v137
    v_mfma_f32_32x32x16_bf16 v[80:95], v[200:203], v[152:155], v[80:95]
    v_cvt_pk_bf16_f32 v157, v138, v139
    v_exp_f32 v140, v140
    v_exp_f32 v141, v141
    v_exp_f32 v142, v142
    v_exp_f32 v143, v143
    v_cvt_pk_bf16_f32 v158, v140, v141
    v_cvt_pk_bf16_f32 v159, v142, v143
    v_mfma_f32_32x32x16_bf16 v[128:143], v[176:179], v[16:19], 0
    v_exp_f32 v112, v112
    v_exp_f32 v113, v113
    v_exp_f32 v114, v114
    v_exp_f32 v115, v115
    v_cvt_pk_bf16_f32 v144, v112, v113
    v_mfma_f32_32x32x16_bf16 v[80:95], v[204:207], v[156:159], v[80:95]
    v_cvt_pk_bf16_f32 v145, v114, v115
    v_exp_f32 v116, v116
    v_exp_f32 v117, v117
    v_exp_f32 v118, v118
    v_exp_f32 v119, v119
    v_cvt_pk_bf16_f32 v146, v116, v117
    v_mfma_f32_32x32x16_bf16 v[128:143], v[180:183], v[20:23], v[128:143]
    buffer_load_dwordx4 v[196:199], v2, s[20:23], s33 offen offset:3072 sc1
    v_cvt_pk_bf16_f32 v147, v118, v119
    v_exp_f32 v120, v120
    v_exp_f32 v121, v121
    v_exp_f32 v122, v122
    v_exp_f32 v123, v123
    v_cvt_pk_bf16_f32 v148, v120, v121
    v_mfma_f32_32x32x16_bf16 v[96:111], v[200:203], v[144:147], v[96:111]
    s_waitcnt vmcnt(7)
    v_cvt_pk_bf16_f32 v149, v122, v123
    v_exp_f32 v124, v124
    v_exp_f32 v125, v125
    v_exp_f32 v126, v126
    v_exp_f32 v127, v127
    v_cvt_pk_bf16_f32 v150, v124, v125
    v_cvt_pk_bf16_f32 v151, v126, v127
    v_mfma_f32_32x32x16_bf16 v[112:127], v[160:163], v[24:27], 0
    s_add_u32 s33, s33, 4096
    v_exp_f32 v128, v128
    v_exp_f32 v129, v129
    v_exp_f32 v130, v130
    v_exp_f32 v131, v131
    v_cvt_pk_bf16_f32 v152, v128, v129
    v_mfma_f32_32x32x16_bf16 v[96:111], v[204:207], v[148:151], v[96:111]
    buffer_load_dwordx4 v[176:179], v2, s[20:23], s33 offen offset:0 sc1
    v_cvt_pk_bf16_f32 v153, v130, v131
    v_exp_f32 v132, v132
    v_exp_f32 v133, v133
    v_exp_f32 v134, v134
    v_exp_f32 v135, v135
    v_cvt_pk_bf16_f32 v154, v132, v133
    v_mfma_f32_32x32x16_bf16 v[112:127], v[164:167], v[28:31], v[112:127]
    buffer_load_dwordx4 v[180:183], v2, s[20:23], s33 offen offset:1024 sc1
    v_cvt_pk_bf16_f32 v155, v134, v135
    v_exp_f32 v136, v136
    v_exp_f32 v137, v137
    v_exp_f32 v138, v138
    v_exp_f32 v139, v139
    v_cvt_pk_bf16_f32 v156, v136, v137
    v_mfma_f32_32x32x16_bf16 v[48:63], v[200:203], v[152:155], v[48:63]
    v_cvt_pk_bf16_f32 v157, v138, v139
    v_exp_f32 v140, v140
    v_exp_f32 v141, v141
    v_exp_f32 v142, v142
    v_exp_f32 v143, v143
    v_cvt_pk_bf16_f32 v158, v140, v141
    v_cvt_pk_bf16_f32 v159, v142, v143
    v_mfma_f32_32x32x16_bf16 v[128:143], v[160:163], v[32:35], 0
    v_exp_f32 v112, v112
    v_exp_f32 v113, v113
    v_exp_f32 v114, v114
    v_exp_f32 v115, v115
    v_cvt_pk_bf16_f32 v144, v112, v113
    v_mfma_f32_32x32x16_bf16 v[48:63], v[204:207], v[156:159], v[48:63]
    v_cvt_pk_bf16_f32 v145, v114, v115
    v_exp_f32 v116, v116
    v_exp_f32 v117, v117
    v_exp_f32 v118, v118
    v_exp_f32 v119, v119
    v_cvt_pk_bf16_f32 v146, v116, v117
    v_mfma_f32_32x32x16_bf16 v[128:143], v[164:167], v[36:39], v[128:143]
    v_cvt_pk_bf16_f32 v147, v118, v119
    v_exp_f32 v120, v120
    v_exp_f32 v121, v121
    v_exp_f32 v122, v122
    v_exp_f32 v123, v123
    v_cvt_pk_bf16_f32 v148, v120, v121
    v_mfma_f32_32x32x16_bf16 v[64:79], v[184:187], v[144:147], v[64:79]
    v_cvt_pk_bf16_f32 v149, v122, v123
    v_exp_f32 v124, v124
    v_exp_f32 v125, v125
    v_exp_f32 v126, v126
    v_exp_f32 v127, v127
    v_cvt_pk_bf16_f32 v150, v124, v125
    v_cvt_pk_bf16_f32 v151, v126, v127
    v_mfma_f32_32x32x16_bf16 v[112:127], v[160:163], v[40:43], 0
    v_exp_f32 v128, v128
    v_exp_f32 v129, v129
    v_exp_f32 v130, v130
    v_exp_f32 v131, v131
    v_cvt_pk_bf16_f32 v152, v128, v129
    v_mfma_f32_32x32x16_bf16 v[64:79], v[188:191], v[148:151], v[64:79]
    v_cvt_pk_bf16_f32 v153, v130, v131
    v_exp_f32 v132, v132
    v_exp_f32 v133, v133
    v_exp_f32 v134, v134
    v_exp_f32 v135, v135
    v_cvt_pk_bf16_f32 v154, v132, v133
    v_mfma_f32_32x32x16_bf16 v[112:127], v[164:167], v[44:47], v[112:127]
    buffer_load_dwordx4 v[200:203], v2, s[20:23], s33 offen offset:2048 sc1
    v_cvt_pk_bf16_f32 v155, v134, v135
    v_exp_f32 v136, v136
    v_exp_f32 v137, v137
    v_exp_f32 v138, v138
    v_exp_f32 v139, v139
    v_cvt_pk_bf16_f32 v156, v136, v137
    v_mfma_f32_32x32x16_bf16 v[80:95], v[184:187], v[152:155], v[80:95]
    ds_write_b128 v12, v[64:67] offset:0
    ds_write_b128 v12, v[68:71] offset:1024
    ds_write_b128 v12, v[72:75] offset:2048
    ds_write_b128 v12, v[76:79] offset:3072
    v_cvt_pk_bf16_f32 v157, v138, v139
    v_exp_f32 v140, v140
    v_exp_f32 v141, v141
    v_exp_f32 v142, v142
    v_exp_f32 v143, v143
    v_cvt_pk_bf16_f32 v158, v140, v141
    v_cvt_pk_bf16_f32 v159, v142, v143
    v_mfma_f32_32x32x16_bf16 v[128:143], v[160:163], v[16:19], 0
    v_exp_f32 v112, v112
    v_exp_f32 v113, v113
    v_exp_f32 v114, v114
    v_exp_f32 v115, v115
    v_cvt_pk_bf16_f32 v144, v112, v113
    v_mfma_f32_32x32x16_bf16 v[80:95], v[188:191], v[156:159], v[80:95]
    v_cvt_pk_bf16_f32 v145, v114, v115
    v_exp_f32 v116, v116
    v_exp_f32 v117, v117
    v_exp_f32 v118, v118
    v_exp_f32 v119, v119
    v_cvt_pk_bf16_f32 v146, v116, v117
    v_mfma_f32_32x32x16_bf16 v[128:143], v[164:167], v[20:23], v[128:143]
    buffer_load_dwordx4 v[204:207], v2, s[20:23], s33 offen offset:3072 sc1
    v_cvt_pk_bf16_f32 v147, v118, v119
    v_exp_f32 v120, v120
    v_exp_f32 v121, v121
    v_exp_f32 v122, v122
    v_exp_f32 v123, v123
    v_cvt_pk_bf16_f32 v148, v120, v121
    v_mfma_f32_32x32x16_bf16 v[96:111], v[184:187], v[144:147], v[96:111]
    s_add_u32 s33, s33, 4096
    ds_write_b128 v13, v[80:83] offset:0
    ds_write_b128 v13, v[84:87] offset:1024
    ds_write_b128 v13, v[88:91] offset:2048
    ds_write_b128 v13, v[92:95] offset:3072
    v_cvt_pk_bf16_f32 v149, v122, v123
    v_exp_f32 v124, v124
    v_exp_f32 v125, v125
    v_exp_f32 v126, v126
    v_exp_f32 v127, v127
    v_cvt_pk_bf16_f32 v150, v124, v125
    v_cvt_pk_bf16_f32 v151, v126, v127
    v_exp_f32 v128, v128
    v_exp_f32 v129, v129
    v_exp_f32 v130, v130
    v_exp_f32 v131, v131
    v_cvt_pk_bf16_f32 v152, v128, v129
    v_mfma_f32_32x32x16_bf16 v[96:111], v[188:191], v[148:151], v[96:111]
    buffer_load_dwordx4 v[160:163], v2, s[20:23], s33 offen offset:0 sc1
    v_cvt_pk_bf16_f32 v153, v130, v131
    v_exp_f32 v132, v132
    v_exp_f32 v133, v133
    v_exp_f32 v134, v134
    v_exp_f32 v135, v135
    v_cvt_pk_bf16_f32 v154, v132, v133
    buffer_load_dwordx4 v[164:167], v2, s[20:23], s33 offen offset:1024 sc1
    v_cvt_pk_bf16_f32 v155, v134, v135
    v_exp_f32 v136, v136
    v_exp_f32 v137, v137
    v_exp_f32 v138, v138
    v_exp_f32 v139, v139
    v_cvt_pk_bf16_f32 v156, v136, v137
    s_nop 0
    v_mfma_f32_32x32x16_bf16 v[48:63], v[184:187], v[152:155], v[48:63]
    ds_write_b128 v14, v[96:99] offset:0
    ds_write_b128 v14, v[100:103] offset:1024
    ds_write_b128 v14, v[104:107] offset:2048
    ds_write_b128 v14, v[108:111] offset:3072
    v_cvt_pk_bf16_f32 v157, v138, v139
    v_exp_f32 v140, v140
    v_exp_f32 v141, v141
    v_exp_f32 v142, v142
    v_exp_f32 v143, v143
    v_cvt_pk_bf16_f32 v158, v140, v141
    v_cvt_pk_bf16_f32 v159, v142, v143
    s_waitcnt lgkmcnt(0)
    s_barrier
    v_mfma_f32_32x32x16_bf16 v[48:63], v[188:191], v[156:159], v[48:63]
    ds_read_b128 v[64:67], v11 offset:0
    ds_read_b128 v[68:71], v11 offset:1024
    ds_read_b128 v[72:75], v11 offset:2048
    ds_read_b128 v[76:79], v11 offset:3072
    ds_read_b128 v[80:83], v11 offset:4096
    ds_read_b128 v[84:87], v11 offset:5120
    ds_read_b128 v[88:91], v11 offset:6144
    ds_read_b128 v[92:95], v11 offset:7168
    ds_read_b128 v[96:99], v11 offset:8192
    ds_read_b128 v[100:103], v11 offset:9216
    ds_read_b128 v[104:107], v11 offset:10240
    ds_read_b128 v[108:111], v11 offset:11264
    buffer_load_dwordx4 v[184:187], v2, s[20:23], s33 offen offset:2048 sc1
    buffer_load_dwordx4 v[188:191], v2, s[20:23], s33 offen offset:3072 sc1
    s_add_u32 s33, s33, 4096
    buffer_load_dwordx4 v[112:115], v2, s[20:23], s33 offen offset:0 sc1
    buffer_load_dwordx4 v[116:119], v2, s[20:23], s33 offen offset:1024 sc1
    s_mov_b32 s38, 0x5d800000
    s_mov_b32 s39, 0x21800000
    s_lshl_b32 s37, s16, 2
    s_add_u32 s37, s37, 56704
    s_waitcnt lgkmcnt(8)
    v_pk_add_f32 v[60:61], v[60:61], v[76:77]
    v_pk_add_f32 v[62:63], v[62:63], v[78:79]
    v_pk_add_f32 v[48:49], v[48:49], v[64:65]
    v_pk_add_f32 v[50:51], v[50:51], v[66:67]
    v_pk_add_f32 v[52:53], v[52:53], v[68:69]
    v_pk_add_f32 v[54:55], v[54:55], v[70:71]
    v_pk_add_f32 v[56:57], v[56:57], v[72:73]
    v_pk_add_f32 v[58:59], v[58:59], v[74:75]
    s_waitcnt lgkmcnt(4)
    v_pk_add_f32 v[60:61], v[60:61], v[92:93]
    v_pk_add_f32 v[62:63], v[62:63], v[94:95]
    v_pk_add_f32 v[48:49], v[48:49], v[80:81]
    v_pk_add_f32 v[50:51], v[50:51], v[82:83]
    v_pk_add_f32 v[52:53], v[52:53], v[84:85]
    v_pk_add_f32 v[54:55], v[54:55], v[86:87]
    v_pk_add_f32 v[56:57], v[56:57], v[88:89]
    v_pk_add_f32 v[58:59], v[58:59], v[90:91]
    s_waitcnt lgkmcnt(0)
    v_pk_add_f32 v[60:61], v[60:61], v[108:109]
    v_pk_add_f32 v[62:63], v[62:63], v[110:111]
    v_mov_b32 v12, v60
    v_mov_b32 v13, v60
    v_pk_add_f32 v[48:49], v[48:49], v[96:97]
    v_pk_add_f32 v[50:51], v[50:51], v[98:99]
    v_permlane32_swap_b32 v12, v13
    v_pk_add_f32 v[52:53], v[52:53], v[100:101]
    v_rcp_f32 v12, v13
    v_cmp_nge_f32 vcc, s38, v13
    v_cmp_nle_f32 s[40:41], s39, v13
    v_pk_add_f32 v[54:55], v[54:55], v[102:103]
    v_pk_add_f32 v[56:57], v[56:57], v[104:105]
    v_pk_add_f32 v[58:59], v[58:59], v[106:107]
    v_mov_b32 v13, v12
    s_or_b64 vcc, vcc, s[40:41]
    s_cselect_b32 s39, 1, 0
    v_pk_mul_f32 v[48:49], v[48:49], v[12:13]
    v_pk_mul_f32 v[50:51], v[50:51], v[12:13]
    v_cvt_pk_bf16_f32 v64, v48, v49
    v_cvt_pk_bf16_f32 v65, v50, v51
    ds_write_b64 v4, v[64:65] offset:0
    v_pk_mul_f32 v[52:53], v[52:53], v[12:13]
    v_pk_mul_f32 v[54:55], v[54:55], v[12:13]
    v_cvt_pk_bf16_f32 v66, v52, v53
    v_cvt_pk_bf16_f32 v67, v54, v55
    ds_write_b64 v4, v[66:67] offset:16
    v_pk_mul_f32 v[56:57], v[56:57], v[12:13]
    v_pk_mul_f32 v[58:59], v[58:59], v[12:13]
    v_cvt_pk_bf16_f32 v68, v56, v57
    v_cvt_pk_bf16_f32 v69, v58, v59
    ds_write_b64 v4, v[68:69] offset:32
    v_pk_mul_f32 v[60:61], v[60:61], v[12:13]
    v_pk_mul_f32 v[62:63], v[62:63], v[12:13]
    v_cvt_pk_bf16_f32 v70, v60, v61
    v_cvt_pk_bf16_f32 v71, v62, v63
    s_mov_b32 exec_hi, 0
    ds_write_b64 v4, v[70:71] offset:48
    s_mov_b32 exec_hi, -1
    v_mov_b32 v15, s37
    v_mov_b32 v14, s39
    ds_write_b32 v15, v14
    v_mov_b32 v15, 56704
    v_lshlrev_b32 v84, 16, v208
    v_and_b32 v85, 0xffff0000, v208
    v_lshlrev_b32 v86, 16, v209
    v_and_b32 v87, 0xffff0000, v209
    v_lshlrev_b32 v88, 16, v210
    v_and_b32 v89, 0xffff0000, v210
    v_lshlrev_b32 v90, 16, v211
    v_and_b32 v91, 0xffff0000, v211
    buffer_load_dwordx4 v[120:123], v2, s[20:23], s33 offen offset:2048 sc1
    buffer_load_dwordx4 v[124:127], v2, s[20:23], s33 offen offset:3072 sc1
    s_add_u32 s33, s33, 4096
    s_waitcnt lgkmcnt(0)
    s_barrier
    ds_read_b128 v[12:15], v15
    ds_read_b128 v[48:51], v5 offset:49152
    ds_read_b128 v[52:55], v5 offset:49216
    ds_read_b128 v[56:59], v5 offset:49280
    ds_read_b128 v[60:63], v5 offset:49344
    ds_read_b128 v[64:67], v5 offset:49408
    ds_read_b128 v[68:71], v5 offset:49472
    ds_read_b128 v[72:75], v5 offset:49536
    ds_read_b128 v[76:79], v5 offset:49600
    ds_read_b128 v[80:83], v5 offset:49664
    ds_read_b128 v[24:27], v5 offset:49728
    ds_read_b128 v[28:31], v5 offset:49792
    ds_read_b128 v[32:35], v5 offset:49856
    ds_read_b128 v[36:39], v5 offset:49920
    ds_read_b128 v[40:43], v5 offset:49984
    v_lshlrev_b32 v92, 16, v212
    v_and_b32 v93, 0xffff0000, v212
    v_lshlrev_b32 v94, 16, v213
    v_and_b32 v95, 0xffff0000, v213
    buffer_load_dwordx4 v[128:131], v2, s[20:23], s33 offen offset:0 sc1
    v_lshlrev_b32 v96, 16, v214
    v_and_b32 v97, 0xffff0000, v214
    v_lshlrev_b32 v98, 16, v215
    v_and_b32 v99, 0xffff0000, v215
    buffer_load_dwordx4 v[132:135], v2, s[20:23], s33 offen offset:1024 sc1
    v_lshlrev_b32 v100, 16, v216
    v_and_b32 v101, 0xffff0000, v216
    v_lshlrev_b32 v102, 16, v217
    v_and_b32 v103, 0xffff0000, v217
    buffer_load_dwordx4 v[136:139], v2, s[20:23], s33 offen offset:2048 sc1
    v_lshlrev_b32 v104, 16, v218
    v_and_b32 v105, 0xffff0000, v218
    v_lshlrev_b32 v106, 16, v219
    v_and_b32 v107, 0xffff0000, v219
    v_lshlrev_b32 v108, 16, v220
    v_and_b32 v109, 0xffff0000, v220
    v_lshlrev_b32 v110, 16, v221
    v_and_b32 v111, 0xffff0000, v221
    s_waitcnt lgkmcnt(14)
    v_or3_b32 v12, v12, v13, v14
    v_or_b32 v12, v12, v15
    s_mul_i32 s34, s19, 118784
    v_readfirstlane_b32 s39, v12
    s_mul_i32 s35, s16, 5120
    s_add_u32 s34, s34, s35
    s_add_u32 s34, s34, 0x418000
    s_mov_b32 m0, s35
    s_andn2_b32 s39, s39, s36
    s_cmp_lg_u32 s39, 0
    s_cbranch_scc1 K_att43_fallback
    s_waitcnt lgkmcnt(13)
    v_mfma_f32_16x16x32_bf16 v[84:87], a[0:3], v[48:51], v[84:87]
    s_and_b32 s37, s18, 1
    s_lshl_b32 s44, s17, 1
    s_waitcnt lgkmcnt(12)
    v_mfma_f32_16x16x32_bf16 v[84:87], a[4:7], v[52:55], v[84:87]
    buffer_load_dwordx4 v[140:143], v2, s[20:23], s33 offen offset:3072 sc1
    s_add_u32 s33, s33, 4096
    s_waitcnt lgkmcnt(11)
    v_mfma_f32_16x16x32_bf16 v[84:87], a[8:11], v[56:59], v[84:87]
    s_add_u32 s44, s44, s37
    s_lshl_b32 s44, s44, 1
    s_waitcnt lgkmcnt(10)
    v_mfma_f32_16x16x32_bf16 v[84:87], a[12:15], v[60:63], v[84:87]
    s_lshr_b32 s37, s16, 1
    s_add_u32 s44, s44, s37
    s_waitcnt lgkmcnt(9)
    v_mfma_f32_16x16x32_bf16 v[84:87], a[16:19], v[64:67], v[84:87]
    buffer_load_dwordx4 v[144:147], v2, s[20:23], s33 offen offset:0 sc1
    s_waitcnt lgkmcnt(8)
    v_mfma_f32_16x16x32_bf16 v[84:87], a[20:23], v[68:71], v[84:87]
    s_and_b32 s45, s19, 14
    s_and_b32 s37, s16, 1
    s_waitcnt lgkmcnt(7)
    v_mfma_f32_16x16x32_bf16 v[84:87], a[24:27], v[72:75], v[84:87]
    s_add_u32 s45, s45, s37
    s_mul_i32 s38, s16, 28672
    s_waitcnt lgkmcnt(6)
    v_mfma_f32_16x16x32_bf16 v[84:87], a[28:31], v[76:79], v[84:87]
    buffer_load_dwordx4 v[148:151], v2, s[20:23], s33 offen offset:1024 sc1
    s_waitcnt lgkmcnt(5)
    v_mfma_f32_16x16x32_bf16 v[84:87], a[32:35], v[80:83], v[84:87]
    s_bfe_u32 s37, s18, 0x10001
    s_lshl_b32 s39, s37, 14
    s_waitcnt lgkmcnt(4)
    v_mfma_f32_16x16x32_bf16 v[84:87], a[36:39], v[24:27], v[84:87]
    s_add_u32 s38, s38, s39
    s_mul_i32 s53, s37, -28672
    s_waitcnt lgkmcnt(3)
    v_mfma_f32_16x16x32_bf16 v[84:87], a[40:43], v[28:31], v[84:87]
    buffer_load_dwordx4 v[152:155], v2, s[20:23], s33 offen offset:2048 sc1
    s_waitcnt lgkmcnt(2)
    v_mfma_f32_16x16x32_bf16 v[84:87], a[44:47], v[32:35], v[84:87]
    s_add_u32 s53, s53, 4096
    s_mul_i32 s46, s44, 114688
    s_waitcnt lgkmcnt(1)
    v_mfma_f32_16x16x32_bf16 v[84:87], a[48:51], v[36:39], v[84:87]
    s_xor_b32 s37, s44, 1
    s_mul_i32 s47, s37, 114688
    s_waitcnt lgkmcnt(0)
    v_mfma_f32_16x16x32_bf16 v[84:87], a[52:55], v[40:43], v[84:87]
    buffer_load_dwordx4 v[156:159], v2, s[20:23], s33 offen offset:3072 sc1
    s_add_u32 s33, s33, 4096
    v_mfma_f32_16x16x32_bf16 v[88:91], a[56:59], v[48:51], v[88:91]
    s_add_u32 s39, s38, 0x1e00000
    s_add_u32 s46, s46, s39
    v_mfma_f32_16x16x32_bf16 v[88:91], a[60:63], v[52:55], v[88:91]
    s_add_u32 s47, s47, s39
    s_mul_i32 s48, s45, 115712
    v_mfma_f32_16x16x32_bf16 v[88:91], a[64:67], v[56:59], v[88:91]
    buffer_load_dwordx4 v[16:19], v2, s[20:23], s33 offen offset:0 sc1
    v_mfma_f32_16x16x32_bf16 v[88:91], a[68:71], v[60:63], v[88:91]
    s_add_u32 s50, s48, 0x61c000
    s_xor_b32 s37, s45, 1
    v_mfma_f32_16x16x32_bf16 v[88:91], a[72:75], v[64:67], v[88:91]
    s_mul_i32 s49, s37, 115712
    s_add_u32 s39, s38, 0x600000
    v_mfma_f32_16x16x32_bf16 v[88:91], a[76:79], v[68:71], v[88:91]
    buffer_load_dwordx4 v[20:23], v2, s[20:23], s33 offen offset:1024 sc1
    v_mfma_f32_16x16x32_bf16 v[88:91], a[80:83], v[72:75], v[88:91]
    s_add_u32 s48, s48, s39
    s_add_u32 s49, s49, s39
    v_mfma_f32_16x16x32_bf16 v[88:91], a[84:87], v[76:79], v[88:91]
    v_mov_b32 v12, v84
    v_mul_f32 v13, v84, v84
    v_mfma_f32_16x16x32_bf16 v[88:91], a[88:91], v[80:83], v[88:91]
    buffer_load_dwordx4 v2, s[20:23], s34 offen offset:0 sc1 lds
    v_mfma_f32_16x16x32_bf16 v[88:91], a[92:95], v[24:27], v[88:91]
    v_mov_b32 v14, v85
    v_mul_f32 v15, v85, v85
    v_mfma_f32_16x16x32_bf16 v[88:91], a[96:99], v[28:31], v[88:91]
    v_add_f32 v12, v12, v86
    v_fmac_f32 v13, v86, v86
    v_mfma_f32_16x16x32_bf16 v[88:91], a[100:103], v[32:35], v[88:91]
    buffer_load_dwordx4 v2, s[20:23], s34 offen offset:1024 sc1 lds
    v_mfma_f32_16x16x32_bf16 v[88:91], a[104:107], v[36:39], v[88:91]
    v_add_f32 v14, v14, v87
    v_fmac_f32 v15, v87, v87
    v_mfma_f32_16x16x32_bf16 v[88:91], a[108:111], v[40:43], v[88:91]
    s_mul_i32 s51, s44, 28
    s_lshl_b32 s37, s45, 1
    v_mfma_f32_16x16x32_bf16 v[92:95], a[112:115], v[48:51], v[92:95]
    buffer_load_dwordx4 v2, s[20:23], s34 offen offset:2048 sc1 lds
    v_mfma_f32_16x16x32_bf16 v[92:95], a[116:119], v[52:55], v[92:95]
    s_add_u32 s51, s51, s37
    s_lshl_b32 s51, s51, 10
    v_mfma_f32_16x16x32_bf16 v[92:95], a[120:123], v[56:59], v[92:95]
    s_mul_i32 s42, s16, 7168
    s_add_u32 s42, s42, s30
    v_mfma_f32_16x16x32_bf16 v[92:95], a[124:127], v[60:63], v[92:95]
    buffer_load_dwordx4 v2, s[20:23], s34 offen offset:3072 sc1 lds
    v_mfma_f32_16x16x32_bf16 v[92:95], a[128:131], v[64:67], v[92:95]
    s_add_u32 s42, s42, 0x1a00000
    s_add_u32 s43, s42, 4096
    v_mfma_f32_16x16x32_bf16 v[92:95], a[132:135], v[68:71], v[92:95]
    v_bfe_u32 v11, v1, 3, 1
    v_mul_u32_u24 v9, 0x200000, v11
    v_mfma_f32_16x16x32_bf16 v[92:95], a[136:139], v[72:75], v[92:95]
    s_add_u32 m0, s35, 4096
    s_add_u32 s34, s34, 4096
    buffer_load_dwordx4 v2, s[20:23], s34 offen offset:0 sc1 lds
    v_mfma_f32_16x16x32_bf16 v[92:95], a[140:143], v[76:79], v[92:95]
    v_add_f32 v12, v12, v88
    v_fmac_f32 v13, v88, v88
    v_mfma_f32_16x16x32_bf16 v[92:95], a[144:147], v[80:83], v[92:95]
    v_add_f32 v14, v14, v89
    v_fmac_f32 v15, v89, v89
    v_mfma_f32_16x16x32_bf16 v[92:95], a[148:151], v[24:27], v[92:95]
    v_mfma_f32_16x16x32_bf16 v[92:95], a[152:155], v[28:31], v[92:95]
    v_add_f32 v12, v12, v90
    v_fmac_f32 v13, v90, v90
    v_mfma_f32_16x16x32_bf16 v[92:95], a[156:159], v[32:35], v[92:95]
    v_add_f32 v14, v14, v91
    v_fmac_f32 v15, v91, v91
    v_mfma_f32_16x16x32_bf16 v[92:95], a[160:163], v[36:39], v[92:95]
    v_mfma_f32_16x16x32_bf16 v[92:95], a[164:167], v[40:43], v[92:95]
    v_lshl_add_u32 v9, v7, 9, v9
    v_lshl_add_u32 v9, v8, 4, v9
    v_mfma_f32_16x16x32_bf16 v[96:99], a[168:171], v[48:51], v[96:99]
    v_cmp_ne_u32 vcc, 0, v11
    v_lshlrev_b32 v10, 5, v8
    v_mfma_f32_16x16x32_bf16 v[96:99], a[172:175], v[52:55], v[96:99]
    v_mfma_f32_16x16x32_bf16 v[96:99], a[176:179], v[56:59], v[96:99]
    s_lshl_b32 s37, s16, 3
    s_add_u32 s37, s37, 56448
    v_mfma_f32_16x16x32_bf16 v[96:99], a[180:183], v[60:63], v[96:99]
    v_add_u32 v11, s37, v10
    v_mfma_f32_16x16x32_bf16 v[96:99], a[184:187], v[64:67], v[96:99]
    buffer_load_dwordx4 a[0:3], v2, s[20:23], s48 offen offset:0 sc1
    v_mfma_f32_16x16x32_bf16 v[96:99], a[188:191], v[68:71], v[96:99]
    v_mfma_f32_16x16x32_bf16 v[96:99], a[192:195], v[72:75], v[96:99]
    v_mfma_f32_16x16x32_bf16 v[96:99], a[196:199], v[76:79], v[96:99]
    buffer_load_dwordx4 a[4:7], v2, s[20:23], s49 offen offset:0 sc1
    v_mfma_f32_16x16x32_bf16 v[96:99], a[200:203], v[80:83], v[96:99]
    v_add_f32 v12, v12, v92
    v_fmac_f32 v13, v92, v92
    v_mfma_f32_16x16x32_bf16 v[96:99], a[204:207], v[24:27], v[96:99]
    v_add_f32 v14, v14, v93
    v_fmac_f32 v15, v93, v93
    v_mfma_f32_16x16x32_bf16 v[96:99], a[208:211], v[28:31], v[96:99]
    buffer_load_dwordx4 a[8:11], v2, s[20:23], s48 offen offset:1024 sc1
    v_mfma_f32_16x16x32_bf16 v[96:99], a[212:215], v[32:35], v[96:99]
    v_add_f32 v12, v12, v94
    v_fmac_f32 v13, v94, v94
    v_mfma_f32_16x16x32_bf16 v[96:99], a[216:219], v[36:39], v[96:99]
    v_add_f32 v14, v14, v95
    v_fmac_f32 v15, v95, v95
    v_mfma_f32_16x16x32_bf16 v[96:99], a[220:223], v[40:43], v[96:99]
    buffer_load_dwordx4 a[12:15], v2, s[20:23], s49 offen offset:1024 sc1
    v_mfma_f32_16x16x32_bf16 v[100:103], a[224:227], v[48:51], v[100:103]
    v_mfma_f32_16x16x32_bf16 v[100:103], a[228:231], v[52:55], v[100:103]
    v_mfma_f32_16x16x32_bf16 v[100:103], a[232:235], v[56:59], v[100:103]
    buffer_load_dwordx4 a[16:19], v2, s[20:23], s48 offen offset:2048 sc1
    v_mfma_f32_16x16x32_bf16 v[100:103], a[236:239], v[60:63], v[100:103]
    v_mfma_f32_16x16x32_bf16 v[100:103], a[240:243], v[64:67], v[100:103]
    v_mfma_f32_16x16x32_bf16 v[100:103], a[244:247], v[68:71], v[100:103]
    buffer_load_dwordx4 a[20:23], v2, s[20:23], s49 offen offset:2048 sc1
    v_mfma_f32_16x16x32_bf16 v[100:103], a[248:251], v[72:75], v[100:103]
    v_mfma_f32_16x16x32_bf16 v[100:103], a[252:255], v[76:79], v[100:103]
    v_add_f32 v12, v12, v96
    v_fmac_f32 v13, v96, v96
    v_mfma_f32_16x16x32_bf16 v[100:103], v[224:227], v[80:83], v[100:103]
    buffer_load_dwordx4 a[24:27], v2, s[20:23], s48 offen offset:3072 sc1
    s_add_u32 s48, s48, 4096
    v_mfma_f32_16x16x32_bf16 v[100:103], v[228:231], v[24:27], v[100:103]
    v_add_f32 v14, v14, v97
    v_fmac_f32 v15, v97, v97
    v_mfma_f32_16x16x32_bf16 v[100:103], v[232:235], v[28:31], v[100:103]
    v_add_f32 v12, v12, v98
    v_fmac_f32 v13, v98, v98
    v_mfma_f32_16x16x32_bf16 v[100:103], v[236:239], v[32:35], v[100:103]
    buffer_load_dwordx4 a[28:31], v2, s[20:23], s49 offen offset:3072 sc1
    s_add_u32 s49, s49, 4096
    v_mfma_f32_16x16x32_bf16 v[100:103], v[240:243], v[36:39], v[100:103]
    v_add_f32 v14, v14, v99
    v_fmac_f32 v15, v99, v99
    v_mfma_f32_16x16x32_bf16 v[100:103], v[244:247], v[40:43], v[100:103]
    v_mfma_f32_16x16x32_bf16 v[104:107], v[248:251], v[48:51], v[104:107]
    buffer_load_dwordx4 a[32:35], v2, s[20:23], s48 offen offset:0 sc1
    v_mfma_f32_16x16x32_bf16 v[104:107], v[252:255], v[52:55], v[104:107]
    s_waitcnt vmcnt(36)
    v_mfma_f32_16x16x32_bf16 v[104:107], v[168:171], v[56:59], v[104:107]
    v_mfma_f32_16x16x32_bf16 v[104:107], v[172:175], v[60:63], v[104:107]
    buffer_load_dwordx4 a[36:39], v2, s[20:23], s49 offen offset:0 sc1
    v_mfma_f32_16x16x32_bf16 v[104:107], v[192:195], v[64:67], v[104:107]
    v_mfma_f32_16x16x32_bf16 v[104:107], v[196:199], v[68:71], v[104:107]
    s_waitcnt vmcnt(33)
    v_mfma_f32_16x16x32_bf16 v[104:107], v[176:179], v[72:75], v[104:107]
    v_mfma_f32_16x16x32_bf16 v[104:107], v[180:183], v[76:79], v[104:107]
    v_add_f32 v12, v12, v100
    v_fmac_f32 v13, v100, v100
    v_mfma_f32_16x16x32_bf16 v[104:107], v[200:203], v[80:83], v[104:107]
    v_add_f32 v14, v14, v101
    v_fmac_f32 v15, v101, v101
    v_mfma_f32_16x16x32_bf16 v[104:107], v[204:207], v[24:27], v[104:107]
    s_waitcnt vmcnt(29)
    v_mfma_f32_16x16x32_bf16 v[104:107], v[160:163], v[28:31], v[104:107]
    v_add_f32 v12, v12, v102
    v_fmac_f32 v13, v102, v102
    v_mfma_f32_16x16x32_bf16 v[104:107], v[164:167], v[32:35], v[104:107]
    v_add_f32 v14, v14, v103
    v_fmac_f32 v15, v103, v103
    v_mfma_f32_16x16x32_bf16 v[104:107], v[184:187], v[36:39], v[104:107]
    v_mfma_f32_16x16x32_bf16 v[104:107], v[188:191], v[40:43], v[104:107]
    s_waitcnt vmcnt(25)
    v_mfma_f32_16x16x32_bf16 v[108:111], v[112:115], v[48:51], v[108:111]
    v_mfma_f32_16x16x32_bf16 v[108:111], v[116:119], v[52:55], v[108:111]
    v_mfma_f32_16x16x32_bf16 v[108:111], v[120:123], v[56:59], v[108:111]
    v_mfma_f32_16x16x32_bf16 v[108:111], v[124:127], v[60:63], v[108:111]
    s_waitcnt vmcnt(21)
    v_mfma_f32_16x16x32_bf16 v[108:111], v[128:131], v[64:67], v[108:111]
    v_mfma_f32_16x16x32_bf16 v[108:111], v[132:135], v[68:71], v[108:111]
    v_mfma_f32_16x16x32_bf16 v[108:111], v[136:139], v[72:75], v[108:111]
    v_mfma_f32_16x16x32_bf16 v[108:111], v[140:143], v[76:79], v[108:111]
    s_waitcnt vmcnt(17)
    v_mfma_f32_16x16x32_bf16 v[108:111], v[144:147], v[80:83], v[108:111]
    v_add_f32 v12, v12, v104
    v_fmac_f32 v13, v104, v104
    v_mfma_f32_16x16x32_bf16 v[108:111], v[148:151], v[24:27], v[108:111]
    v_add_f32 v14, v14, v105
    v_fmac_f32 v15, v105, v105
    v_mfma_f32_16x16x32_bf16 v[108:111], v[152:155], v[28:31], v[108:111]
    v_mfma_f32_16x16x32_bf16 v[108:111], v[156:159], v[32:35], v[108:111]
    v_add_f32 v12, v12, v106
    v_fmac_f32 v13, v106, v106
    s_waitcnt vmcnt(15)
    v_mfma_f32_16x16x32_bf16 v[108:111], v[16:19], v[36:39], v[108:111]
    v_add_f32 v14, v14, v107
    v_fmac_f32 v15, v107, v107
    v_mfma_f32_16x16x32_bf16 v[108:111], v[20:23], v[40:43], v[108:111]
    s_nop 7
    v_add_f32 v12, v12, v108
    v_fmac_f32 v13, v108, v108
    v_add_f32 v14, v14, v109
    v_fmac_f32 v15, v109, v109
    v_add_f32 v12, v12, v110
    v_fmac_f32 v13, v110, v110
    v_add_f32 v14, v14, v111
    v_fmac_f32 v15, v111, v111
    v_pk_add_f32 v[12:13], v[12:13], v[14:15]
    s_nop 0
    v_mov_b32 v14, v12
    v_mov_b32 v15, v13
    s_nop 1
    v_permlane32_swap_b32 v12, v14
    v_permlane32_swap_b32 v13, v15
    v_pk_add_f32 v[12:13], v[12:13], v[14:15]
    s_nop 0
    v_mov_b32 v14, v12
    v_mov_b32 v15, v13
    s_nop 1
    v_permlane16_swap_b32 v12, v14
    v_permlane16_swap_b32 v13, v15
    v_pk_add_f32 v[12:13], v[12:13], v[14:15]
    ds_write_b64 v11, v[12:13]
    buffer_load_dwordx4 a[40:43], v2, s[20:23], s48 offen offset:1024 sc1
    buffer_load_dwordx4 a[44:47], v2, s[20:23], s49 offen offset:1024 sc1
    s_waitcnt lgkmcnt(0)
    s_barrier
    ds_read_b128 v[48:51], v10 offset:56448
    ds_read_b128 v[52:55], v10 offset:56464
    buffer_load_dwordx4 a[48:51], v2, s[20:23], s48 offen offset:2048 sc1
    buffer_load_dwordx4 a[52:55], v2, s[20:23], s49 offen offset:2048 sc1
    s_waitcnt lgkmcnt(0)
    v_pk_add_f32 v[12:13], v[48:49], v[50:51]
    v_pk_add_f32 v[14:15], v[52:53], v[54:55]
    v_pk_add_f32 v[12:13], v[12:13], v[14:15]
    v_mul_f32 v12, 0x3b124925, v12
    v_mul_f32 v13, 0x3b124925, v13
    v_fma_f32 v13, -v12, v12, v13
    v_max_f32 v13, 0, v13
    v_add_f32 v13, 0x3727c5ac, v13
    v_rsq_f32 v14, v13
    v_mov_b32 v13, 0
    v_mul_f32 v14, 0x3eeff558, v14
    v_mul_f32_e64 v12, -v12, v14
    v_cndmask_b32 v14, 1.0, v14, vcc
    v_cndmask_b32 v12, v13, v12, vcc
    v_mov_b32 v15, v14
    v_mov_b32 v13, v12
    v_pk_fma_f32 v[84:85], v[84:85], v[14:15], v[12:13]
    v_pk_fma_f32 v[86:87], v[86:87], v[14:15], v[12:13]
    v_pk_fma_f32 v[88:89], v[88:89], v[14:15], v[12:13]
    v_pk_fma_f32 v[90:91], v[90:91], v[14:15], v[12:13]
    v_cvt_pk_bf16_f32 v208, v84, v85
    v_cvt_pk_bf16_f32 v209, v86, v87
    v_cvt_pk_bf16_f32 v210, v88, v89
    v_cvt_pk_bf16_f32 v211, v90, v91
    s_nop 0
    v_permlane32_swap_b32 v208, v210
    v_permlane32_swap_b32 v209, v211
    buffer_store_dwordx4 v[208:211], v9, s[20:23], s42 offen offset:0 sc1
    v_pk_fma_f32 v[92:93], v[92:93], v[14:15], v[12:13]
    v_pk_fma_f32 v[94:95], v[94:95], v[14:15], v[12:13]
    v_pk_fma_f32 v[96:97], v[96:97], v[14:15], v[12:13]
    v_pk_fma_f32 v[98:99], v[98:99], v[14:15], v[12:13]
    v_cvt_pk_bf16_f32 v212, v92, v93
    v_cvt_pk_bf16_f32 v213, v94, v95
    v_cvt_pk_bf16_f32 v214, v96, v97
    v_cvt_pk_bf16_f32 v215, v98, v99
    s_nop 0
    v_permlane32_swap_b32 v212, v214
    v_permlane32_swap_b32 v213, v215
    buffer_store_dwordx4 v[212:215], v9, s[20:23], s42 offen offset:2048 sc1
    v_pk_fma_f32 v[100:101], v[100:101], v[14:15], v[12:13]
    v_pk_fma_f32 v[102:103], v[102:103], v[14:15], v[12:13]
    v_pk_fma_f32 v[104:105], v[104:105], v[14:15], v[12:13]
    v_pk_fma_f32 v[106:107], v[106:107], v[14:15], v[12:13]
    v_cvt_pk_bf16_f32 v216, v100, v101
    v_cvt_pk_bf16_f32 v217, v102, v103
    v_cvt_pk_bf16_f32 v218, v104, v105
    v_cvt_pk_bf16_f32 v219, v106, v107
    s_nop 0
    v_permlane32_swap_b32 v216, v218
    v_permlane32_swap_b32 v217, v219
    buffer_store_dwordx4 v[216:219], v9, s[20:23], s43 offen offset:0 sc1
    v_pk_fma_f32 v[108:109], v[108:109], v[14:15], v[12:13]
    v_pk_fma_f32 v[110:111], v[110:111], v[14:15], v[12:13]
    v_cvt_pk_bf16_f32 v220, v108, v109
    v_cvt_pk_bf16_f32 v221, v110, v111
    s_nop 1
    v_permlane32_swap_b32 v220, v222
    v_permlane32_swap_b32 v221, v223
    s_mov_b32 exec_hi, 0
    buffer_store_dwordx4 v[220:223], v9, s[20:23], s43 offen offset:2048 sc1
    s_mov_b32 exec_hi, -1
    v_add_u32 v14, 0x10000, v2
    v_add_u32 v15, 0x20000, v2
    v_mov_b32 v225, 0
    v_mov_b32 v226, 0
    v_mov_b32 v227, 0
    v_mov_b32 v224, 0xb8ab3ef0
    v_cndmask_b32 v224, v224, v225, s[28:29]
    v_mov_b32 v10, 0x409d30fc
    v_mov_b32 v11, 0x409d30fc
    v_mov_b32 v12, 1.0
    v_mov_b32 v13, 1.0
    s_lshl_b32 s30, s17, 2
    s_add_u32 s30, s30, s16
    s_mul_i32 s31, s30, 28672
    s_add_u32 s31, s31, 0x1c00000
    s_mul_i32 s32, s30, 112
    s_lshl_b32 s33, s18, 3
    s_add_u32 s32, s32, s33
    s_lshl_b32 s32, s32, 10
    s_add_u32 s32, s32, 0x1e00000
    s_add_u32 s33, s32, 4096
    v_mov_b32 v6, s62
    v_mov_b32 v7, s63
    s_lshl_b32 s40, s17, 8
    s_add_u32 s40, s40, 0x3c4000
    s_lshl_b32 s41, s18, 3
    s_add_u32 s41, s41, s40
    v_min_u32 v4, 15, v1
    v_lshlrev_b32 v4, 3, v4
    buffer_load_dwordx4 a[56:59], v2, s[20:23], s48 offen offset:3072 sc1
    s_add_u32 s48, s48, 4096
    buffer_load_dwordx4 a[60:63], v2, s[20:23], s49 offen offset:3072 sc1
    s_add_u32 s49, s49, 4096
    buffer_load_dwordx4 a[64:67], v2, s[20:23], s48 offen offset:0 sc1
    buffer_load_dwordx4 a[68:71], v2, s[20:23], s49 offen offset:0 sc1
    buffer_load_dwordx4 a[72:75], v2, s[20:23], s48 offen offset:1024 sc1
    buffer_load_dwordx4 a[76:79], v2, s[20:23], s49 offen offset:1024 sc1
    s_cmp_lg_u32 s16, 0
    s_waitcnt vmcnt(6)
    s_barrier
    s_cbranch_scc1 K_sig47
    s_mov_b64 exec, 1
    buffer_store_dwordx2 v[6:7], off, s[20:23], s41
    buffer_store_dwordx2 v[6:7], off, s[20:23], s41 offset:128 sc1
    s_mov_b64 exec, -1
K_sig47:
    s_cmp_ge_u32 s18, 14
    s_cbranch_scc1 K_idle46
K_mlp48:
    s_cmp_lg_u32 s16, 0
    s_cbranch_scc1 K_wdone49
    buffer_load_dwordx2 v[6:7], v4, s[20:23], s40 offen sc1
    s_mov_b64 s[42:43], 0
    s_mov_b32 s3, 0
K_wloop50:
    s_waitcnt vmcnt(0)
    v_cmp_eq_u64 vcc, s[62:63], v[6:7]
    s_or_b64 s[42:43], s[42:43], vcc
    s_cmp_eq_u64 s[42:43], -1
    s_cbranch_scc1 K_wgot52
    s_add_u32 s3, s3, 1
    s_bitcmp1_b32 s3, 3
    s_cbranch_scc0 K_wskip51
    s_add_u32 s3, s3, 7
    buffer_load_dwordx2 v[6:7], v4, s[20:23], s40 offen offset:128 sc1
    s_cmp_gt_u32 s3, 0x40000
    s_cbranch_scc0 K_wloop50
    s_branch K_wgot52
K_wskip51:
    buffer_load_dwordx2 v[6:7], v4, s[20:23], s40 offen sc1
    s_branch K_wloop50
K_wgot52:
    s_waitcnt vmcnt(0)
K_wdone49:
    s_barrier
    buffer_load_dwordx4 v[16:19], v2, s[20:23], s31 offen offset:0 sc1
    buffer_load_dwordx4 v[20:23], v2, s[20:23], s31 offen offset:1024 sc1
    buffer_load_dwordx4 v[24:27], v2, s[20:23], s31 offen offset:2048 sc1
    buffer_load_dwordx4 v[28:31], v2, s[20:23], s31 offen offset:3072 sc1
    s_add_u32 s31, s31, 4096
    buffer_load_dwordx4 v[32:35], v2, s[20:23], s31 offen offset:0 sc1
    buffer_load_dwordx4 v[36:39], v2, s[20:23], s31 offen offset:1024 sc1
    buffer_load_dwordx4 v[40:43], v2, s[20:23], s31 offen offset:2048 sc1
    buffer_load_dwordx4 v[44:47], v2, s[20:23], s31 offen offset:3072 sc1
    s_add_u32 s31, s31, 4096
    ds_read_b128 v[192:195], v14 offset:0
    ds_read_b128 v[196:199], v14 offset:1024
    ds_read_b128 v[200:203], v14 offset:2048
    ds_read_b128 v[204:207], v14 offset:3072
    ds_read_b128 v[208:211], v14 offset:4096
    ds_read_b128 v[212:215], v14 offset:5120
    s_waitcnt lgkmcnt(4)
    v_mfma_f32_32x32x16_bf16 v[128:143], v[192:195], v[224:227], 0
    buffer_load_dwordx4 v[48:51], v2, s[20:23], s31 offen offset:0 sc1
    ds_read_b128 v[216:219], v14 offset:6144
    v_mfma_f32_32x32x16_bf16 v[144:159], v[196:199], v[224:227], 0
    ds_read_b128 v[220:223], v14 offset:7168
    s_waitcnt lgkmcnt(4)
    v_mfma_f32_32x32x16_bf16 v[160:175], v[200:203], v[224:227], 0
    ds_read_b128 v[192:195], v14 offset:8192
    v_mfma_f32_32x32x16_bf16 v[176:191], v[204:207], v[224:227], 0
    ds_read_b128 v[196:199], v14 offset:9216
    s_waitcnt vmcnt(8) lgkmcnt(4)
    v_mfma_f32_32x32x16_bf16 v[128:143], v[208:211], v[16:19], v[128:143]
    buffer_load_dwordx4 v[52:55], v2, s[20:23], s31 offen offset:1024 sc1
    ds_read_b128 v[200:203], v14 offset:10240
    v_mfma_f32_32x32x16_bf16 v[144:159], v[212:215], v[16:19], v[144:159]
    ds_read_b128 v[204:207], v14 offset:11264
    s_waitcnt lgkmcnt(4)
    v_mfma_f32_32x32x16_bf16 v[160:175], v[216:219], v[16:19], v[160:175]
    buffer_load_dwordx4 a[80:83], v2, s[20:23], s48 offen offset:2048 sc1
    ds_read_b128 v[208:211], v14 offset:12288
    v_mfma_f32_32x32x16_bf16 v[176:191], v[220:223], v[16:19], v[176:191]
    ds_read_b128 v[212:215], v14 offset:13312
    s_waitcnt vmcnt(9) lgkmcnt(4)
    v_mfma_f32_32x32x16_bf16 v[128:143], v[192:195], v[20:23], v[128:143]
    buffer_load_dwordx4 v[56:59], v2, s[20:23], s31 offen offset:2048 sc1
    ds_read_b128 v[216:219], v14 offset:14336
    v_mfma_f32_32x32x16_bf16 v[144:159], v[196:199], v[20:23], v[144:159]
    ds_read_b128 v[220:223], v14 offset:15360
    s_waitcnt lgkmcnt(4)
    v_mfma_f32_32x32x16_bf16 v[160:175], v[200:203], v[20:23], v[160:175]
    buffer_load_dwordx4 a[84:87], v2, s[20:23], s49 offen offset:2048 sc1
    ds_read_b128 v[192:195], v14 offset:16384
    v_mfma_f32_32x32x16_bf16 v[176:191], v[204:207], v[20:23], v[176:191]
    ds_read_b128 v[196:199], v14 offset:17408
    s_waitcnt vmcnt(10) lgkmcnt(4)
    v_mfma_f32_32x32x16_bf16 v[128:143], v[208:211], v[24:27], v[128:143]
    buffer_load_dwordx4 v[60:63], v2, s[20:23], s31 offen offset:3072 sc1
    s_add_u32 s31, s31, 4096
    ds_read_b128 v[200:203], v14 offset:18432
    v_mfma_f32_32x32x16_bf16 v[144:159], v[212:215], v[24:27], v[144:159]
    ds_read_b128 v[204:207], v14 offset:19456
    s_waitcnt lgkmcnt(4)
    v_mfma_f32_32x32x16_bf16 v[160:175], v[216:219], v[24:27], v[160:175]
    ds_read_b128 v[208:211], v14 offset:20480
    v_mfma_f32_32x32x16_bf16 v[176:191], v[220:223], v[24:27], v[176:191]
    ds_read_b128 v[212:215], v14 offset:21504
    s_waitcnt vmcnt(10) lgkmcnt(4)
    v_mfma_f32_32x32x16_bf16 v[128:143], v[192:195], v[28:31], v[128:143]
    buffer_load_dwordx4 v[64:67], v2, s[20:23], s31 offen offset:0 sc1
    ds_read_b128 v[216:219], v14 offset:22528
    v_mfma_f32_32x32x16_bf16 v[144:159], v[196:199], v[28:31], v[144:159]
    ds_read_b128 v[220:223], v14 offset:23552
    s_waitcnt lgkmcnt(4)
    v_mfma_f32_32x32x16_bf16 v[160:175], v[200:203], v[28:31], v[160:175]
    buffer_load_dwordx4 a[88:91], v2, s[20:23], s48 offen offset:3072 sc1
    s_add_u32 s48, s48, s53
    ds_read_b128 v[192:195], v14 offset:24576
    v_mfma_f32_32x32x16_bf16 v[176:191], v[204:207], v[28:31], v[176:191]
    ds_read_b128 v[196:199], v14 offset:25600
    s_waitcnt vmcnt(11) lgkmcnt(4)
    v_mfma_f32_32x32x16_bf16 v[128:143], v[208:211], v[32:35], v[128:143]
    buffer_load_dwordx4 v[68:71], v2, s[20:23], s31 offen offset:1024 sc1
    ds_read_b128 v[200:203], v14 offset:26624
    v_mfma_f32_32x32x16_bf16 v[144:159], v[212:215], v[32:35], v[144:159]
    ds_read_b128 v[204:207], v14 offset:27648
    s_waitcnt lgkmcnt(4)
    v_mfma_f32_32x32x16_bf16 v[160:175], v[216:219], v[32:35], v[160:175]
    buffer_load_dwordx4 a[92:95], v2, s[20:23], s49 offen offset:3072 sc1
    s_add_u32 s49, s49, s53
    ds_read_b128 v[208:211], v14 offset:28672
    v_mfma_f32_32x32x16_bf16 v[176:191], v[220:223], v[32:35], v[176:191]
    ds_read_b128 v[212:215], v14 offset:29696
    s_waitcnt vmcnt(12) lgkmcnt(4)
    v_mfma_f32_32x32x16_bf16 v[128:143], v[192:195], v[36:39], v[128:143]
    buffer_load_dwordx4 v[72:75], v2, s[20:23], s31 offen offset:2048 sc1
    ds_read_b128 v[216:219], v14 offset:30720
    v_mfma_f32_32x32x16_bf16 v[144:159], v[196:199], v[36:39], v[144:159]
    ds_read_b128 v[220:223], v14 offset:31744
    s_waitcnt lgkmcnt(4)
    v_mfma_f32_32x32x16_bf16 v[160:175], v[200:203], v[36:39], v[160:175]
    ds_read_b128 v[192:195], v14 offset:32768
    v_mfma_f32_32x32x16_bf16 v[176:191], v[204:207], v[36:39], v[176:191]
    ds_read_b128 v[196:199], v14 offset:33792
    s_waitcnt vmcnt(12) lgkmcnt(4)
    v_mfma_f32_32x32x16_bf16 v[128:143], v[208:211], v[40:43], v[128:143]
    buffer_load_dwordx4 v[76:79], v2, s[20:23], s31 offen offset:3072 sc1
    s_add_u32 s31, s31, 4096
    ds_read_b128 v[200:203], v14 offset:34816
    v_mfma_f32_32x32x16_bf16 v[144:159], v[212:215], v[40:43], v[144:159]
    ds_read_b128 v[204:207], v14 offset:35840
    s_waitcnt lgkmcnt(4)
    v_mfma_f32_32x32x16_bf16 v[160:175], v[216:219], v[40:43], v[160:175]
    buffer_load_dwordx4 a[96:99], v2, s[20:23], s48 offen offset:0 sc1
    ds_read_b128 v[208:211], v14 offset:36864
    v_mfma_f32_32x32x16_bf16 v[176:191], v[220:223], v[40:43], v[176:191]
    ds_read_b128 v[212:215], v14 offset:37888
    s_waitcnt vmcnt(13) lgkmcnt(4)
    v_mfma_f32_32x32x16_bf16 v[128:143], v[192:195], v[44:47], v[128:143]
    buffer_load_dwordx4 v[80:83], v2, s[20:23], s31 offen offset:0 sc1
    ds_read_b128 v[216:219], v14 offset:38912
    v_mfma_f32_32x32x16_bf16 v[144:159], v[196:199], v[44:47], v[144:159]
    ds_read_b128 v[220:223], v14 offset:39936
    s_waitcnt lgkmcnt(4)
    v_mfma_f32_32x32x16_bf16 v[160:175], v[200:203], v[44:47], v[160:175]
    buffer_load_dwordx4 a[100:103], v2, s[20:23], s49 offen offset:0 sc1
    ds_read_b128 v[192:195], v14 offset:40960
    v_mfma_f32_32x32x16_bf16 v[176:191], v[204:207], v[44:47], v[176:191]
    ds_read_b128 v[196:199], v14 offset:41984
    s_waitcnt vmcnt(14) lgkmcnt(4)
    v_mfma_f32_32x32x16_bf16 v[128:143], v[208:211], v[48:51], v[128:143]
    buffer_load_dwordx4 v[84:87], v2, s[20:23], s31 offen offset:1024 sc1
    ds_read_b128 v[200:203], v14 offset:43008
    v_mfma_f32_32x32x16_bf16 v[144:159], v[212:215], v[48:51], v[144:159]
    ds_read_b128 v[204:207], v14 offset:44032
    s_waitcnt lgkmcnt(4)
    v_mfma_f32_32x32x16_bf16 v[160:175], v[216:219], v[48:51], v[160:175]
    ds_read_b128 v[208:211], v14 offset:45056
    v_mfma_f32_32x32x16_bf16 v[176:191], v[220:223], v[48:51], v[176:191]
    ds_read_b128 v[212:215], v14 offset:46080
    s_waitcnt vmcnt(14) lgkmcnt(4)
    v_mfma_f32_32x32x16_bf16 v[128:143], v[192:195], v[52:55], v[128:143]
    buffer_load_dwordx4 v[88:91], v2, s[20:23], s31 offen offset:2048 sc1
    ds_read_b128 v[216:219], v14 offset:47104
    v_mfma_f32_32x32x16_bf16 v[144:159], v[196:199], v[52:55], v[144:159]
    ds_read_b128 v[220:223], v14 offset:48128
    s_waitcnt lgkmcnt(4)
    v_mfma_f32_32x32x16_bf16 v[160:175], v[200:203], v[52:55], v[160:175]
    buffer_load_dwordx4 a[104:107], v2, s[20:23], s48 offen offset:1024 sc1
    ds_read_b128 v[192:195], v14 offset:49152
    v_mfma_f32_32x32x16_bf16 v[176:191], v[204:207], v[52:55], v[176:191]
    ds_read_b128 v[196:199], v14 offset:50176
    s_waitcnt vmcnt(14) lgkmcnt(4)
    v_mfma_f32_32x32x16_bf16 v[128:143], v[208:211], v[56:59], v[128:143]
    buffer_load_dwordx4 v[92:95], v2, s[20:23], s31 offen offset:3072 sc1
    s_add_u32 s31, s31, 4096
    ds_read_b128 v[200:203], v14 offset:51200
    v_mfma_f32_32x32x16_bf16 v[144:159], v[212:215], v[56:59], v[144:159]
    ds_read_b128 v[204:207], v14 offset:52224
    s_waitcnt lgkmcnt(4)
    v_mfma_f32_32x32x16_bf16 v[160:175], v[216:219], v[56:59], v[160:175]
    buffer_load_dwordx4 a[108:111], v2, s[20:23], s49 offen offset:1024 sc1
    ds_read_b128 v[208:211], v14 offset:53248
    v_mfma_f32_32x32x16_bf16 v[176:191], v[220:223], v[56:59], v[176:191]
    ds_read_b128 v[212:215], v14 offset:54272
    s_waitcnt vmcnt(14) lgkmcnt(4)
    v_mfma_f32_32x32x16_bf16 v[128:143], v[192:195], v[60:63], v[128:143]
    buffer_load_dwordx4 v[96:99], v2, s[20:23], s31 offen offset:0 sc1
    ds_read_b128 v[216:219], v14 offset:55296
    v_mfma_f32_32x32x16_bf16 v[144:159], v[196:199], v[60:63], v[144:159]
    ds_read_b128 v[220:223], v14 offset:56320
    s_waitcnt lgkmcnt(4)
    v_mfma_f32_32x32x16_bf16 v[160:175], v[200:203], v[60:63], v[160:175]
    ds_read_b128 v[192:195], v14 offset:57344
    v_mfma_f32_32x32x16_bf16 v[176:191], v[204:207], v[60:63], v[176:191]
    ds_read_b128 v[196:199], v14 offset:58368
    s_waitcnt vmcnt(14) lgkmcnt(4)
    v_mfma_f32_32x32x16_bf16 v[128:143], v[208:211], v[64:67], v[128:143]
    buffer_load_dwordx4 v[100:103], v2, s[20:23], s31 offen offset:1024 sc1
    ds_read_b128 v[200:203], v14 offset:59392
    v_mfma_f32_32x32x16_bf16 v[144:159], v[212:215], v[64:67], v[144:159]
    ds_read_b128 v[204:207], v14 offset:60416
    s_waitcnt lgkmcnt(4)
    v_mfma_f32_32x32x16_bf16 v[160:175], v[216:219], v[64:67], v[160:175]
    buffer_load_dwordx4 a[112:115], v2, s[20:23], s48 offen offset:2048 sc1
    ds_read_b128 v[208:211], v14 offset:61440
    v_mfma_f32_32x32x16_bf16 v[176:191], v[220:223], v[64:67], v[176:191]
    ds_read_b128 v[212:215], v14 offset:62464
    s_waitcnt vmcnt(14) lgkmcnt(4)
    v_mfma_f32_32x32x16_bf16 v[128:143], v[192:195], v[68:71], v[128:143]
    buffer_load_dwordx4 v[104:107], v2, s[20:23], s31 offen offset:2048 sc1
    ds_read_b128 v[216:219], v14 offset:63488
    v_mfma_f32_32x32x16_bf16 v[144:159], v[196:199], v[68:71], v[144:159]
    ds_read_b128 v[220:223], v14 offset:64512
    s_waitcnt lgkmcnt(4)
    v_mfma_f32_32x32x16_bf16 v[160:175], v[200:203], v[68:71], v[160:175]
    buffer_load_dwordx4 a[116:119], v2, s[20:23], s49 offen offset:2048 sc1
    ds_read_b128 v[192:195], v15 offset:0
    v_mfma_f32_32x32x16_bf16 v[176:191], v[204:207], v[68:71], v[176:191]
    ds_read_b128 v[196:199], v15 offset:1024
    s_waitcnt vmcnt(14) lgkmcnt(4)
    v_mfma_f32_32x32x16_bf16 v[128:143], v[208:211], v[72:75], v[128:143]
    buffer_load_dwordx4 v[108:111], v2, s[20:23], s31 offen offset:3072 sc1
    s_add_u32 s31, s31, 4096
    ds_read_b128 v[200:203], v15 offset:2048
    v_mfma_f32_32x32x16_bf16 v[144:159], v[212:215], v[72:75], v[144:159]
    ds_read_b128 v[204:207], v15 offset:3072
    s_waitcnt lgkmcnt(4)
    v_mfma_f32_32x32x16_bf16 v[160:175], v[216:219], v[72:75], v[160:175]
    ds_read_b128 v[208:211], v15 offset:4096
    v_mfma_f32_32x32x16_bf16 v[176:191], v[220:223], v[72:75], v[176:191]
    ds_read_b128 v[212:215], v15 offset:5120
    s_waitcnt vmcnt(14) lgkmcnt(4)
    v_mfma_f32_32x32x16_bf16 v[128:143], v[192:195], v[76:79], v[128:143]
    buffer_load_dwordx4 v[112:115], v2, s[20:23], s31 offen offset:0 sc1
    ds_read_b128 v[216:219], v15 offset:6144
    v_mfma_f32_32x32x16_bf16 v[144:159], v[196:199], v[76:79], v[144:159]
    ds_read_b128 v[220:223], v15 offset:7168
    s_waitcnt lgkmcnt(4)
    v_mfma_f32_32x32x16_bf16 v[160:175], v[200:203], v[76:79], v[160:175]
    buffer_load_dwordx4 a[224:227], v2, s[20:23], s50 offen sc1
    ds_read_b128 v[192:195], v15 offset:8192
    v_mfma_f32_32x32x16_bf16 v[176:191], v[204:207], v[76:79], v[176:191]
    ds_read_b128 v[196:199], v15 offset:9216
    s_waitcnt vmcnt(14) lgkmcnt(4)
    v_mfma_f32_32x32x16_bf16 v[128:143], v[208:211], v[80:83], v[128:143]
    buffer_load_dwordx4 v[116:119], v2, s[20:23], s31 offen offset:1024 sc1
    ds_read_b128 v[200:203], v15 offset:10240
    v_mfma_f32_32x32x16_bf16 v[144:159], v[212:215], v[80:83], v[144:159]
    ds_read_b128 v[204:207], v15 offset:11264
    s_waitcnt lgkmcnt(4)
    v_mfma_f32_32x32x16_bf16 v[160:175], v[216:219], v[80:83], v[160:175]
    buffer_load_dwordx4 a[120:123], v2, s[20:23], s48 offen offset:3072 sc1
    s_add_u32 s48, s48, 4096
    ds_read_b128 v[208:211], v15 offset:12288
    v_mfma_f32_32x32x16_bf16 v[176:191], v[220:223], v[80:83], v[176:191]
    ds_read_b128 v[212:215], v15 offset:13312
    s_waitcnt vmcnt(14) lgkmcnt(4)
    v_mfma_f32_32x32x16_bf16 v[128:143], v[192:195], v[84:87], v[128:143]
    buffer_load_dwordx4 v[120:123], v2, s[20:23], s31 offen offset:2048 sc1
    ds_read_b128 v[216:219], v15 offset:14336
    v_mfma_f32_32x32x16_bf16 v[144:159], v[196:199], v[84:87], v[144:159]
    ds_read_b128 v[220:223], v15 offset:15360
    s_waitcnt lgkmcnt(4)
    v_mfma_f32_32x32x16_bf16 v[160:175], v[200:203], v[84:87], v[160:175]
    ds_read_b128 v[192:195], v15 offset:16384
    v_mfma_f32_32x32x16_bf16 v[176:191], v[204:207], v[84:87], v[176:191]
    ds_read_b128 v[196:199], v15 offset:17408
    s_waitcnt vmcnt(14) lgkmcnt(4)
    v_mfma_f32_32x32x16_bf16 v[128:143], v[208:211], v[88:91], v[128:143]
    buffer_load_dwordx4 v[124:127], v2, s[20:23], s31 offen offset:3072 sc1
    s_add_u32 s31, s31, 4096
    ds_read_b128 v[200:203], v15 offset:18432
    v_mfma_f32_32x32x16_bf16 v[144:159], v[212:215], v[88:91], v[144:159]
    ds_read_b128 v[204:207], v15 offset:19456
    s_waitcnt lgkmcnt(4)
    v_mfma_f32_32x32x16_bf16 v[160:175], v[216:219], v[88:91], v[160:175]
    buffer_load_dwordx4 a[124:127], v2, s[20:23], s49 offen offset:3072 sc1
    s_add_u32 s49, s49, 4096
    ds_read_b128 v[208:211], v15 offset:20480
    v_mfma_f32_32x32x16_bf16 v[176:191], v[220:223], v[88:91], v[176:191]
    ds_read_b128 v[212:215], v15 offset:21504
    s_waitcnt vmcnt(14) lgkmcnt(4)
    v_mfma_f32_32x32x16_bf16 v[128:143], v[192:195], v[92:95], v[128:143]
    buffer_load_dwordx4 a[128:131], v2, s[20:23], s48 offen offset:0 sc1
    ds_read_b128 v[216:219], v15 offset:22528
    v_mfma_f32_32x32x16_bf16 v[144:159], v[196:199], v[92:95], v[144:159]
    ds_read_b128 v[220:223], v15 offset:23552
    s_waitcnt lgkmcnt(4)
    v_mfma_f32_32x32x16_bf16 v[160:175], v[200:203], v[92:95], v[160:175]
    buffer_load_dwordx4 a[132:135], v2, s[20:23], s49 offen offset:0 sc1
    ds_read_b128 v[192:195], v15 offset:24576
    v_mfma_f32_32x32x16_bf16 v[176:191], v[204:207], v[92:95], v[176:191]
    ds_read_b128 v[196:199], v15 offset:25600
    s_waitcnt vmcnt(14) lgkmcnt(4)
    v_mfma_f32_32x32x16_bf16 v[128:143], v[208:211], v[96:99], v[128:143]
    buffer_load_dwordx4 a[136:139], v2, s[20:23], s48 offen offset:1024 sc1
    ds_read_b128 v[200:203], v15 offset:26624
    v_mfma_f32_32x32x16_bf16 v[144:159], v[212:215], v[96:99], v[144:159]
    ds_read_b128 v[204:207], v15 offset:27648
    s_waitcnt lgkmcnt(4)
    v_mfma_f32_32x32x16_bf16 v[160:175], v[216:219], v[96:99], v[160:175]
    buffer_load_dwordx4 a[140:143], v2, s[20:23], s49 offen offset:1024 sc1
    ds_read_b128 v[208:211], v15 offset:28672
    v_mfma_f32_32x32x16_bf16 v[176:191], v[220:223], v[96:99], v[176:191]
    ds_read_b128 v[212:215], v15 offset:29696
    s_waitcnt vmcnt(15) lgkmcnt(4)
    v_mfma_f32_32x32x16_bf16 v[128:143], v[192:195], v[100:103], v[128:143]
    buffer_load_dwordx4 a[144:147], v2, s[20:23], s48 offen offset:2048 sc1
    ds_read_b128 v[216:219], v15 offset:30720
    v_mfma_f32_32x32x16_bf16 v[144:159], v[196:199], v[100:103], v[144:159]
    ds_read_b128 v[220:223], v15 offset:31744
    s_waitcnt lgkmcnt(4)
    v_mfma_f32_32x32x16_bf16 v[160:175], v[200:203], v[100:103], v[160:175]
    buffer_load_dwordx4 a[148:151], v2, s[20:23], s49 offen offset:2048 sc1
    ds_read_b128 v[192:195], v2 offset:0
    v_mfma_f32_32x32x16_bf16 v[176:191], v[204:207], v[100:103], v[176:191]
    ds_read_b128 v[196:199], v2 offset:1024
    s_waitcnt vmcnt(15) lgkmcnt(4)
    v_mfma_f32_32x32x16_bf16 v[128:143], v[208:211], v[104:107], v[128:143]
    buffer_load_dwordx4 a[152:155], v2, s[20:23], s48 offen offset:3072 sc1
    s_add_u32 s48, s48, 4096
    ds_read_b128 v[200:203], v2 offset:2048
    v_mfma_f32_32x32x16_bf16 v[144:159], v[212:215], v[104:107], v[144:159]
    ds_read_b128 v[204:207], v2 offset:3072
    s_waitcnt lgkmcnt(4)
    v_mfma_f32_32x32x16_bf16 v[160:175], v[216:219], v[104:107], v[160:175]
    buffer_load_dwordx4 a[156:159], v2, s[20:23], s49 offen offset:3072 sc1
    s_add_u32 s49, s49, 4096
    ds_read_b128 v[208:211], v2 offset:4096
    v_mfma_f32_32x32x16_bf16 v[176:191], v[220:223], v[104:107], v[176:191]
    ds_read_b128 v[212:215], v2 offset:5120
    s_waitcnt vmcnt(15) lgkmcnt(4)
    v_mfma_f32_32x32x16_bf16 v[128:143], v[192:195], v[108:111], v[128:143]
    buffer_load_dwordx4 a[160:163], v2, s[20:23], s48 offen offset:0 sc1
    ds_read_b128 v[216:219], v2 offset:6144
    v_mfma_f32_32x32x16_bf16 v[144:159], v[196:199], v[108:111], v[144:159]
    ds_read_b128 v[220:223], v2 offset:7168
    s_waitcnt lgkmcnt(4)
    v_mfma_f32_32x32x16_bf16 v[160:175], v[200:203], v[108:111], v[160:175]
    buffer_load_dwordx4 a[164:167], v2, s[20:23], s49 offen offset:0 sc1
    ds_read_b128 v[192:195], v2 offset:8192
    v_mfma_f32_32x32x16_bf16 v[176:191], v[204:207], v[108:111], v[176:191]
    ds_read_b128 v[196:199], v2 offset:9216
    s_waitcnt vmcnt(16) lgkmcnt(4)
    v_mfma_f32_32x32x16_bf16 v[128:143], v[208:211], v[112:115], v[128:143]
    buffer_load_dwordx4 a[168:171], v2, s[20:23], s48 offen offset:1024 sc1
    ds_read_b128 v[200:203], v2 offset:10240
    v_mfma_f32_32x32x16_bf16 v[144:159], v[212:215], v[112:115], v[144:159]
    ds_read_b128 v[204:207], v2 offset:11264
    s_waitcnt lgkmcnt(4)
    v_mfma_f32_32x32x16_bf16 v[160:175], v[216:219], v[112:115], v[160:175]
    buffer_load_dwordx4 a[172:175], v2, s[20:23], s49 offen offset:1024 sc1
    ds_read_b128 v[208:211], v2 offset:12288
    v_mfma_f32_32x32x16_bf16 v[176:191], v[220:223], v[112:115], v[176:191]
    ds_read_b128 v[212:215], v2 offset:13312
    s_waitcnt vmcnt(16) lgkmcnt(4)
    v_mfma_f32_32x32x16_bf16 v[128:143], v[192:195], v[116:119], v[128:143]
    buffer_load_dwordx4 a[176:179], v2, s[20:23], s48 offen offset:2048 sc1
    ds_read_b128 v[216:219], v2 offset:14336
    v_mfma_f32_32x32x16_bf16 v[144:159], v[196:199], v[116:119], v[144:159]
    ds_read_b128 v[220:223], v2 offset:15360
    s_waitcnt lgkmcnt(4)
    v_mfma_f32_32x32x16_bf16 v[160:175], v[200:203], v[116:119], v[160:175]
    buffer_load_dwordx4 a[180:183], v2, s[20:23], s49 offen offset:2048 sc1
    ds_read_b128 v[192:195], v2 offset:16384
    v_mfma_f32_32x32x16_bf16 v[176:191], v[204:207], v[116:119], v[176:191]
    ds_read_b128 v[196:199], v2 offset:17408
    s_waitcnt vmcnt(16) lgkmcnt(4)
    v_mfma_f32_32x32x16_bf16 v[128:143], v[208:211], v[120:123], v[128:143]
    buffer_load_dwordx4 a[184:187], v2, s[20:23], s48 offen offset:3072 sc1
    s_add_u32 s48, s48, 4096
    ds_read_b128 v[200:203], v2 offset:18432
    v_mfma_f32_32x32x16_bf16 v[144:159], v[212:215], v[120:123], v[144:159]
    ds_read_b128 v[204:207], v2 offset:19456
    s_waitcnt lgkmcnt(4)
    v_mfma_f32_32x32x16_bf16 v[160:175], v[216:219], v[120:123], v[160:175]
    buffer_load_dwordx4 a[188:191], v2, s[20:23], s49 offen offset:3072 sc1
    s_add_u32 s49, s49, 4096
    v_mfma_f32_32x32x16_bf16 v[176:191], v[220:223], v[120:123], v[176:191]
    s_waitcnt vmcnt(17) lgkmcnt(2)
    v_mfma_f32_32x32x16_bf16 v[128:143], v[192:195], v[124:127], v[128:143]
    buffer_load_dwordx4 a[192:195], v2, s[20:23], s48 offen offset:0 sc1
    v_mfma_f32_32x32x16_bf16 v[144:159], v[196:199], v[124:127], v[144:159]
    s_waitcnt lgkmcnt(0)
    v_mfma_f32_32x32x16_bf16 v[160:175], v[200:203], v[124:127], v[160:175]
    buffer_load_dwordx4 a[196:199], v2, s[20:23], s49 offen offset:0 sc1
    v_mfma_f32_32x32x16_bf16 v[176:191], v[204:207], v[124:127], v[176:191]
    s_nop 5
    v_pk_fma_f32 v[228:229], v[128:129], v[128:129], v[10:11]
    v_pk_fma_f32 v[230:231], v[130:131], v[130:131], v[10:11]
    v_pk_fma_f32 v[232:233], v[132:133], v[132:133], v[10:11]
    v_pk_fma_f32 v[234:235], v[134:135], v[134:135], v[10:11]
    v_pk_mul_f32 v[228:229], v[128:129], v[228:229]
    v_pk_mul_f32 v[230:231], v[130:131], v[230:231]
    v_pk_mul_f32 v[232:233], v[132:133], v[232:233]
    v_pk_mul_f32 v[234:235], v[134:135], v[234:235]
    v_exp_f32_e64 v228, -v228
    v_exp_f32_e64 v229, -v229
    v_exp_f32_e64 v230, -v230
    v_exp_f32_e64 v231, -v231
    v_exp_f32_e64 v232, -v232
    v_exp_f32_e64 v233, -v233
    v_exp_f32_e64 v234, -v234
    v_exp_f32_e64 v235, -v235
    v_pk_add_f32 v[228:229], v[228:229], v[12:13]
    v_pk_add_f32 v[230:231], v[230:231], v[12:13]
    v_pk_add_f32 v[232:233], v[232:233], v[12:13]
    v_pk_add_f32 v[234:235], v[234:235], v[12:13]
    v_rcp_f32 v228, v228
    v_rcp_f32 v229, v229
    v_rcp_f32 v230, v230
    v_rcp_f32 v231, v231
    v_rcp_f32 v232, v232
    v_rcp_f32 v233, v233
    v_rcp_f32 v234, v234
    v_rcp_f32 v235, v235
    v_pk_mul_f32 v[228:229], v[128:129], v[228:229]
    v_pk_mul_f32 v[230:231], v[130:131], v[230:231]
    v_pk_mul_f32 v[232:233], v[132:133], v[232:233]
    v_pk_mul_f32 v[234:235], v[134:135], v[234:235]
    v_cvt_pk_bf16_f32 v236, v228, v229
    v_cvt_pk_bf16_f32 v237, v230, v231
    v_cvt_pk_bf16_f32 v238, v232, v233
    v_cvt_pk_bf16_f32 v239, v234, v235
    buffer_store_dwordx4 v[236:239], v2, s[20:23], s32 offen offset:0 sc1
    v_pk_fma_f32 v[228:229], v[136:137], v[136:137], v[10:11]
    v_pk_fma_f32 v[230:231], v[138:139], v[138:139], v[10:11]
    v_pk_fma_f32 v[232:233], v[140:141], v[140:141], v[10:11]
    v_pk_fma_f32 v[234:235], v[142:143], v[142:143], v[10:11]
    v_pk_mul_f32 v[228:229], v[136:137], v[228:229]
    v_pk_mul_f32 v[230:231], v[138:139], v[230:231]
    v_pk_mul_f32 v[232:233], v[140:141], v[232:233]
    v_pk_mul_f32 v[234:235], v[142:143], v[234:235]
    v_exp_f32_e64 v228, -v228
    v_exp_f32_e64 v229, -v229
    v_exp_f32_e64 v230, -v230
    v_exp_f32_e64 v231, -v231
    v_exp_f32_e64 v232, -v232
    v_exp_f32_e64 v233, -v233
    v_exp_f32_e64 v234, -v234
    v_exp_f32_e64 v235, -v235
    v_pk_add_f32 v[228:229], v[228:229], v[12:13]
    v_pk_add_f32 v[230:231], v[230:231], v[12:13]
    v_pk_add_f32 v[232:233], v[232:233], v[12:13]
    v_pk_add_f32 v[234:235], v[234:235], v[12:13]
    v_rcp_f32 v228, v228
    v_rcp_f32 v229, v229
    v_rcp_f32 v230, v230
    v_rcp_f32 v231, v231
    v_rcp_f32 v232, v232
    v_rcp_f32 v233, v233
    v_rcp_f32 v234, v234
    v_rcp_f32 v235, v235
    v_pk_mul_f32 v[228:229], v[136:137], v[228:229]
    v_pk_mul_f32 v[230:231], v[138:139], v[230:231]
    v_pk_mul_f32 v[232:233], v[140:141], v[232:233]
    v_pk_mul_f32 v[234:235], v[142:143], v[234:235]
    v_cvt_pk_bf16_f32 v240, v228, v229
    v_cvt_pk_bf16_f32 v241, v230, v231
    v_cvt_pk_bf16_f32 v242, v232, v233
    v_cvt_pk_bf16_f32 v243, v234, v235
    buffer_store_dwordx4 v[240:243], v2, s[20:23], s32 offen offset:1024 sc1
    v_pk_fma_f32 v[228:229], v[144:145], v[144:145], v[10:11]
    v_pk_fma_f32 v[230:231], v[146:147], v[146:147], v[10:11]
    v_pk_fma_f32 v[232:233], v[148:149], v[148:149], v[10:11]
    v_pk_fma_f32 v[234:235], v[150:151], v[150:151], v[10:11]
    v_pk_mul_f32 v[228:229], v[144:145], v[228:229]
    v_pk_mul_f32 v[230:231], v[146:147], v[230:231]
    v_pk_mul_f32 v[232:233], v[148:149], v[232:233]
    v_pk_mul_f32 v[234:235], v[150:151], v[234:235]
    v_exp_f32_e64 v228, -v228
    v_exp_f32_e64 v229, -v229
    v_exp_f32_e64 v230, -v230
    v_exp_f32_e64 v231, -v231
    v_exp_f32_e64 v232, -v232
    v_exp_f32_e64 v233, -v233
    v_exp_f32_e64 v234, -v234
    v_exp_f32_e64 v235, -v235
    v_pk_add_f32 v[228:229], v[228:229], v[12:13]
    v_pk_add_f32 v[230:231], v[230:231], v[12:13]
    v_pk_add_f32 v[232:233], v[232:233], v[12:13]
    v_pk_add_f32 v[234:235], v[234:235], v[12:13]
    v_rcp_f32 v228, v228
    v_rcp_f32 v229, v229
    v_rcp_f32 v230, v230
    v_rcp_f32 v231, v231
    v_rcp_f32 v232, v232
    v_rcp_f32 v233, v233
    v_rcp_f32 v234, v234
    v_rcp_f32 v235, v235
    v_pk_mul_f32 v[228:229], v[144:145], v[228:229]
    v_pk_mul_f32 v[230:231], v[146:147], v[230:231]
    v_pk_mul_f32 v[232:233], v[148:149], v[232:233]
    v_pk_mul_f32 v[234:235], v[150:151], v[234:235]
    v_cvt_pk_bf16_f32 v236, v228, v229
    v_cvt_pk_bf16_f32 v237, v230, v231
    v_cvt_pk_bf16_f32 v238, v232, v233
    v_cvt_pk_bf16_f32 v239, v234, v235
    buffer_store_dwordx4 v[236:239], v2, s[20:23], s32 offen offset:2048 sc1
    v_pk_fma_f32 v[228:229], v[152:153], v[152:153], v[10:11]
    v_pk_fma_f32 v[230:231], v[154:155], v[154:155], v[10:11]
    v_pk_fma_f32 v[232:233], v[156:157], v[156:157], v[10:11]
    v_pk_fma_f32 v[234:235], v[158:159], v[158:159], v[10:11]
    v_pk_mul_f32 v[228:229], v[152:153], v[228:229]
    v_pk_mul_f32 v[230:231], v[154:155], v[230:231]
    v_pk_mul_f32 v[232:233], v[156:157], v[232:233]
    v_pk_mul_f32 v[234:235], v[158:159], v[234:235]
    v_exp_f32_e64 v228, -v228
    v_exp_f32_e64 v229, -v229
    v_exp_f32_e64 v230, -v230
    v_exp_f32_e64 v231, -v231
    v_exp_f32_e64 v232, -v232
    v_exp_f32_e64 v233, -v233
    v_exp_f32_e64 v234, -v234
    v_exp_f32_e64 v235, -v235
    v_pk_add_f32 v[228:229], v[228:229], v[12:13]
    v_pk_add_f32 v[230:231], v[230:231], v[12:13]
    v_pk_add_f32 v[232:233], v[232:233], v[12:13]
    v_pk_add_f32 v[234:235], v[234:235], v[12:13]
    v_rcp_f32 v228, v228
    v_rcp_f32 v229, v229
    v_rcp_f32 v230, v230
    v_rcp_f32 v231, v231
    v_rcp_f32 v232, v232
    v_rcp_f32 v233, v233
    v_rcp_f32 v234, v234
    v_rcp_f32 v235, v235
    v_pk_mul_f32 v[228:229], v[152:153], v[228:229]
    v_pk_mul_f32 v[230:231], v[154:155], v[230:231]
    v_pk_mul_f32 v[232:233], v[156:157], v[232:233]
    v_pk_mul_f32 v[234:235], v[158:159], v[234:235]
    v_cvt_pk_bf16_f32 v240, v228, v229
    v_cvt_pk_bf16_f32 v241, v230, v231
    v_cvt_pk_bf16_f32 v242, v232, v233
    v_cvt_pk_bf16_f32 v243, v234, v235
    buffer_store_dwordx4 v[240:243], v2, s[20:23], s32 offen offset:3072 sc1
    v_pk_fma_f32 v[228:229], v[160:161], v[160:161], v[10:11]
    v_pk_fma_f32 v[230:231], v[162:163], v[162:163], v[10:11]
    v_pk_fma_f32 v[232:233], v[164:165], v[164:165], v[10:11]
    v_pk_fma_f32 v[234:235], v[166:167], v[166:167], v[10:11]
    v_pk_mul_f32 v[228:229], v[160:161], v[228:229]
    v_pk_mul_f32 v[230:231], v[162:163], v[230:231]
    v_pk_mul_f32 v[232:233], v[164:165], v[232:233]
    v_pk_mul_f32 v[234:235], v[166:167], v[234:235]
    v_exp_f32_e64 v228, -v228
    v_exp_f32_e64 v229, -v229
    v_exp_f32_e64 v230, -v230
    v_exp_f32_e64 v231, -v231
    v_exp_f32_e64 v232, -v232
    v_exp_f32_e64 v233, -v233
    v_exp_f32_e64 v234, -v234
    v_exp_f32_e64 v235, -v235
    v_pk_add_f32 v[228:229], v[228:229], v[12:13]
    v_pk_add_f32 v[230:231], v[230:231], v[12:13]
    v_pk_add_f32 v[232:233], v[232:233], v[12:13]
    v_pk_add_f32 v[234:235], v[234:235], v[12:13]
    v_rcp_f32 v228, v228
    v_rcp_f32 v229, v229
    v_rcp_f32 v230, v230
    v_rcp_f32 v231, v231
    v_rcp_f32 v232, v232
    v_rcp_f32 v233, v233
    v_rcp_f32 v234, v234
    v_rcp_f32 v235, v235
    v_pk_mul_f32 v[228:229], v[160:161], v[228:229]
    v_pk_mul_f32 v[230:231], v[162:163], v[230:231]
    v_pk_mul_f32 v[232:233], v[164:165], v[232:233]
    v_pk_mul_f32 v[234:235], v[166:167], v[234:235]
    v_cvt_pk_bf16_f32 v236, v228, v229
    v_cvt_pk_bf16_f32 v237, v230, v231
    v_cvt_pk_bf16_f32 v238, v232, v233
    v_cvt_pk_bf16_f32 v239, v234, v235
    buffer_store_dwordx4 v[236:239], v2, s[20:23], s33 offen offset:0 sc1
    v_pk_fma_f32 v[228:229], v[168:169], v[168:169], v[10:11]
    v_pk_fma_f32 v[230:231], v[170:171], v[170:171], v[10:11]
    v_pk_fma_f32 v[232:233], v[172:173], v[172:173], v[10:11]
    v_pk_fma_f32 v[234:235], v[174:175], v[174:175], v[10:11]
    v_pk_mul_f32 v[228:229], v[168:169], v[228:229]
    v_pk_mul_f32 v[230:231], v[170:171], v[230:231]
    v_pk_mul_f32 v[232:233], v[172:173], v[232:233]
    v_pk_mul_f32 v[234:235], v[174:175], v[234:235]
    v_exp_f32_e64 v228, -v228
    v_exp_f32_e64 v229, -v229
    v_exp_f32_e64 v230, -v230
    v_exp_f32_e64 v231, -v231
    v_exp_f32_e64 v232, -v232
    v_exp_f32_e64 v233, -v233
    v_exp_f32_e64 v234, -v234
    v_exp_f32_e64 v235, -v235
    v_pk_add_f32 v[228:229], v[228:229], v[12:13]
    v_pk_add_f32 v[230:231], v[230:231], v[12:13]
    v_pk_add_f32 v[232:233], v[232:233], v[12:13]
    v_pk_add_f32 v[234:235], v[234:235], v[12:13]
    v_rcp_f32 v228, v228
    v_rcp_f32 v229, v229
    v_rcp_f32 v230, v230
    v_rcp_f32 v231, v231
    v_rcp_f32 v232, v232
    v_rcp_f32 v233, v233
    v_rcp_f32 v234, v234
    v_rcp_f32 v235, v235
    v_pk_mul_f32 v[228:229], v[168:169], v[228:229]
    v_pk_mul_f32 v[230:231], v[170:171], v[230:231]
    v_pk_mul_f32 v[232:233], v[172:173], v[232:233]
    v_pk_mul_f32 v[234:235], v[174:175], v[234:235]
    v_cvt_pk_bf16_f32 v240, v228, v229
    v_cvt_pk_bf16_f32 v241, v230, v231
    v_cvt_pk_bf16_f32 v242, v232, v233
    v_cvt_pk_bf16_f32 v243, v234, v235
    buffer_store_dwordx4 v[240:243], v2, s[20:23], s33 offen offset:1024 sc1
    v_pk_fma_f32 v[228:229], v[176:177], v[176:177], v[10:11]
    v_pk_fma_f32 v[230:231], v[178:179], v[178:179], v[10:11]
    v_pk_fma_f32 v[232:233], v[180:181], v[180:181], v[10:11]
    v_pk_fma_f32 v[234:235], v[182:183], v[182:183], v[10:11]
    v_pk_mul_f32 v[228:229], v[176:177], v[228:229]
    v_pk_mul_f32 v[230:231], v[178:179], v[230:231]
    v_pk_mul_f32 v[232:233], v[180:181], v[232:233]
    v_pk_mul_f32 v[234:235], v[182:183], v[234:235]
    v_exp_f32_e64 v228, -v228
    v_exp_f32_e64 v229, -v229
    v_exp_f32_e64 v230, -v230
    v_exp_f32_e64 v231, -v231
    v_exp_f32_e64 v232, -v232
    v_exp_f32_e64 v233, -v233
    v_exp_f32_e64 v234, -v234
    v_exp_f32_e64 v235, -v235
    v_pk_add_f32 v[228:229], v[228:229], v[12:13]
    v_pk_add_f32 v[230:231], v[230:231], v[12:13]
    v_pk_add_f32 v[232:233], v[232:233], v[12:13]
    v_pk_add_f32 v[234:235], v[234:235], v[12:13]
    v_rcp_f32 v228, v228
    v_rcp_f32 v229, v229
    v_rcp_f32 v230, v230
    v_rcp_f32 v231, v231
    v_rcp_f32 v232, v232
    v_rcp_f32 v233, v233
    v_rcp_f32 v234, v234
    v_rcp_f32 v235, v235
    v_pk_mul_f32 v[228:229], v[176:177], v[228:229]
    v_pk_mul_f32 v[230:231], v[178:179], v[230:231]
    v_pk_mul_f32 v[232:233], v[180:181], v[232:233]
    v_pk_mul_f32 v[234:235], v[182:183], v[234:235]
    v_cvt_pk_bf16_f32 v236, v228, v229
    v_cvt_pk_bf16_f32 v237, v230, v231
    v_cvt_pk_bf16_f32 v238, v232, v233
    v_cvt_pk_bf16_f32 v239, v234, v235
    buffer_store_dwordx4 v[236:239], v2, s[20:23], s33 offen offset:2048 sc1
    v_pk_fma_f32 v[228:229], v[184:185], v[184:185], v[10:11]
    v_pk_fma_f32 v[230:231], v[186:187], v[186:187], v[10:11]
    v_pk_fma_f32 v[232:233], v[188:189], v[188:189], v[10:11]
    v_pk_fma_f32 v[234:235], v[190:191], v[190:191], v[10:11]
    v_pk_mul_f32 v[228:229], v[184:185], v[228:229]
    v_pk_mul_f32 v[230:231], v[186:187], v[230:231]
    v_pk_mul_f32 v[232:233], v[188:189], v[232:233]
    v_pk_mul_f32 v[234:235], v[190:191], v[234:235]
    v_exp_f32_e64 v228, -v228
    v_exp_f32_e64 v229, -v229
    v_exp_f32_e64 v230, -v230
    v_exp_f32_e64 v231, -v231
    v_exp_f32_e64 v232, -v232
    v_exp_f32_e64 v233, -v233
    v_exp_f32_e64 v234, -v234
    v_exp_f32_e64 v235, -v235
    v_pk_add_f32 v[228:229], v[228:229], v[12:13]
    v_pk_add_f32 v[230:231], v[230:231], v[12:13]
    v_pk_add_f32 v[232:233], v[232:233], v[12:13]
    v_pk_add_f32 v[234:235], v[234:235], v[12:13]
    v_rcp_f32 v228, v228
    v_rcp_f32 v229, v229
    v_rcp_f32 v230, v230
    v_rcp_f32 v231, v231
    v_rcp_f32 v232, v232
    v_rcp_f32 v233, v233
    v_rcp_f32 v234, v234
    v_rcp_f32 v235, v235
    v_pk_mul_f32 v[228:229], v[184:185], v[228:229]
    v_pk_mul_f32 v[230:231], v[186:187], v[230:231]
    v_pk_mul_f32 v[232:233], v[188:189], v[232:233]
    v_pk_mul_f32 v[234:235], v[190:191], v[234:235]
    v_cvt_pk_bf16_f32 v240, v228, v229
    v_cvt_pk_bf16_f32 v241, v230, v231
    v_cvt_pk_bf16_f32 v242, v232, v233
    v_cvt_pk_bf16_f32 v243, v234, v235
    buffer_store_dwordx4 v[240:243], v2, s[20:23], s33 offen offset:3072 sc1
    v_mov_b32 v6, s62
    v_mov_b32 v7, s63
    s_lshl_b32 s40, s17, 8
    s_add_u32 s40, s40, 0x3c5000
    s_lshl_b32 s41, s18, 3
    s_add_u32 s41, s41, s40
    v_min_u32 v4, 13, v1
    v_lshlrev_b32 v4, 3, v4
    buffer_load_dwordx4 a[200:203], v2, s[20:23], s48 offen offset:1024 sc1
    buffer_load_dwordx4 a[204:207], v2, s[20:23], s49 offen offset:1024 sc1
    buffer_load_dwordx4 a[208:211], v2, s[20:23], s48 offen offset:2048 sc1
    buffer_load_dwordx4 a[212:215], v2, s[20:23], s49 offen offset:2048 sc1
    buffer_load_dwordx4 a[216:219], v2, s[20:23], s48 offen offset:3072 sc1
    s_add_u32 s48, s48, 4096
    buffer_load_dwordx4 a[220:223], v2, s[20:23], s49 offen offset:3072 sc1
    s_add_u32 s49, s49, 4096
    s_cmp_lg_u32 s16, 0
    s_waitcnt vmcnt(6)
    s_barrier
    s_cbranch_scc1 K_sig53
    s_mov_b64 exec, 1
    buffer_store_dwordx2 v[6:7], off, s[20:23], s41
    buffer_store_dwordx2 v[6:7], off, s[20:23], s41 offset:128 sc1
    s_mov_b64 exec, -1
K_sig53:
    s_cmp_lg_u32 s16, 0
    s_cbranch_scc1 K_wdone54
    buffer_load_dwordx2 v[6:7], v4, s[20:23], s40 offen sc1
    s_mov_b64 s[42:43], 0
    s_mov_b32 s3, 0
K_wloop55:
    s_waitcnt vmcnt(0)
    v_cmp_eq_u64 vcc, s[62:63], v[6:7]
    s_or_b64 s[42:43], s[42:43], vcc
    s_cmp_eq_u64 s[42:43], -1
    s_cbranch_scc1 K_wgot57
    s_add_u32 s3, s3, 1
    s_bitcmp1_b32 s3, 3
    s_cbranch_scc0 K_wskip56
    s_add_u32 s3, s3, 7
    buffer_load_dwordx2 v[6:7], v4, s[20:23], s40 offen offset:128 sc1
    s_cmp_gt_u32 s3, 0x40000
    s_cbranch_scc0 K_wloop55
    s_branch K_wgot57
K_wskip56:
    buffer_load_dwordx2 v[6:7], v4, s[20:23], s40 offen sc1
    s_branch K_wloop55
K_wgot57:
    s_waitcnt vmcnt(0)
K_wdone54:
    s_barrier
    buffer_load_dwordx4 v[80:83], v2, s[20:23], s46 offen offset:0 sc1
    buffer_load_dwordx4 v[84:87], v2, s[20:23], s47 offen offset:0 sc1
    buffer_load_dwordx4 v[88:91], v2, s[20:23], s46 offen offset:1024 sc1
    buffer_load_dwordx4 v[92:95], v2, s[20:23], s47 offen offset:1024 sc1
    buffer_load_dwordx4 v[96:99], v2, s[20:23], s46 offen offset:2048 sc1
    buffer_load_dwordx4 v[100:103], v2, s[20:23], s47 offen offset:2048 sc1
    buffer_load_dwordx4 v[104:107], v2, s[20:23], s46 offen offset:3072 sc1
    s_add_u32 s46, s46, 4096
    buffer_load_dwordx4 v[108:111], v2, s[20:23], s47 offen offset:3072 sc1
    s_add_u32 s47, s47, 4096
    buffer_load_dwordx4 v[112:115], v2, s[20:23], s46 offen offset:0 sc1
    buffer_load_dwordx4 v[116:119], v2, s[20:23], s47 offen offset:0 sc1
    buffer_load_dwordx4 v[120:123], v2, s[20:23], s46 offen offset:1024 sc1
    buffer_load_dwordx4 v[124:127], v2, s[20:23], s47 offen offset:1024 sc1
    v_mfma_f32_32x32x16_bf16 v[16:31], a[224:227], v[224:227], 0
    s_add_u32 s52, s51, 0x1a00000
    s_waitcnt vmcnt(11)
    v_mfma_f32_32x32x16_bf16 v[16:31], a[0:3], v[80:83], v[16:31]
    buffer_load_dwordx4 v[128:131], v2, s[20:23], s46 offen offset:2048 sc1
    v_mfma_f32_32x32x16_bf16 v[32:47], a[4:7], v[80:83], 0
    s_waitcnt vmcnt(11)
    v_mfma_f32_32x32x16_bf16 v[48:63], a[0:3], v[84:87], 0
    buffer_load_dwordx4 v[132:135], v2, s[20:23], s47 offen offset:2048 sc1
    v_mfma_f32_32x32x16_bf16 v[64:79], a[4:7], v[84:87], 0
    s_waitcnt vmcnt(11)
    v_mfma_f32_32x32x16_bf16 v[16:31], a[8:11], v[88:91], v[16:31]
    buffer_load_dwordx4 v[136:139], v2, s[20:23], s46 offen offset:3072 sc1
    s_add_u32 s46, s46, 4096
    v_mfma_f32_32x32x16_bf16 v[32:47], a[12:15], v[88:91], v[32:47]
    s_waitcnt vmcnt(11)
    v_mfma_f32_32x32x16_bf16 v[48:63], a[8:11], v[92:95], v[48:63]
    buffer_load_dwordx4 v[140:143], v2, s[20:23], s47 offen offset:3072 sc1
    s_add_u32 s47, s47, 4096
    v_mfma_f32_32x32x16_bf16 v[64:79], a[12:15], v[92:95], v[64:79]
    s_waitcnt vmcnt(11)
    v_mfma_f32_32x32x16_bf16 v[16:31], a[16:19], v[96:99], v[16:31]
    buffer_load_dwordx4 v[144:147], v2, s[20:23], s46 offen offset:0 sc1
    v_mfma_f32_32x32x16_bf16 v[32:47], a[20:23], v[96:99], v[32:47]
    s_waitcnt vmcnt(11)
    v_mfma_f32_32x32x16_bf16 v[48:63], a[16:19], v[100:103], v[48:63]
    buffer_load_dwordx4 v[148:151], v2, s[20:23], s47 offen offset:0 sc1
    v_mfma_f32_32x32x16_bf16 v[64:79], a[20:23], v[100:103], v[64:79]
    s_waitcnt vmcnt(11)
    v_mfma_f32_32x32x16_bf16 v[16:31], a[24:27], v[104:107], v[16:31]
    buffer_load_dwordx4 v[152:155], v2, s[20:23], s46 offen offset:1024 sc1
    v_mfma_f32_32x32x16_bf16 v[32:47], a[28:31], v[104:107], v[32:47]
    s_waitcnt vmcnt(11)
    v_mfma_f32_32x32x16_bf16 v[48:63], a[24:27], v[108:111], v[48:63]
    buffer_load_dwordx4 v[156:159], v2, s[20:23], s47 offen offset:1024 sc1
    v_mfma_f32_32x32x16_bf16 v[64:79], a[28:31], v[108:111], v[64:79]
    s_waitcnt vmcnt(11)
    v_mfma_f32_32x32x16_bf16 v[16:31], a[32:35], v[112:115], v[16:31]
    buffer_load_dwordx4 v[160:163], v2, s[20:23], s46 offen offset:2048 sc1
    v_mfma_f32_32x32x16_bf16 v[32:47], a[36:39], v[112:115], v[32:47]
    s_waitcnt vmcnt(11)
    v_mfma_f32_32x32x16_bf16 v[48:63], a[32:35], v[116:119], v[48:63]
    buffer_load_dwordx4 v[164:167], v2, s[20:23], s47 offen offset:2048 sc1
    v_mfma_f32_32x32x16_bf16 v[64:79], a[36:39], v[116:119], v[64:79]
    s_waitcnt vmcnt(11)
    v_mfma_f32_32x32x16_bf16 v[16:31], a[40:43], v[120:123], v[16:31]
    buffer_load_dwordx4 v[168:171], v2, s[20:23], s46 offen offset:3072 sc1
    s_add_u32 s46, s46, s53
    v_mfma_f32_32x32x16_bf16 v[32:47], a[44:47], v[120:123], v[32:47]
    s_waitcnt vmcnt(11)
    v_mfma_f32_32x32x16_bf16 v[48:63], a[40:43], v[124:127], v[48:63]
    buffer_load_dwordx4 v[172:175], v2, s[20:23], s47 offen offset:3072 sc1
    s_add_u32 s47, s47, s53
    v_mfma_f32_32x32x16_bf16 v[64:79], a[44:47], v[124:127], v[64:79]
    s_waitcnt vmcnt(11)
    v_mfma_f32_32x32x16_bf16 v[16:31], a[48:51], v[128:131], v[16:31]
    buffer_load_dwordx4 v[176:179], v2, s[20:23], s46 offen offset:0 sc1
    v_mfma_f32_32x32x16_bf16 v[32:47], a[52:55], v[128:131], v[32:47]
    s_waitcnt vmcnt(11)
    v_mfma_f32_32x32x16_bf16 v[48:63], a[48:51], v[132:135], v[48:63]
    buffer_load_dwordx4 v[180:183], v2, s[20:23], s47 offen offset:0 sc1
    v_mfma_f32_32x32x16_bf16 v[64:79], a[52:55], v[132:135], v[64:79]
    s_waitcnt vmcnt(11)
    v_mfma_f32_32x32x16_bf16 v[16:31], a[56:59], v[136:139], v[16:31]
    buffer_load_dwordx4 v[184:187], v2, s[20:23], s46 offen offset:1024 sc1
    v_mfma_f32_32x32x16_bf16 v[32:47], a[60:63], v[136:139], v[32:47]
    s_waitcnt vmcnt(11)
    v_mfma_f32_32x32x16_bf16 v[48:63], a[56:59], v[140:143], v[48:63]
    buffer_load_dwordx4 v[188:191], v2, s[20:23], s47 offen offset:1024 sc1
    v_mfma_f32_32x32x16_bf16 v[64:79], a[60:63], v[140:143], v[64:79]
    s_waitcnt vmcnt(11)
    v_mfma_f32_32x32x16_bf16 v[16:31], a[64:67], v[144:147], v[16:31]
    buffer_load_dwordx4 v[192:195], v2, s[20:23], s46 offen offset:2048 sc1
    v_mfma_f32_32x32x16_bf16 v[32:47], a[68:71], v[144:147], v[32:47]
    s_waitcnt vmcnt(11)
    v_mfma_f32_32x32x16_bf16 v[48:63], a[64:67], v[148:151], v[48:63]
    buffer_load_dwordx4 v[196:199], v2, s[20:23], s47 offen offset:2048 sc1
    v_mfma_f32_32x32x16_bf16 v[64:79], a[68:71], v[148:151], v[64:79]
    s_waitcnt vmcnt(11)
    v_mfma_f32_32x32x16_bf16 v[16:31], a[72:75], v[152:155], v[16:31]
    buffer_load_dwordx4 v[200:203], v2, s[20:23], s46 offen offset:3072 sc1
    s_add_u32 s46, s46, 4096
    v_mfma_f32_32x32x16_bf16 v[32:47], a[76:79], v[152:155], v[32:47]
    s_waitcnt vmcnt(11)
    v_mfma_f32_32x32x16_bf16 v[48:63], a[72:75], v[156:159], v[48:63]
    buffer_load_dwordx4 v[204:207], v2, s[20:23], s47 offen offset:3072 sc1
    s_add_u32 s47, s47, 4096
    v_mfma_f32_32x32x16_bf16 v[64:79], a[76:79], v[156:159], v[64:79]
    s_waitcnt vmcnt(11)
    v_mfma_f32_32x32x16_bf16 v[16:31], a[80:83], v[160:163], v[16:31]
    buffer_load_dwordx4 v[80:83], v2, s[20:23], s46 offen offset:0 sc1
    v_mfma_f32_32x32x16_bf16 v[32:47], a[84:87], v[160:163], v[32:47]
    s_waitcnt vmcnt(11)
    v_mfma_f32_32x32x16_bf16 v[48:63], a[80:83], v[164:167], v[48:63]
    buffer_load_dwordx4 v[84:87], v2, s[20:23], s47 offen offset:0 sc1
    v_mfma_f32_32x32x16_bf16 v[64:79], a[84:87], v[164:167], v[64:79]
    s_waitcnt vmcnt(11)
    v_mfma_f32_32x32x16_bf16 v[16:31], a[88:91], v[168:171], v[16:31]
    buffer_load_dwordx4 v[88:91], v2, s[20:23], s46 offen offset:1024 sc1
    v_mfma_f32_32x32x16_bf16 v[32:47], a[92:95], v[168:171], v[32:47]
    s_waitcnt vmcnt(11)
    v_mfma_f32_32x32x16_bf16 v[48:63], a[88:91], v[172:175], v[48:63]
    buffer_load_dwordx4 v[92:95], v2, s[20:23], s47 offen offset:1024 sc1
    v_mfma_f32_32x32x16_bf16 v[64:79], a[92:95], v[172:175], v[64:79]
    s_waitcnt vmcnt(11)
    v_mfma_f32_32x32x16_bf16 v[16:31], a[96:99], v[176:179], v[16:31]
    buffer_load_dwordx4 v[96:99], v2, s[20:23], s46 offen offset:2048 sc1
    v_mfma_f32_32x32x16_bf16 v[32:47], a[100:103], v[176:179], v[32:47]
    s_waitcnt vmcnt(11)
    v_mfma_f32_32x32x16_bf16 v[48:63], a[96:99], v[180:183], v[48:63]
    buffer_load_dwordx4 v[100:103], v2, s[20:23], s47 offen offset:2048 sc1
    v_mfma_f32_32x32x16_bf16 v[64:79], a[100:103], v[180:183], v[64:79]
    s_waitcnt vmcnt(11)
    v_mfma_f32_32x32x16_bf16 v[16:31], a[104:107], v[184:187], v[16:31]
    buffer_load_dwordx4 v[104:107], v2, s[20:23], s46 offen offset:3072 sc1
    s_add_u32 s46, s46, 4096
    v_mfma_f32_32x32x16_bf16 v[32:47], a[108:111], v[184:187], v[32:47]
    s_waitcnt vmcnt(11)
    v_mfma_f32_32x32x16_bf16 v[48:63], a[104:107], v[188:191], v[48:63]
    buffer_load_dwordx4 v[108:111], v2, s[20:23], s47 offen offset:3072 sc1
    s_add_u32 s47, s47, 4096
    v_mfma_f32_32x32x16_bf16 v[64:79], a[108:111], v[188:191], v[64:79]
    s_waitcnt vmcnt(11)
    v_mfma_f32_32x32x16_bf16 v[16:31], a[112:115], v[192:195], v[16:31]
    buffer_load_dwordx4 v[112:115], v2, s[20:23], s46 offen offset:0 sc1
    v_mfma_f32_32x32x16_bf16 v[32:47], a[116:119], v[192:195], v[32:47]
    s_waitcnt vmcnt(11)
    v_mfma_f32_32x32x16_bf16 v[48:63], a[112:115], v[196:199], v[48:63]
    buffer_load_dwordx4 v[116:119], v2, s[20:23], s47 offen offset:0 sc1
    v_mfma_f32_32x32x16_bf16 v[64:79], a[116:119], v[196:199], v[64:79]
    s_waitcnt vmcnt(11)
    v_mfma_f32_32x32x16_bf16 v[16:31], a[120:123], v[200:203], v[16:31]
    buffer_load_dwordx4 v[120:123], v2, s[20:23], s46 offen offset:1024 sc1
    v_mfma_f32_32x32x16_bf16 v[32:47], a[124:127], v[200:203], v[32:47]
    s_waitcnt vmcnt(11)
    v_mfma_f32_32x32x16_bf16 v[48:63], a[120:123], v[204:207], v[48:63]
    buffer_load_dwordx4 v[124:127], v2, s[20:23], s47 offen offset:1024 sc1
    v_mfma_f32_32x32x16_bf16 v[64:79], a[124:127], v[204:207], v[64:79]
    s_waitcnt vmcnt(11)
    v_mfma_f32_32x32x16_bf16 v[16:31], a[128:131], v[80:83], v[16:31]
    buffer_load_dwordx4 v[128:131], v2, s[20:23], s46 offen offset:2048 sc1
    v_mfma_f32_32x32x16_bf16 v[32:47], a[132:135], v[80:83], v[32:47]
    s_waitcnt vmcnt(11)
    v_mfma_f32_32x32x16_bf16 v[48:63], a[128:131], v[84:87], v[48:63]
    buffer_load_dwordx4 v[132:135], v2, s[20:23], s47 offen offset:2048 sc1
    v_mfma_f32_32x32x16_bf16 v[64:79], a[132:135], v[84:87], v[64:79]
    s_waitcnt vmcnt(11)
    v_mfma_f32_32x32x16_bf16 v[16:31], a[136:139], v[88:91], v[16:31]
    buffer_load_dwordx4 v[136:139], v2, s[20:23], s46 offen offset:3072 sc1
    s_add_u32 s46, s46, 4096
    v_mfma_f32_32x32x16_bf16 v[32:47], a[140:143], v[88:91], v[32:47]
    s_waitcnt vmcnt(11)
    v_mfma_f32_32x32x16_bf16 v[48:63], a[136:139], v[92:95], v[48:63]
    buffer_load_dwordx4 v[140:143], v2, s[20:23], s47 offen offset:3072 sc1
    s_add_u32 s47, s47, 4096
    v_mfma_f32_32x32x16_bf16 v[64:79], a[140:143], v[92:95], v[64:79]
    s_waitcnt vmcnt(11)
    v_mfma_f32_32x32x16_bf16 v[16:31], a[144:147], v[96:99], v[16:31]
    buffer_load_dwordx4 v[144:147], v2, s[20:23], s46 offen offset:0 sc1
    v_mfma_f32_32x32x16_bf16 v[32:47], a[148:151], v[96:99], v[32:47]
    s_waitcnt vmcnt(11)
    v_mfma_f32_32x32x16_bf16 v[48:63], a[144:147], v[100:103], v[48:63]
    buffer_load_dwordx4 v[148:151], v2, s[20:23], s47 offen offset:0 sc1
    v_mfma_f32_32x32x16_bf16 v[64:79], a[148:151], v[100:103], v[64:79]
    s_waitcnt vmcnt(11)
    v_mfma_f32_32x32x16_bf16 v[16:31], a[152:155], v[104:107], v[16:31]
    buffer_load_dwordx4 v[152:155], v2, s[20:23], s46 offen offset:1024 sc1
    v_mfma_f32_32x32x16_bf16 v[32:47], a[156:159], v[104:107], v[32:47]
    s_waitcnt vmcnt(11)
    v_mfma_f32_32x32x16_bf16 v[48:63], a[152:155], v[108:111], v[48:63]
    buffer_load_dwordx4 v[156:159], v2, s[20:23], s47 offen offset:1024 sc1
    v_mfma_f32_32x32x16_bf16 v[64:79], a[156:159], v[108:111], v[64:79]
    s_waitcnt vmcnt(11)
    v_mfma_f32_32x32x16_bf16 v[16:31], a[160:163], v[112:115], v[16:31]
    buffer_load_dwordx4 v[160:163], v2, s[20:23], s46 offen offset:2048 sc1
    v_mfma_f32_32x32x16_bf16 v[32:47], a[164:167], v[112:115], v[32:47]
    s_waitcnt vmcnt(11)
    v_mfma_f32_32x32x16_bf16 v[48:63], a[160:163], v[116:119], v[48:63]
    buffer_load_dwordx4 v[164:167], v2, s[20:23], s47 offen offset:2048 sc1
    v_mfma_f32_32x32x16_bf16 v[64:79], a[164:167], v[116:119], v[64:79]
    s_waitcnt vmcnt(11)
    v_mfma_f32_32x32x16_bf16 v[16:31], a[168:171], v[120:123], v[16:31]
    buffer_load_dwordx4 v[168:171], v2, s[20:23], s46 offen offset:3072 sc1
    s_add_u32 s46, s46, 4096
    v_mfma_f32_32x32x16_bf16 v[32:47], a[172:175], v[120:123], v[32:47]
    s_waitcnt vmcnt(11)
    v_mfma_f32_32x32x16_bf16 v[48:63], a[168:171], v[124:127], v[48:63]
    buffer_load_dwordx4 v[172:175], v2, s[20:23], s47 offen offset:3072 sc1
    s_add_u32 s47, s47, 4096
    v_mfma_f32_32x32x16_bf16 v[64:79], a[172:175], v[124:127], v[64:79]
    s_waitcnt vmcnt(11)
    v_mfma_f32_32x32x16_bf16 v[16:31], a[176:179], v[128:131], v[16:31]
    buffer_load_dwordx4 v[208:211], v2, s[20:23], s52 offen offset:0 sc1
    v_mfma_f32_32x32x16_bf16 v[32:47], a[180:183], v[128:131], v[32:47]
    s_waitcnt vmcnt(11)
    v_mfma_f32_32x32x16_bf16 v[48:63], a[176:179], v[132:135], v[48:63]
    buffer_load_dwordx4 v[212:215], v2, s[20:23], s52 offen offset:1024 sc1
    v_mfma_f32_32x32x16_bf16 v[64:79], a[180:183], v[132:135], v[64:79]
    s_waitcnt vmcnt(11)
    v_mfma_f32_32x32x16_bf16 v[16:31], a[184:187], v[136:139], v[16:31]
    v_mfma_f32_32x32x16_bf16 v[32:47], a[188:191], v[136:139], v[32:47]
    s_waitcnt vmcnt(10)
    v_mfma_f32_32x32x16_bf16 v[48:63], a[184:187], v[140:143], v[48:63]
    v_mfma_f32_32x32x16_bf16 v[64:79], a[188:191], v[140:143], v[64:79]
    s_waitcnt vmcnt(9)
    v_mfma_f32_32x32x16_bf16 v[16:31], a[192:195], v[144:147], v[16:31]
    v_mfma_f32_32x32x16_bf16 v[32:47], a[196:199], v[144:147], v[32:47]
    s_waitcnt vmcnt(8)
    v_mfma_f32_32x32x16_bf16 v[48:63], a[192:195], v[148:151], v[48:63]
    v_mfma_f32_32x32x16_bf16 v[64:79], a[196:199], v[148:151], v[64:79]
    s_waitcnt vmcnt(7)
    v_mfma_f32_32x32x16_bf16 v[16:31], a[200:203], v[152:155], v[16:31]
    v_mfma_f32_32x32x16_bf16 v[32:47], a[204:207], v[152:155], v[32:47]
    s_waitcnt vmcnt(6)
    v_mfma_f32_32x32x16_bf16 v[48:63], a[200:203], v[156:159], v[48:63]
    v_mfma_f32_32x32x16_bf16 v[64:79], a[204:207], v[156:159], v[64:79]
    s_waitcnt vmcnt(5)
    v_mfma_f32_32x32x16_bf16 v[16:31], a[208:211], v[160:163], v[16:31]
    v_mfma_f32_32x32x16_bf16 v[32:47], a[212:215], v[160:163], v[32:47]
    s_waitcnt vmcnt(4)
    v_mfma_f32_32x32x16_bf16 v[48:63], a[208:211], v[164:167], v[48:63]
    v_mfma_f32_32x32x16_bf16 v[64:79], a[212:215], v[164:167], v[64:79]
    s_waitcnt vmcnt(3)
    v_mfma_f32_32x32x16_bf16 v[16:31], a[216:219], v[168:171], v[16:31]
    v_mfma_f32_32x32x16_bf16 v[32:47], a[220:223], v[168:171], v[32:47]
    s_waitcnt vmcnt(2)
    v_mfma_f32_32x32x16_bf16 v[48:63], a[216:219], v[172:175], v[48:63]
    v_mfma_f32_32x32x16_bf16 v[64:79], a[220:223], v[172:175], v[64:79]
    s_xor_b32 s37, s16, 1
    s_mul_i32 s37, s37, 12288
    s_add_u32 s37, s37, 0
    v_add_u32 v10, s37, v2
    s_xor_b32 s37, s16, 2
    s_mul_i32 s37, s37, 12288
    s_add_u32 s37, s37, 4096
    v_add_u32 v11, s37, v2
    s_xor_b32 s37, s16, 3
    s_mul_i32 s37, s37, 12288
    s_add_u32 s37, s37, 8192
    v_add_u32 v12, s37, v2
    ds_write_b128 v10, v[32:35] offset:0
    ds_write_b128 v10, v[36:39] offset:1024
    ds_write_b128 v10, v[40:43] offset:2048
    ds_write_b128 v10, v[44:47] offset:3072
    ds_write_b128 v11, v[48:51] offset:0
    ds_write_b128 v11, v[52:55] offset:1024
    ds_write_b128 v11, v[56:59] offset:2048
    ds_write_b128 v11, v[60:63] offset:3072
    ds_write_b128 v12, v[64:67] offset:0
    ds_write_b128 v12, v[68:71] offset:1024
    ds_write_b128 v12, v[72:75] offset:2048
    ds_write_b128 v12, v[76:79] offset:3072
    s_mul_i32 s37, s16, 12288
    v_add_u32 v10, s37, v2
    s_waitcnt vmcnt(0)
    v_lshlrev_b32 v128, 16, v208
    v_and_b32 v129, 0xffff0000, v208
    v_lshlrev_b32 v130, 16, v209
    v_and_b32 v131, 0xffff0000, v209
    v_lshlrev_b32 v132, 16, v210
    v_and_b32 v133, 0xffff0000, v210
    v_lshlrev_b32 v134, 16, v211
    v_and_b32 v135, 0xffff0000, v211
    v_lshlrev_b32 v136, 16, v212
    v_and_b32 v137, 0xffff0000, v212
    v_lshlrev_b32 v138, 16, v213
    v_and_b32 v139, 0xffff0000, v213
    v_lshlrev_b32 v140, 16, v214
    v_and_b32 v141, 0xffff0000, v214
    v_lshlrev_b32 v142, 16, v215
    v_and_b32 v143, 0xffff0000, v215
    v_mov_b32 v8, 0x40088e99
    v_mov_b32 v9, 0x40088e99
    v_pk_fma_f32 v[16:17], v[16:17], v[8:9], v[128:129]
    v_pk_fma_f32 v[18:19], v[18:19], v[8:9], v[130:131]
    v_pk_fma_f32 v[20:21], v[20:21], v[8:9], v[132:133]
    v_pk_fma_f32 v[22:23], v[22:23], v[8:9], v[134:135]
    v_pk_fma_f32 v[24:25], v[24:25], v[8:9], v[136:137]
    v_pk_fma_f32 v[26:27], v[26:27], v[8:9], v[138:139]
    v_pk_fma_f32 v[28:29], v[28:29], v[8:9], v[140:141]
    v_pk_fma_f32 v[30:31], v[30:31], v[8:9], v[142:143]
    s_waitcnt lgkmcnt(0)
    s_barrier
    ds_read_b128 v[80:83], v10 offset:0
    ds_read_b128 v[84:87], v10 offset:1024
    ds_read_b128 v[88:91], v10 offset:2048
    ds_read_b128 v[92:95], v10 offset:3072
    ds_read_b128 v[96:99], v10 offset:4096
    ds_read_b128 v[100:103], v10 offset:5120
    ds_read_b128 v[104:107], v10 offset:6144
    ds_read_b128 v[108:111], v10 offset:7168
    ds_read_b128 v[112:115], v10 offset:8192
    ds_read_b128 v[116:119], v10 offset:9216
    ds_read_b128 v[120:123], v10 offset:10240
    ds_read_b128 v[124:127], v10 offset:11264
    s_mov_b32 s24, s12
    s_mov_b32 s25, s13
    s_mov_b32 s26, 0x1c0000
    s_mov_b32 s27, 0x20000
    v_and_b32 v11, 31, v1
    v_mul_u32_u24 v11, 80, v11
    v_lshl_add_u32 v11, v3, 3, v11
    v_add_u32 v11, s37, v11
    v_lshrrev_b32 v13, 2, v1
    v_and_b32 v14, 3, v1
    v_mul_u32_u24 v12, 80, v13
    v_lshl_add_u32 v12, v14, 4, v12
    v_add_u32 v12, s37, v12
    v_mul_u32_u24 v13, 896, v13
    v_lshl_add_u32 v13, v14, 4, v13
    s_mul_i32 s38, s44, 28672
    s_lshl_b32 s39, s45, 6
    s_add_u32 s38, s38, s39
    s_add_u32 s39, s38, 14336
    s_waitcnt lgkmcnt(8)
    v_pk_fma_f32 v[16:17], v[80:81], v[8:9], v[16:17]
    v_pk_fma_f32 v[18:19], v[82:83], v[8:9], v[18:19]
    v_pk_fma_f32 v[20:21], v[84:85], v[8:9], v[20:21]
    v_pk_fma_f32 v[22:23], v[86:87], v[8:9], v[22:23]
    v_pk_fma_f32 v[24:25], v[88:89], v[8:9], v[24:25]
    v_pk_fma_f32 v[26:27], v[90:91], v[8:9], v[26:27]
    v_pk_fma_f32 v[28:29], v[92:93], v[8:9], v[28:29]
    v_pk_fma_f32 v[30:31], v[94:95], v[8:9], v[30:31]
    s_waitcnt lgkmcnt(4)
    v_pk_fma_f32 v[16:17], v[96:97], v[8:9], v[16:17]
    v_pk_fma_f32 v[18:19], v[98:99], v[8:9], v[18:19]
    v_pk_fma_f32 v[20:21], v[100:101], v[8:9], v[20:21]
    v_pk_fma_f32 v[22:23], v[102:103], v[8:9], v[22:23]
    v_pk_fma_f32 v[24:25], v[104:105], v[8:9], v[24:25]
    v_pk_fma_f32 v[26:27], v[106:107], v[8:9], v[26:27]
    v_pk_fma_f32 v[28:29], v[108:109], v[8:9], v[28:29]
    v_pk_fma_f32 v[30:31], v[110:111], v[8:9], v[30:31]
    s_waitcnt lgkmcnt(0)
    v_pk_fma_f32 v[16:17], v[112:113], v[8:9], v[16:17]
    v_pk_fma_f32 v[18:19], v[114:115], v[8:9], v[18:19]
    v_pk_fma_f32 v[20:21], v[116:117], v[8:9], v[20:21]
    v_pk_fma_f32 v[22:23], v[118:119], v[8:9], v[22:23]
    v_pk_fma_f32 v[24:25], v[120:121], v[8:9], v[24:25]
    v_pk_fma_f32 v[26:27], v[122:123], v[8:9], v[26:27]
    v_pk_fma_f32 v[28:29], v[124:125], v[8:9], v[28:29]
    v_pk_fma_f32 v[30:31], v[126:127], v[8:9], v[30:31]
    v_cvt_pk_bf16_f32 v208, v16, v17
    v_cvt_pk_bf16_f32 v209, v18, v19
    v_cvt_pk_bf16_f32 v210, v20, v21
    v_cvt_pk_bf16_f32 v211, v22, v23
    v_cvt_pk_bf16_f32 v212, v24, v25
    v_cvt_pk_bf16_f32 v213, v26, v27
    v_cvt_pk_bf16_f32 v214, v28, v29
    v_cvt_pk_bf16_f32 v215, v30, v31
    ds_write_b64 v11, v[208:209] offset:0
    ds_write_b64 v11, v[210:211] offset:16
    ds_write_b64 v11, v[212:213] offset:32
    ds_write_b64 v11, v[214:215] offset:48
    s_waitcnt lgkmcnt(0)
    ds_read_b128 v[216:219], v12
    ds_read_b128 v[220:223], v12 offset:1280
    s_waitcnt lgkmcnt(1)
    buffer_store_dwordx4 v[216:219], v13, s[24:27], s38 offen
    s_waitcnt lgkmcnt(0)
    buffer_store_dwordx4 v[220:223], v13, s[24:27], s39 offen
    s_endpgm
K_idle46:
    s_and_b32 s37, s17, 1
    s_lshl_b32 s37, s37, 1
    s_add_u32 s37, s37, s18
    s_sub_u32 s37, s37, 14
    s_lshl_b32 s37, s37, 2
    s_add_u32 s37, s37, s16
    s_getpc_b64 s[38:39]
K_cpc58:
    s_sub_u32 s38, s38, K_cpc58-K_mlp48
    s_subb_u32 s39, s39, 0
    s_lshl_b32 s40, s37, 10
    v_lshlrev_b32 v4, 4, v1
    v_add_u32 v4, s40, v4
    v_min_u32 v4, K_idle46-K_mlp48, v4
    v_mov_b32 v5, s39
    v_add_co_u32 v4, vcc, s38, v4
    s_nop 1
    v_addc_co_u32 v5, vcc, 0, v5, vcc
    global_load_dword v60, v[4:5], off
    s_and_b32 s37, s17, 1
    s_lshl_b32 s37, s37, 1
    s_add_u32 s37, s37, s18
    s_sub_u32 s37, s37, 14
    s_lshl_b32 s37, s37, 2
    s_add_u32 s37, s37, s16
    s_min_u32 s38, s37, 13
    s_mul_i32 s38, s38, 115712
    s_add_u32 s38, s38, 0x600000
    v_lshlrev_b32 v4, 7, v1
    s_add_u32 s39, s38, 6144
    buffer_load_dword v16, v4, s[20:23], s39 offen sc1
    s_add_u32 s39, s38, 34816
    buffer_load_dword v17, v4, s[20:23], s39 offen sc1
    s_add_u32 s39, s38, 63488
    buffer_load_dword v18, v4, s[20:23], s39 offen sc1
    s_add_u32 s39, s38, 92160
    buffer_load_dword v19, v4, s[20:23], s39 offen sc1
    s_add_u32 s39, s38, 14336
    buffer_load_dword v20, v4, s[20:23], s39 offen sc1
    s_add_u32 s39, s38, 43008
    buffer_load_dword v21, v4, s[20:23], s39 offen sc1
    s_add_u32 s39, s38, 71680
    buffer_load_dword v22, v4, s[20:23], s39 offen sc1
    s_add_u32 s39, s38, 100352
    buffer_load_dword v23, v4, s[20:23], s39 offen sc1
    s_add_u32 s39, s38, 21504
    buffer_load_dword v24, v4, s[20:23], s39 offen sc1
    s_add_u32 s39, s38, 50176
    buffer_load_dword v25, v4, s[20:23], s39 offen sc1
    s_add_u32 s39, s38, 78848
    buffer_load_dword v26, v4, s[20:23], s39 offen sc1
    s_add_u32 s39, s38, 107520
    buffer_load_dword v27, v4, s[20:23], s39 offen sc1
    s_endpgm
K_gslow7:
    s_mov_b32 s41, 0
K_gloop59:
    buffer_load_dwordx2 v[222:223], v15, s[20:23], s40 offen sc1
    s_add_u32 s41, s41, 1
    s_cmp_gt_u32 s41, 0x40000
    s_waitcnt vmcnt(0)
    s_cbranch_scc1 K_gback8
    v_cmp_ne_u64 vcc, s[62:63], v[222:223]
    s_cbranch_vccnz K_gloop59
    s_branch K_gback8
K_gslow44:
    s_mov_b32 s41, 0
K_gloop60:
    buffer_load_dwordx2 v[222:223], v15, s[20:23], s40 offen sc1
    s_add_u32 s41, s41, 1
    s_cmp_gt_u32 s41, 0x40000
    s_waitcnt vmcnt(0)
    s_cbranch_scc1 K_gback45
    v_cmp_ne_u64 vcc, s[62:63], v[222:223]
    s_cbranch_vccnz K_gloop60
    s_branch K_gback45
K_att6_fallback:
    s_waitcnt vmcnt(0) lgkmcnt(0)
    s_mov_b32 s36, 1
    s_barrier
    s_lshl_b32 s37, s16, 13
    s_add_u32 s37, s37, s30
    s_add_u32 s37, s37, 0x0
    s_lshl_b32 s38, s16, 11
    s_add_u32 m0, s38, 0
    s_add_u32 s39, s37, 4096
    buffer_load_dwordx4 v9, s[20:23], s37 offen sc1 lds
    s_add_u32 m0, s38, 1024
    s_lshl_b32 s31, s17, 14
    buffer_load_dwordx4 v9, s[20:23], s39 offen sc1 lds
    s_add_u32 s31, s31, 0x200000
    v_bfe_u32 v10, v1, 3, 2
    v_mad_u32_u24 v10, v10, 7, v3
    v_lshrrev_b32 v11, 2, v10
    v_lshlrev_b32 v12, 8, v11
    v_and_b32 v11, 1, v10
    v_lshl_add_u32 v12, v11, 7, v12
    v_bfe_u32 v11, v10, 1, 1
    v_lshl_add_u32 v12, v11, 3, v12
    v_lshl_add_u32 v12, v8, 4, v12
    v_add_u32 v10, 2, v10
    v_lshrrev_b32 v11, 2, v10
    v_lshlrev_b32 v13, 8, v11
    v_and_b32 v11, 1, v10
    v_lshl_add_u32 v13, v11, 7, v13
    v_bfe_u32 v11, v10, 1, 1
    v_lshl_add_u32 v13, v11, 3, v13
    v_lshl_add_u32 v13, v8, 4, v13
    s_xor_b32 s37, s16, 0
    s_mul_i32 s37, s37, 1792
    v_add_u32 v112, s37, v12
    v_add_u32 v113, s37, v13
    s_xor_b32 s37, s16, 1
    s_mul_i32 s37, s37, 1792
    v_add_u32 v114, s37, v12
    v_add_u32 v115, s37, v13
    s_xor_b32 s37, s16, 2
    s_mul_i32 s37, s37, 1792
    v_add_u32 v116, s37, v12
    v_add_u32 v117, s37, v13
    s_xor_b32 s37, s16, 3
    s_mul_i32 s37, s37, 1792
    v_add_u32 v118, s37, v12
    v_add_u32 v119, s37, v13
    s_waitcnt vmcnt(0)
    s_barrier
    ds_read_b64 v[16:17], v112 offset:0
    ds_read_b64 v[18:19], v113 offset:0
    ds_read_b64 v[20:21], v112 offset:256
    ds_read_b64 v[22:23], v113 offset:256
    ds_read_b64 v[24:25], v114 offset:0
    ds_read_b64 v[26:27], v115 offset:0
    ds_read_b64 v[28:29], v114 offset:256
    ds_read_b64 v[30:31], v115 offset:256
    ds_read_b64 v[32:33], v116 offset:0
    ds_read_b64 v[34:35], v117 offset:0
    ds_read_b64 v[36:37], v116 offset:256
    ds_read_b64 v[38:39], v117 offset:256
    ds_read_b64 v[40:41], v118 offset:0
    ds_read_b64 v[42:43], v119 offset:0
    ds_read_b64 v[44:45], v118 offset:256
    ds_read_b64 v[46:47], v119 offset:256
    v_mov_b32 v11, 0
    v_mov_b32 v12, 0xff800000
    v_mov_b32 v13, 0xff800000
    v_mov_b32 v14, 0xff800000
    v_mov_b32 v15, 0xff800000
    s_waitcnt lgkmcnt(0)
    v_cndmask_b32 v22, v22, v11, s[28:29]
    v_cndmask_b32 v23, v23, v11, s[28:29]
    v_cndmask_b32 v30, v30, v11, s[28:29]
    v_cndmask_b32 v31, v31, v11, s[28:29]
    v_cndmask_b32 v38, v38, v11, s[28:29]
    v_cndmask_b32 v39, v39, v11, s[28:29]
    v_cndmask_b32 v46, v46, v11, s[28:29]
    v_cndmask_b32 v47, v47, v11, s[28:29]
    s_mov_b32 s31, 0x200000
K_att6_fbloop:
    buffer_load_dwordx4 v[144:147], v2, s[20:23], s31 offen sc1
    buffer_load_dwordx4 v[148:151], v2, s[20:23], s31 offen offset:1024 sc1
    s_waitcnt vmcnt(0)
    v_mfma_f32_32x32x16_bf16 v[48:63], v[144:147], v[16:19], 0
    v_mfma_f32_32x32x16_bf16 v[64:79], v[144:147], v[24:27], 0
    v_mfma_f32_32x32x16_bf16 v[80:95], v[144:147], v[32:35], 0
    v_mfma_f32_32x32x16_bf16 v[96:111], v[144:147], v[40:43], 0
    v_mfma_f32_32x32x16_bf16 v[48:63], v[148:151], v[20:23], v[48:63]
    v_mfma_f32_32x32x16_bf16 v[64:79], v[148:151], v[28:31], v[64:79]
    v_mfma_f32_32x32x16_bf16 v[80:95], v[148:151], v[36:39], v[80:95]
    v_mfma_f32_32x32x16_bf16 v[96:111], v[148:151], v[44:47], v[96:111]
    s_nop 7
    s_nop 1
    v_max3_f32 v12, v12, v48, v49
    v_max3_f32 v12, v12, v50, v51
    v_max3_f32 v12, v12, v52, v53
    v_max3_f32 v12, v12, v54, v55
    v_max3_f32 v12, v12, v56, v57
    v_max3_f32 v12, v12, v58, v59
    v_max3_f32 v12, v12, v60, v61
    v_max3_f32 v12, v12, v62, v63
    v_max3_f32 v13, v13, v64, v65
    v_max3_f32 v13, v13, v66, v67
    v_max3_f32 v13, v13, v68, v69
    v_max3_f32 v13, v13, v70, v71
    v_max3_f32 v13, v13, v72, v73
    v_max3_f32 v13, v13, v74, v75
    v_max3_f32 v13, v13, v76, v77
    v_max3_f32 v13, v13, v78, v79
    v_max3_f32 v14, v14, v80, v81
    v_max3_f32 v14, v14, v82, v83
    v_max3_f32 v14, v14, v84, v85
    v_max3_f32 v14, v14, v86, v87
    v_max3_f32 v14, v14, v88, v89
    v_max3_f32 v14, v14, v90, v91
    v_max3_f32 v14, v14, v92, v93
    v_max3_f32 v14, v14, v94, v95
    v_max3_f32 v15, v15, v96, v97
    v_max3_f32 v15, v15, v98, v99
    v_max3_f32 v15, v15, v100, v101
    v_max3_f32 v15, v15, v102, v103
    v_max3_f32 v15, v15, v104, v105
    v_max3_f32 v15, v15, v106, v107
    v_max3_f32 v15, v15, v108, v109
    v_max3_f32 v15, v15, v110, v111
    s_add_u32 s31, s31, 4096
    s_cmp_lt_u32 s31, 0x240000
    s_cbranch_scc1 K_att6_fbloop
    v_mov_b32 v128, v12
    v_mov_b32 v129, v13
    v_mov_b32 v130, v14
    v_mov_b32 v131, v15
    s_nop 0
    v_permlane32_swap_b32 v12, v128
    v_permlane32_swap_b32 v13, v129
    v_permlane32_swap_b32 v14, v130
    v_permlane32_swap_b32 v15, v131
    v_max_f32 v12, v12, v128
    v_max_f32 v13, v13, v129
    v_max_f32 v14, v14, v130
    v_max_f32 v15, v15, v131
    v_cvt_pk_bf16_f32 v128, -v12, -v12
    v_cvt_pk_bf16_f32 v129, -v13, -v13
    v_cvt_pk_bf16_f32 v130, -v14, -v14
    v_cvt_pk_bf16_f32 v131, -v15, -v15
    v_lshlrev_b32 v128, 16, v128
    v_lshlrev_b32 v129, 16, v129
    v_lshlrev_b32 v130, 16, v130
    v_lshlrev_b32 v131, 16, v131
    v_add_f32_e64 v132, -v12, -v128
    v_add_f32_e64 v133, -v13, -v129
    v_add_f32_e64 v134, -v14, -v130
    v_add_f32_e64 v135, -v15, -v131
    v_cvt_pk_bf16_f32 v128, v128, v132
    v_cvt_pk_bf16_f32 v129, v129, v133
    v_cvt_pk_bf16_f32 v130, v130, v134
    v_cvt_pk_bf16_f32 v131, v131, v135
    v_cndmask_b32 v22, v22, v128, s[28:29]
    v_cndmask_b32 v30, v30, v129, s[28:29]
    v_cndmask_b32 v38, v38, v130, s[28:29]
    v_cndmask_b32 v46, v46, v131, s[28:29]
    v_lshrrev_b32 v7, 4, v1
    v_bfe_u32 v6, v1, 3, 2
    v_mul_u32_u24 v4, 912, v8
    v_lshl_add_u32 v5, v7, 4, v4
    v_mad_u32_u24 v4, v6, 56, v4
    v_lshl_add_u32 v4, v3, 3, v4
    s_mul_i32 s37, s16, 224
    s_add_u32 s37, s37, 49152
    v_add_u32 v4, s37, v4
    s_xor_b32 s37, s16, 1
    s_mul_i32 s37, s37, 12288
    s_add_u32 s37, s37, 0
    v_add_u32 v12, s37, v2
    s_xor_b32 s37, s16, 2
    s_mul_i32 s37, s37, 12288
    s_add_u32 s37, s37, 4096
    v_add_u32 v13, s37, v2
    s_xor_b32 s37, s16, 3
    s_mul_i32 s37, s37, 12288
    s_add_u32 s37, s37, 8192
    v_add_u32 v14, s37, v2
    s_mul_i32 s37, s16, 12288
    v_add_u32 v11, s37, v2
    s_mul_i32 s34, s19, 118784
    s_lshl_b32 s35, s16, 12
    s_add_u32 s34, s34, s35
    s_add_u32 s34, s34, 0x400000
    s_add_u32 m0, s35, 65536
    v_lshlrev_b32 v10, 7, v8
    v_lshl_add_u32 v10, v7, 3, v10
    s_lshl_b32 s38, s16, 11
    v_add_u32 v10, s38, v10
    ds_write_b64 v10, v[208:209] offset:8192
    ds_write_b64 v10, v[210:211] offset:8224
    ds_write_b64 v10, v[212:213] offset:8256
    ds_write_b64 v10, v[214:215] offset:8288
    ds_write_b64 v10, v[216:217] offset:9216
    ds_write_b64 v10, v[218:219] offset:9248
    ds_write_b64 v10, v[220:221] offset:9280
    s_waitcnt lgkmcnt(0)
    s_lshl_b32 s40, s17, 8
    s_add_u32 s40, s40, 0x3c8000
    v_and_b32 v15, 15, v1
    v_lshlrev_b32 v15, 3, v15
    s_lshl_b32 s31, s17, 14
    s_lshl_b32 s32, s16, 12
    s_add_u32 s31, s31, s32
    s_add_u32 s31, s31, 0x200000
    s_mov_b32 s32, s31
    buffer_load_dwordx4 v[160:163], v2, s[20:23], s31 offen sc1
    buffer_load_dwordx4 v[164:167], v2, s[20:23], s31 offen offset:1024 sc1
    buffer_load_dwordx4 v[184:187], v2, s[20:23], s31 offen offset:2048 sc1
    buffer_load_dwordx4 v[188:191], v2, s[20:23], s31 offen offset:3072 sc1
    s_xor_b32 s31, s32, 0x4000
    s_mul_i32 s33, s16, 100352
    s_add_u32 s33, s33, 0x300000
    s_add_u32 s33, s33, 0
    s_waitcnt vmcnt(0)
    s_barrier
    s_branch K_att6_go
K_att43_fallback:
    s_waitcnt vmcnt(0) lgkmcnt(0)
    s_mov_b32 s36, 1
    s_barrier
    s_lshl_b32 s37, s16, 13
    s_add_u32 s37, s37, s30
    s_add_u32 s37, s37, 0x1600000
    s_lshl_b32 s38, s16, 11
    s_add_u32 m0, s38, 0
    s_add_u32 s39, s37, 4096
    buffer_load_dwordx4 v9, s[20:23], s37 offen sc1 lds
    s_add_u32 m0, s38, 1024
    s_lshl_b32 s31, s17, 14
    buffer_load_dwordx4 v9, s[20:23], s39 offen sc1 lds
    s_add_u32 s31, s31, 0x1800000
    v_bfe_u32 v10, v1, 3, 2
    v_mad_u32_u24 v10, v10, 7, v3
    v_lshrrev_b32 v11, 2, v10
    v_lshlrev_b32 v12, 8, v11
    v_and_b32 v11, 1, v10
    v_lshl_add_u32 v12, v11, 7, v12
    v_bfe_u32 v11, v10, 1, 1
    v_lshl_add_u32 v12, v11, 3, v12
    v_lshl_add_u32 v12, v8, 4, v12
    v_add_u32 v10, 2, v10
    v_lshrrev_b32 v11, 2, v10
    v_lshlrev_b32 v13, 8, v11
    v_and_b32 v11, 1, v10
    v_lshl_add_u32 v13, v11, 7, v13
    v_bfe_u32 v11, v10, 1, 1
    v_lshl_add_u32 v13, v11, 3, v13
    v_lshl_add_u32 v13, v8, 4, v13
    s_xor_b32 s37, s16, 0
    s_mul_i32 s37, s37, 1792
    v_add_u32 v112, s37, v12
    v_add_u32 v113, s37, v13
    s_xor_b32 s37, s16, 1
    s_mul_i32 s37, s37, 1792
    v_add_u32 v114, s37, v12
    v_add_u32 v115, s37, v13
    s_xor_b32 s37, s16, 2
    s_mul_i32 s37, s37, 1792
    v_add_u32 v116, s37, v12
    v_add_u32 v117, s37, v13
    s_xor_b32 s37, s16, 3
    s_mul_i32 s37, s37, 1792
    v_add_u32 v118, s37, v12
    v_add_u32 v119, s37, v13
    s_waitcnt vmcnt(0)
    s_barrier
    ds_read_b64 v[16:17], v112 offset:0
    ds_read_b64 v[18:19], v113 offset:0
    ds_read_b64 v[20:21], v112 offset:256
    ds_read_b64 v[22:23], v113 offset:256
    ds_read_b64 v[24:25], v114 offset:0
    ds_read_b64 v[26:27], v115 offset:0
    ds_read_b64 v[28:29], v114 offset:256
    ds_read_b64 v[30:31], v115 offset:256
    ds_read_b64 v[32:33], v116 offset:0
    ds_read_b64 v[34:35], v117 offset:0
    ds_read_b64 v[36:37], v116 offset:256
    ds_read_b64 v[38:39], v117 offset:256
    ds_read_b64 v[40:41], v118 offset:0
    ds_read_b64 v[42:43], v119 offset:0
    ds_read_b64 v[44:45], v118 offset:256
    ds_read_b64 v[46:47], v119 offset:256
    v_mov_b32 v11, 0
    v_mov_b32 v12, 0xff800000
    v_mov_b32 v13, 0xff800000
    v_mov_b32 v14, 0xff800000
    v_mov_b32 v15, 0xff800000
    s_waitcnt lgkmcnt(0)
    v_cndmask_b32 v22, v22, v11, s[28:29]
    v_cndmask_b32 v23, v23, v11, s[28:29]
    v_cndmask_b32 v30, v30, v11, s[28:29]
    v_cndmask_b32 v31, v31, v11, s[28:29]
    v_cndmask_b32 v38, v38, v11, s[28:29]
    v_cndmask_b32 v39, v39, v11, s[28:29]
    v_cndmask_b32 v46, v46, v11, s[28:29]
    v_cndmask_b32 v47, v47, v11, s[28:29]
    s_mov_b32 s31, 0x1800000
K_att43_fbloop:
    buffer_load_dwordx4 v[144:147], v2, s[20:23], s31 offen sc1
    buffer_load_dwordx4 v[148:151], v2, s[20:23], s31 offen offset:1024 sc1
    s_waitcnt vmcnt(0)
    v_mfma_f32_32x32x16_bf16 v[48:63], v[144:147], v[16:19], 0
    v_mfma_f32_32x32x16_bf16 v[64:79], v[144:147], v[24:27], 0
    v_mfma_f32_32x32x16_bf16 v[80:95], v[144:147], v[32:35], 0
    v_mfma_f32_32x32x16_bf16 v[96:111], v[144:147], v[40:43], 0
    v_mfma_f32_32x32x16_bf16 v[48:63], v[148:151], v[20:23], v[48:63]
    v_mfma_f32_32x32x16_bf16 v[64:79], v[148:151], v[28:31], v[64:79]
    v_mfma_f32_32x32x16_bf16 v[80:95], v[148:151], v[36:39], v[80:95]
    v_mfma_f32_32x32x16_bf16 v[96:111], v[148:151], v[44:47], v[96:111]
    s_nop 7
    s_nop 1
    v_max3_f32 v12, v12, v48, v49
    v_max3_f32 v12, v12, v50, v51
    v_max3_f32 v12, v12, v52, v53
    v_max3_f32 v12, v12, v54, v55
    v_max3_f32 v12, v12, v56, v57
    v_max3_f32 v12, v12, v58, v59
    v_max3_f32 v12, v12, v60, v61
    v_max3_f32 v12, v12, v62, v63
    v_max3_f32 v13, v13, v64, v65
    v_max3_f32 v13, v13, v66, v67
    v_max3_f32 v13, v13, v68, v69
    v_max3_f32 v13, v13, v70, v71
    v_max3_f32 v13, v13, v72, v73
    v_max3_f32 v13, v13, v74, v75
    v_max3_f32 v13, v13, v76, v77
    v_max3_f32 v13, v13, v78, v79
    v_max3_f32 v14, v14, v80, v81
    v_max3_f32 v14, v14, v82, v83
    v_max3_f32 v14, v14, v84, v85
    v_max3_f32 v14, v14, v86, v87
    v_max3_f32 v14, v14, v88, v89
    v_max3_f32 v14, v14, v90, v91
    v_max3_f32 v14, v14, v92, v93
    v_max3_f32 v14, v14, v94, v95
    v_max3_f32 v15, v15, v96, v97
    v_max3_f32 v15, v15, v98, v99
    v_max3_f32 v15, v15, v100, v101
    v_max3_f32 v15, v15, v102, v103
    v_max3_f32 v15, v15, v104, v105
    v_max3_f32 v15, v15, v106, v107
    v_max3_f32 v15, v15, v108, v109
    v_max3_f32 v15, v15, v110, v111
    s_add_u32 s31, s31, 4096
    s_cmp_lt_u32 s31, 0x1840000
    s_cbranch_scc1 K_att43_fbloop
    v_mov_b32 v128, v12
    v_mov_b32 v129, v13
    v_mov_b32 v130, v14
    v_mov_b32 v131, v15
    s_nop 0
    v_permlane32_swap_b32 v12, v128
    v_permlane32_swap_b32 v13, v129
    v_permlane32_swap_b32 v14, v130
    v_permlane32_swap_b32 v15, v131
    v_max_f32 v12, v12, v128
    v_max_f32 v13, v13, v129
    v_max_f32 v14, v14, v130
    v_max_f32 v15, v15, v131
    v_cvt_pk_bf16_f32 v128, -v12, -v12
    v_cvt_pk_bf16_f32 v129, -v13, -v13
    v_cvt_pk_bf16_f32 v130, -v14, -v14
    v_cvt_pk_bf16_f32 v131, -v15, -v15
    v_lshlrev_b32 v128, 16, v128
    v_lshlrev_b32 v129, 16, v129
    v_lshlrev_b32 v130, 16, v130
    v_lshlrev_b32 v131, 16, v131
    v_add_f32_e64 v132, -v12, -v128
    v_add_f32_e64 v133, -v13, -v129
    v_add_f32_e64 v134, -v14, -v130
    v_add_f32_e64 v135, -v15, -v131
    v_cvt_pk_bf16_f32 v128, v128, v132
    v_cvt_pk_bf16_f32 v129, v129, v133
    v_cvt_pk_bf16_f32 v130, v130, v134
    v_cvt_pk_bf16_f32 v131, v131, v135
    v_cndmask_b32 v22, v22, v128, s[28:29]
    v_cndmask_b32 v30, v30, v129, s[28:29]
    v_cndmask_b32 v38, v38, v130, s[28:29]
    v_cndmask_b32 v46, v46, v131, s[28:29]
    v_lshrrev_b32 v7, 4, v1
    v_bfe_u32 v6, v1, 3, 2
    v_mul_u32_u24 v4, 912, v8
    v_lshl_add_u32 v5, v7, 4, v4
    v_mad_u32_u24 v4, v6, 56, v4
    v_lshl_add_u32 v4, v3, 3, v4
    s_mul_i32 s37, s16, 224
    s_add_u32 s37, s37, 49152
    v_add_u32 v4, s37, v4
    s_xor_b32 s37, s16, 1
    s_mul_i32 s37, s37, 12288
    s_add_u32 s37, s37, 0
    v_add_u32 v12, s37, v2
    s_xor_b32 s37, s16, 2
    s_mul_i32 s37, s37, 12288
    s_add_u32 s37, s37, 4096
    v_add_u32 v13, s37, v2
    s_xor_b32 s37, s16, 3
    s_mul_i32 s37, s37, 12288
    s_add_u32 s37, s37, 8192
    v_add_u32 v14, s37, v2
    s_mul_i32 s37, s16, 12288
    v_add_u32 v11, s37, v2
    s_mul_i32 s34, s19, 118784
    s_lshl_b32 s35, s16, 12
    s_add_u32 s34, s34, s35
    s_add_u32 s34, s34, 0x400000
    s_add_u32 m0, s35, 65536
    v_bfe_u32 v10, v1, 4, 1
    v_lshlrev_b32 v10, 7, v10
    v_lshl_add_u32 v10, v8, 4, v10
    v_lshl_add_u32 v10, v3, 3, v10
    s_lshl_b32 s38, s16, 11
    v_add_u32 v10, s38, v10
    ds_write_b64 v10, v[208:209] offset:8192
    ds_write_b64 v10, v[210:211] offset:8448
    ds_write_b64 v10, v[212:213] offset:8704
    ds_write_b64 v10, v[214:215] offset:8960
    ds_write_b64 v10, v[216:217] offset:9216
    ds_write_b64 v10, v[218:219] offset:9472
    ds_write_b64 v10, v[220:221] offset:9728
    s_waitcnt lgkmcnt(0)
    s_lshl_b32 s40, s17, 8
    s_add_u32 s40, s40, 0x3c7000
    v_and_b32 v15, 31, v1
    v_lshlrev_b32 v15, 3, v15
    s_lshl_b32 s31, s17, 14
    s_lshl_b32 s32, s16, 12
    s_add_u32 s31, s31, s32
    s_add_u32 s31, s31, 0x1800000
    s_mov_b32 s32, s31
    buffer_load_dwordx4 v[160:163], v2, s[20:23], s31 offen sc1
    buffer_load_dwordx4 v[164:167], v2, s[20:23], s31 offen offset:1024 sc1
    buffer_load_dwordx4 v[184:187], v2, s[20:23], s31 offen offset:2048 sc1
    buffer_load_dwordx4 v[188:191], v2, s[20:23], s31 offen offset:3072 sc1
    s_xor_b32 s31, s32, 0x4000
    s_mul_i32 s33, s16, 100352
    s_add_u32 s33, s33, 0x300000
    s_add_u32 s33, s33, 8192
    s_waitcnt vmcnt(0)
    s_barrier
    s_branch K_att43_go
K_end:
    s_endpgm
.section .rodata,"a"
.p2align 6
.amdhsa_kernel interleave_layers__grouped_kv_mqa__dense_activation_gelu__prompt_kernel
  .amdhsa_next_free_vgpr 512
  .amdhsa_next_free_sgpr 64
  .amdhsa_accum_offset 256
  .amdhsa_group_segment_fixed_size 0
  .amdhsa_kernarg_size 104
  .amdhsa_user_sgpr_count 2
  .amdhsa_user_sgpr_kernarg_segment_ptr 1
  .amdhsa_system_sgpr_workgroup_id_x 1
.end_amdhsa_kernel
```
